```python
import torch

def _softmax(x, axis=-1):
    return torch.softmax(x, dim=axis)
def _gelu(x):
    return torch.nn.functional.gelu(x, approximate="tanh")
def _silu(x):
    return torch.nn.functional.silu(x)
def _sigmoid(x):
    return torch.sigmoid(x)
def _layernorm(x, axis=-1, eps=1e-5):
    m = x.mean(dim=axis, keepdim=True)
    v = x.var(dim=axis, keepdim=True, unbiased=False)
    return (x - m) / torch.sqrt(v + eps)
def _scatter_add(tgt, idx, src, axis=0):
    return tgt.clone().index_add_(axis, idx, src)
def _segment_sum(src, seg, n):
    out = torch.zeros((n,) + src.shape[1:], dtype=src.dtype)
    return out.index_add_(0, seg, src)
def _pad(x, pw):
    flat = tuple(v for pair in reversed(pw) for v in pair)
    return torch.nn.functional.pad(x, flat)

kernel_name = 'parallel_sum__ssm_conv_s5__dense_activation_squared_relu__prompt'

def setup_inputs():

    _w = (lambda a: (lambda t: t.to(torch.bfloat16) if t.is_floating_point() else t)(torch.as_tensor(a)))
    def _A_setup():
        B, S, D = 1, 2048, 512
        P = D
        Lambda_re = -0.5 * (lambda _x: torch.exp(torch.as_tensor(_x)))((lambda *s: torch.randn(*s, dtype=torch.bfloat16) * 0.8)(P))
        Lambda_im = (lambda *s: torch.randn(*s, dtype=torch.bfloat16) * 0.8)(P) * 1.0
        B_re = (lambda *s: torch.randn(*s, dtype=torch.bfloat16) * 1.6)(P, D) * (D ** -0.5)
        B_im = (lambda *s: torch.randn(*s, dtype=torch.bfloat16) * 1.6)(P, D) * (D ** -0.5)
        C_re = (lambda *s: torch.randn(*s, dtype=torch.bfloat16) * 1.6)(D, P) * (P ** -0.5)
        C_im = (lambda *s: torch.randn(*s, dtype=torch.bfloat16) * 1.6)(D, P) * (P ** -0.5)
        log_dt = (lambda *s: torch.randn(*s, dtype=torch.bfloat16) * 0.8)(P) * 0.3 - 2.0
        Dskip = (lambda *s: torch.randn(*s, dtype=torch.bfloat16) * 0.4)(D)
        return {
            "x": _w((lambda *s: torch.randn(*s, dtype=torch.bfloat16) * 0.05)(B, S, D)),
            "Lambda_re": _w(Lambda_re),
            "Lambda_im": _w(Lambda_im),
            "B_re": _w(B_re),
            "B_im": _w(B_im),
            "C_re": _w(C_re),
            "C_im": _w(C_im),
            "log_dt": _w(log_dt),
            "Dskip": _w(Dskip),
        }
    _A_in = _A_setup()

    def _B_setup():
        B, S, D, F = 1, 2048, 512, 1792
        return {
            "x": _w((lambda *s: torch.randn(*s, dtype=torch.bfloat16) * 0.05)(B, S, D)),
            "w1": _w((lambda *s: torch.randn(*s, dtype=torch.bfloat16) * 0.05)(D, F)),
            "b1": _w((lambda *s: torch.randn(*s, dtype=torch.bfloat16) * 0.2)(F)),
            "w2": _w((lambda *s: torch.randn(*s, dtype=torch.bfloat16) * 0.05)(F, D)),
            "b2": _w((lambda *s: torch.randn(*s, dtype=torch.bfloat16) * 1.6)(D)),
        }
    _B_in = _B_setup()

    return {
        "A_x": _A_in["x"],
        "A_Lambda_re": _A_in["Lambda_re"],
        "A_Lambda_im": _A_in["Lambda_im"],
        "A_B_re": _A_in["B_re"],
        "A_B_im": _A_in["B_im"],
        "A_C_re": _A_in["C_re"],
        "A_C_im": _A_in["C_im"],
        "A_log_dt": _A_in["log_dt"],
        "A_Dskip": _A_in["Dskip"],
        "B_x": _B_in["x"],
        "B_w1": _B_in["w1"],
        "B_b1": _B_in["b1"],
        "B_w2": _B_in["w2"],
        "B_b2": _B_in["b2"],
    }

def reference(A_x, A_Lambda_re, A_Lambda_im, A_B_re, A_B_im, A_C_re, A_C_im, A_log_dt, A_Dskip, B_x, B_w1, B_b1, B_w2, B_b2):
    def _A_ref(x, Lambda_re, Lambda_im, B_re, B_im, C_re, C_im, log_dt, Dskip):
        Bsz, L, H = x.shape
        Lam = Lambda_re + 1j * Lambda_im
        Bmat = B_re + 1j * B_im
        Cmat = C_re + 1j * C_im
        dt = torch.exp(log_dt)
        Lam_bar = torch.exp(dt * Lam)
        B_bar = ((Lam_bar - 1.0) / Lam)[:, None] * Bmat
        Bu = torch.einsum("bld,pd->blp", x + 0j, B_bar)
        h = torch.zeros_like(Bu[:, 0, :])
        hs = []
        for t in range(L):
            h = Lam_bar[None, :] * h + Bu[:, t, :]
            hs.append(h)
        hseq = torch.stack(hs, 1)
        y = 2.0 * torch.einsum("blp,dp->bld", hseq, Cmat).real + x * Dskip[None, None, :]
        return y

    def _B_ref(x, w1, b1, w2, b2):
        h = torch.einsum("bsd,df->bsf", x, w1) + b1
        zero = torch.zeros_like(h)
        r = torch.where(h > zero, h, zero)
        h = r * r
        out = torch.einsum("bsf,fd->bsd", h, w2) + b2
        return out

    x = A_x
    xn = _layernorm(x, axis=-1)
    return x + _A_ref(xn, A_Lambda_re, A_Lambda_im, A_B_re, A_B_im, A_C_re, A_C_im, A_log_dt, A_Dskip) + _B_ref(xn, B_w1, B_b1, B_w2, B_b2)
```

```asm
; @launch grid=(256,1,1) block=(256,1,1) lds=163840
.amdgcn_target "amdgcn-amd-amdhsa--gfx950"
.text
.globl parallel_sum__ssm_conv_s5__dense_activation_squared_relu__prompt_kernel
.p2align 8
.type parallel_sum__ssm_conv_s5__dense_activation_squared_relu__prompt_kernel,@function
parallel_sum__ssm_conv_s5__dense_activation_squared_relu__prompt_kernel:
    s_cmp_ge_u32 s2, 256
    s_cbranch_scc1 L_end
    s_load_dwordx16 s[64:79], s[0:1], 0
    s_load_dwordx16 s[80:95], s[0:1], 64
    s_load_dwordx2 s[96:97], s[0:1], 128
    v_lshrrev_b32 v32, 6, v0
    v_and_b32 v1, 63, v0
    v_readfirstlane_b32 s56, v32
    v_lshlrev_b32 v2, 4, v1
    s_nop 1
    s_bfe_u32 s3, s2, 327683
    s_lshl2_add_u32 s3, s3, s56
    s_cmpk_ge_u32 s3, 64
    s_cbranch_scc1 L_ret_P
    s_mul_i32 s3, s3, 256
    s_getpc_b64 s[4:5]
L_pc_P:
    s_add_u32 s3, s3, L_pad_P_0-L_pc_P
    s_ashr_i32 s6, s3, 31
    s_add_u32 s4, s4, s3
    s_addc_u32 s5, s5, s6
    s_mov_b64 exec, 0
    s_setpc_b64 s[4:5]
L_ret_P:
    s_mov_b64 exec, -1
    s_mov_b64 s[4:5], 0
    s_bfe_u32 s3, s2, 327683
    s_lshl2_add_u32 s3, s3, s56
    s_xor_b32 s3, s3, 127
    s_cmpk_ge_u32 s3, 64
    s_cbranch_scc1 L_ret_Q
    s_mul_i32 s3, s3, 256
    s_getpc_b64 s[4:5]
L_pc_Q:
    s_add_u32 s3, s3, L_pad_Q_0-L_pc_Q
    s_ashr_i32 s6, s3, 31
    s_add_u32 s4, s4, s3
    s_addc_u32 s5, s5, s6
    s_mov_b64 exec, 0
    s_setpc_b64 s[4:5]
L_ret_Q:
    s_mov_b64 exec, -1
    s_mov_b64 s[4:5], 0
R_P1:
    v_lshrrev_b32 v32, 3, v1
    v_and_b32 v33, 7, v1
    v_lshrrev_b32 v34, 4, v1
    v_lshrrev_b32 v35, 5, v1
    v_and_b32 v36, 31, v1
    v_xor_b32 v37, v33, v34
    v_lshlrev_b32 v37, 4, v37
    v_lshl_add_u32 v5, v32, 10, v37
    v_xor_b32 v6, 64, v5
    v_and_b32 v38, 1, v34
    v_lshlrev_b32 v38, 2, v38
    v_xor_b32 v38, v38, v33
    v_lshlrev_b32 v38, 4, v38
L_pad_P_0:
    s_cbranch_execz L_ret_P
    v_lshl_add_u32 v9, v32, 10, v38
    v_mul_u32_u24 v7, 3584, v32
    v_add_u32 v7, v7, v38
    v_lshrrev_b32 v8, 2, v1
    v_mul_u32_u24 v8, 3584, v8
    v_and_b32 v38, 3, v1
    v_lshl_add_u32 v8, v38, 4, v8
    v_bfe_u32 v38, v1, 1, 3
    v_xor_b32 v38, v38, v35
    v_lshlrev_b32 v38, 4, v38
    v_lshl_add_u32 v10, v36, 7, v38
    v_xor_b32 v11, 32, v10
    v_xor_b32 v12, 64, v10
    v_xor_b32 v13, 96, v10
    v_and_b32 v38, 3, v1
    v_lshlrev_b32 v38, 3, v38
    v_and_b32 v33, 1, v34
    v_lshl_add_u32 v38, v33, 5, v38
    v_bfe_u32 v33, v1, 2, 2
    v_lshl_add_u32 v22, v35, 3, v33
    v_lshl_add_u32 v18, v22, 7, v38
    v_lshl_add_u32 v22, v22, 6, v38
    v_lshl_add_u32 v24, v35, 2, v33
    v_lshl_add_u32 v24, v24, 7, v38
    v_and_b32 v33, 1, v32
    v_lshlrev_b32 v33, 6, v33
    v_add_u32 v18, v18, v33
    v_xor_b32 v19, 64, v18
    v_add_u32 v24, v24, v33
    s_and_b32 s3, s2, 7
    s_lshr_b32 s4, s2, 3
    s_lshr_b32 s57, s3, 2
    s_and_b32 s7, s4, 7
    s_lshl3_add_u32 s57, s57, s7
    s_and_b32 s5, s4, 3
    s_lshr_b32 s6, s4, 3
    s_and_b32 s59, s3, 3
    s_add_u32 s59, s59, s6
    s_lshl_b32 s59, s59, 1
    s_and_b32 s7, s4, 4
    s_add_u32 s59, s59, s7
    s_and_b32 s58, s3, 3
    s_and_b32 s7, s6, 1
    s_lshl1_add_u32 s58, s58, s7
    s_lshl_b32 s6, s6, 1
    s_lshl_b32 s60, s56, 12
    s_and_b32 s7, s56, 1
    s_lshl_b32 s7, s7, 6
    v_xor_b32 v24, s7, v24
L_pad_P_1:
    s_cbranch_execz L_ret_P
    s_lshr_b32 s7, s56, 1
    v_lshl_add_u32 v24, s7, 12, v24
    v_mov_b32 v32, -1
    v_accvgpr_write_b32 a248, v32
    v_accvgpr_write_b32 a249, v32
    v_accvgpr_write_b32 a250, v32
    v_accvgpr_write_b32 a251, v32
    s_waitcnt lgkmcnt(0)
    s_mov_b32 s8, s64
    s_mov_b32 s9, s65
    s_mov_b32 s10, 2097152
    s_mov_b32 s11, 0x00020000
    s_mov_b32 s20, s88
    s_mov_b32 s21, s89
    s_mov_b32 s22, 1835008
    s_mov_b32 s23, 0x00020000
    s_mov_b32 s24, s74
    s_mov_b32 s25, s75
    s_mov_b32 s26, 524288
    s_mov_b32 s27, 0x00020000
    s_mov_b32 s28, s76
    s_mov_b32 s29, s77
    s_mov_b32 s30, 524288
    s_mov_b32 s31, 0x00020000
    s_mov_b32 s32, s92
    s_mov_b32 s33, s93
    s_mov_b32 s34, 4194304
    s_mov_b32 s35, 0x00020000
    s_mov_b32 s36, s94
    s_mov_b32 s37, s95
    s_mov_b32 s38, 256
    s_mov_b32 s39, 0x00020000
    s_mov_b32 s16, s96
    s_mov_b32 s17, s97
    s_mov_b32 s18, 17973248
    s_mov_b32 s19, 0x00020000
    s_mov_b64 s[44:45], s[86:87]
    s_mov_b64 s[46:47], s[90:91]
    s_mov_b64 s[48:49], s[80:81]
    s_mov_b64 s[50:51], s[66:67]
    s_mov_b64 s[52:53], s[68:69]
    s_mov_b64 s[54:55], s[78:79]
    s_lshl_b32 s61, s58, 13
    s_nop 0
L_pad_P_2:
    s_cbranch_execz L_ret_P
    s_add_u32 s61, s61, 11599872
    s_add_u32 s40, s96, s61
    s_addc_u32 s41, s97, 0
    s_mov_b32 s42, 8192
    s_mov_b32 s43, 0x00020000
    s_bitcmp1_b32 s56, 0
    s_cselect_b64 s[98:99], s[72:73], s[70:71]
    s_cmp_ge_u32 s6, 4
    s_cselect_b64 s[98:99], s[98:99], s[84:85]
    s_mov_b32 s7, 1835008
    s_cselect_b32 s14, 524288, s7
    s_mov_b32 s12, s98
    s_mov_b32 s13, s99
    s_mov_b32 s15, 0x00020000
    s_lshr_b32 s66, s58, 1
    s_and_b32 s7, s58, 1
    s_lshr_b32 s61, s6, 2
    s_lshl1_add_u32 s61, s61, s7
    s_xor_b32 s101, s61, 1
    s_add_u32 s67, s61, s5
    s_and_b32 s67, s67, 3
    s_lshr_b32 s68, s56, 1
    s_lshl_b32 s68, s68, 15
    s_mul_i32 s69, s66, 458752
    s_and_b32 s61, s56, 1
    s_lshl1_add_u32 s61, s67, s61
    s_lshl_b32 s61, s61, 7
    s_add_u32 s69, s69, s61
    s_lshl2_add_u32 s70, s67, s56
    s_lshl_b32 s70, s70, 15
    s_lshl_b32 s61, s58, 7
    s_add_u32 s70, s70, s61
    s_lshl2_add_u32 s100, s57, s67
    s_mul_i32 s100, s100, 98304
    s_lshr_b32 s61, s60, 1
    s_add_u32 s100, s100, s61
    s_add_u32 s100, s100, 11665408
    s_lshl2_add_u32 s82, s57, s66
    s_lshl_b32 s82, s82, 8
    s_add_u32 s82, s82, 17956864
    s_lshl2_add_u32 s101, s101, s82
    s_lshl_b32 s61, s5, 2
    s_lshr_b32 s61, 528, s61
    s_and_b32 s61, s61, 3
    s_lshl2_add_u32 s61, s7, s61
    s_lshl_b32 s74, s61, 7
    s_lshl_b32 s61, s5, 2
    s_lshr_b32 s61, 4129, s61
    s_and_b32 s61, s61, 3
    s_lshl2_add_u32 s61, s7, s61
    s_lshl_b32 s75, s61, 7
L_pad_P_3:
    s_cbranch_execz L_ret_P
    s_lshl_b32 s61, s5, 2
    s_lshr_b32 s61, 8450, s61
    s_and_b32 s61, s61, 3
    s_lshl2_add_u32 s61, s7, s61
    s_lshl_b32 s76, s61, 7
    s_lshl_b32 s77, s7, 6
    s_add_u32 s77, s77, 384
    s_mov_b32 s72, 0x3f803f80
    s_lshl2_add_u32 s63, s57, s56
    s_mul_i32 s64, s63, 180224
    s_lshl_b32 s63, s63, 15
    s_mul_i32 s71, s66, 28672
    s_add_u32 s71, s71, s64
    s_lshl_b32 s83, s58, 13
    s_add_u32 s83, s83, s64
    s_add_u32 s83, s83, 114688
    s_cmp_lg_u32 s56, 0
    s_cbranch_scc1 L_fs216
    s_xor_b32 s78, s101, 4
    v_mov_b32 v37, 0
    s_mov_b64 exec, 1
    buffer_store_dword v37, off, s[16:19], s78 sc1
    s_mov_b64 exec, -1
L_fs216:
    s_cmp_ge_u32 s6, 4
    s_cbranch_scc1 L_ssm
    v_add_u32 v3, s63, v5
    v_add_u32 v4, s63, v6
    s_lshl2_add_u32 s65, s5, s56
    s_mul_i32 s73, s66, 896
    s_lshr_b32 s3, s56, 1
    s_and_b32 s4, s56, 1
    s_mul_i32 s4, s4, 114688
    s_add_u32 s4, s4, s73
    s_add_u32 s3, s3, s59
    s_add_u32 s5, s56, s59
    s_add_u32 m0, s60, 0
    s_add_u32 s61, s59, 0
    s_and_b32 s61, s61, 7
    s_mul_i32 s61, s61, 128
    buffer_load_dwordx4 v3, s[8:11], s61 offen offset:0 lds
    s_add_u32 s61, s61, 7168
    buffer_load_dwordx4 v4, s[8:11], s61 offen offset:1024 lds
    s_add_u32 s61, s61, 7168
    buffer_load_dwordx4 v3, s[8:11], s61 offen offset:2048 lds
    s_add_u32 s61, s61, 7168
    buffer_load_dwordx4 v4, s[8:11], s61 offen offset:3072 lds
L_pad_P_4:
    s_cbranch_execz L_ret_P
    s_add_u32 m0, s60, 16384
    s_add_u32 s61, s59, 1
    s_and_b32 s61, s61, 7
    s_mul_i32 s61, s61, 128
    buffer_load_dwordx4 v3, s[8:11], s61 offen offset:0 lds
    s_add_u32 s61, s61, 7168
    buffer_load_dwordx4 v4, s[8:11], s61 offen offset:1024 lds
    s_add_u32 s61, s61, 7168
    buffer_load_dwordx4 v3, s[8:11], s61 offen offset:2048 lds
    s_add_u32 s61, s61, 7168
    buffer_load_dwordx4 v4, s[8:11], s61 offen offset:3072 lds
    s_add_u32 m0, s60, 32768
    s_add_u32 s61, s59, 2
    s_and_b32 s61, s61, 7
    s_mul_i32 s61, s61, 128
    buffer_load_dwordx4 v3, s[8:11], s61 offen offset:0 lds
    s_add_u32 s61, s61, 7168
    buffer_load_dwordx4 v4, s[8:11], s61 offen offset:1024 lds
    s_add_u32 s61, s61, 7168
    buffer_load_dwordx4 v3, s[8:11], s61 offen offset:2048 lds
    s_add_u32 s61, s61, 7168
    buffer_load_dwordx4 v4, s[8:11], s61 offen offset:3072 lds
    v_accvgpr_write_b32 a224, 0
    v_accvgpr_write_b32 a225, 0
    v_accvgpr_write_b32 a226, 0
    v_accvgpr_write_b32 a227, 0
    v_accvgpr_write_b32 a228, 0
    v_accvgpr_write_b32 a229, 0
    v_accvgpr_write_b32 a230, 0
    v_accvgpr_write_b32 a231, 0
    v_accvgpr_write_b32 a232, 0
    v_accvgpr_write_b32 a233, 0
    v_accvgpr_write_b32 a234, 0
    s_nop 0
L_pad_P_5:
    s_cbranch_execz L_ret_P
    v_accvgpr_write_b32 a235, 0
    v_accvgpr_write_b32 a236, 0
    v_accvgpr_write_b32 a237, 0
    v_accvgpr_write_b32 a238, 0
    v_accvgpr_write_b32 a239, 0
    v_accvgpr_write_b32 a240, 0
    v_accvgpr_write_b32 a241, 0
    v_accvgpr_write_b32 a242, 0
    v_accvgpr_write_b32 a243, 0
    v_accvgpr_write_b32 a244, 0
    v_accvgpr_write_b32 a245, 0
    v_accvgpr_write_b32 a246, 0
    v_accvgpr_write_b32 a247, 0
    v_and_b32 v32, 31, v1
    v_lshl_add_u32 v32, v32, 1, s73
    v_add_u32 v33, s74, v32
    global_load_ushort a224, v33, s[44:45] offset:0
    global_load_ushort a226, v33, s[44:45] offset:64
    v_add_u32 v33, s75, v32
    global_load_ushort a228, v33, s[44:45] offset:0
    global_load_ushort a230, v33, s[44:45] offset:64
    v_add_u32 v33, s76, v32
    global_load_ushort a232, v33, s[44:45] offset:0
    global_load_ushort a234, v33, s[44:45] offset:64
    v_add_u32 v33, s77, v32
    global_load_ushort a236, v33, s[44:45] offset:0
    s_bfe_u32 s61, s2, 262147
    s_lshl2_add_u32 s61, s61, s56
    s_cmpk_ge_u32 s61, 0
    s_cbranch_scc1 L_ret_F
    s_mul_i32 s61, s61, 256
    s_getpc_b64 s[78:79]
L_pc_F:
    s_add_u32 s61, s61, L_pad_F_0-L_pc_F
    s_ashr_i32 s62, s61, 31
    s_add_u32 s78, s78, s61
    s_addc_u32 s79, s79, s62
    s_mov_b64 exec, 0
    s_setpc_b64 s[78:79]
L_ret_F:
    s_mov_b64 exec, -1
L_pad_P_6:
    s_cbranch_execz L_ret_P
    s_mov_b64 s[78:79], 0
    v_and_b32 v32, 1, v1
    v_lshlrev_b32 v32, 4, v32
    v_mov_b32 v33, 0x3f80
    v_lshlrev_b32 v32, v32, v33
    v_lshrrev_b32 v33, 3, v1
    v_xor_b32 v33, v33, v1
    v_and_b32 v33, 4, v33
    v_cmp_eq_u32 vcc, 0, v33
    v_cndmask_b32 v32, 0, v32, vcc
    v_bfe_u32 v33, v1, 3, 2
    v_bfe_u32 v34, v1, 1, 1
    v_lshl_add_u32 v33, v33, 1, v34
    v_cmp_eq_u32 vcc, 0, v33
    v_cndmask_b32 v34, 0, v32, vcc
    v_accvgpr_write_b32 a208, v34
    v_cmp_eq_u32 vcc, 1, v33
    v_cndmask_b32 v34, 0, v32, vcc
    v_accvgpr_write_b32 a209, v34
    v_cmp_eq_u32 vcc, 2, v33
    v_cndmask_b32 v34, 0, v32, vcc
    v_accvgpr_write_b32 a210, v34
    v_cmp_eq_u32 vcc, 3, v33
    v_cndmask_b32 v34, 0, v32, vcc
    v_accvgpr_write_b32 a211, v34
    v_cmp_eq_u32 vcc, 4, v33
    v_cndmask_b32 v34, 0, v32, vcc
    v_accvgpr_write_b32 a212, v34
    v_cmp_eq_u32 vcc, 5, v33
    v_cndmask_b32 v34, 0, v32, vcc
    v_accvgpr_write_b32 a213, v34
    v_cmp_eq_u32 vcc, 6, v33
    v_cndmask_b32 v34, 0, v32, vcc
    v_accvgpr_write_b32 a214, v34
    v_cmp_eq_u32 vcc, 7, v33
    v_cndmask_b32 v34, 0, v32, vcc
    v_accvgpr_write_b32 a215, v34
    v_add_u32 v14, s60, v10
    v_add_u32 v15, s60, v11
    v_add_u32 v16, s60, v12
    v_add_u32 v17, s60, v13
    v_mov_b32 v28, 0
    v_mov_b32 v29, 0
    v_mov_b32 v30, 0
    v_mov_b32 v31, 0
    s_waitcnt vmcnt(15)
    ds_read_b128 v[128:131], v14 offset:0
    ds_read_b128 v[132:135], v15 offset:0
    s_nop 0
L_pad_P_7:
    s_cbranch_execz L_ret_P
    ds_read_b128 v[136:139], v16 offset:0
    ds_read_b128 v[140:143], v17 offset:0
    s_add_u32 m0, s60, 49152
    s_add_u32 s61, s59, 3
    s_and_b32 s61, s61, 7
    s_mul_i32 s61, s61, 128
    buffer_load_dwordx4 v3, s[8:11], s61 offen offset:0 lds
    s_add_u32 s61, s61, 7168
    buffer_load_dwordx4 v4, s[8:11], s61 offen offset:1024 lds
    s_add_u32 s61, s61, 7168
    buffer_load_dwordx4 v3, s[8:11], s61 offen offset:2048 lds
    s_add_u32 s61, s61, 7168
    buffer_load_dwordx4 v4, s[8:11], s61 offen offset:3072 lds
    s_waitcnt vmcnt(15)
    s_waitcnt lgkmcnt(0)
    ds_read_b128 v[144:147], v14 offset:16384
    ds_read_b128 v[148:151], v15 offset:16384
    ds_read_b128 v[152:155], v16 offset:16384
    ds_read_b128 v[156:159], v17 offset:16384
    s_add_u32 m0, s60, 65536
    s_add_u32 s61, s59, 4
    s_and_b32 s61, s61, 7
    s_mul_i32 s61, s61, 128
    buffer_load_dwordx4 v3, s[8:11], s61 offen offset:0 lds
    v_dot2_f32_bf16 v28, v128, s72, v28
    v_dot2_f32_bf16 v29, v128, v128, v29
    v_dot2_f32_bf16 v30, v129, s72, v30
    v_dot2_f32_bf16 v31, v129, v129, v31
    s_add_u32 s61, s61, 7168
    buffer_load_dwordx4 v4, s[8:11], s61 offen offset:1024 lds
    v_dot2_f32_bf16 v28, v130, s72, v28
    v_dot2_f32_bf16 v29, v130, v130, v29
    v_dot2_f32_bf16 v30, v131, s72, v30
    v_dot2_f32_bf16 v31, v131, v131, v31
    s_nop 0
L_pad_P_8:
    s_cbranch_execz L_ret_P
    s_add_u32 s61, s61, 7168
    buffer_load_dwordx4 v3, s[8:11], s61 offen offset:2048 lds
    v_dot2_f32_bf16 v28, v132, s72, v28
    v_dot2_f32_bf16 v29, v132, v132, v29
    v_dot2_f32_bf16 v30, v133, s72, v30
    v_dot2_f32_bf16 v31, v133, v133, v31
    s_add_u32 s61, s61, 7168
    buffer_load_dwordx4 v4, s[8:11], s61 offen offset:3072 lds
    v_dot2_f32_bf16 v28, v134, s72, v28
    v_dot2_f32_bf16 v29, v134, v134, v29
    v_dot2_f32_bf16 v30, v135, s72, v30
    v_dot2_f32_bf16 v31, v135, v135, v31
    v_dot2_f32_bf16 v28, v136, s72, v28
    v_dot2_f32_bf16 v29, v136, v136, v29
    v_dot2_f32_bf16 v30, v137, s72, v30
    v_dot2_f32_bf16 v31, v137, v137, v31
    v_dot2_f32_bf16 v28, v138, s72, v28
    v_dot2_f32_bf16 v29, v138, v138, v29
    v_dot2_f32_bf16 v30, v139, s72, v30
    v_dot2_f32_bf16 v31, v139, v139, v31
    v_dot2_f32_bf16 v28, v140, s72, v28
    v_dot2_f32_bf16 v29, v140, v140, v29
    v_dot2_f32_bf16 v30, v141, s72, v30
    v_dot2_f32_bf16 v31, v141, v141, v31
    v_dot2_f32_bf16 v28, v142, s72, v28
    v_dot2_f32_bf16 v29, v142, v142, v29
    v_dot2_f32_bf16 v30, v143, s72, v30
    v_dot2_f32_bf16 v31, v143, v143, v31
    s_waitcnt vmcnt(15)
    s_waitcnt lgkmcnt(0)
    ds_read_b128 v[160:163], v14 offset:32768
    ds_read_b128 v[164:167], v15 offset:32768
    s_nop 0
L_pad_P_9:
    s_cbranch_execz L_ret_P
    ds_read_b128 v[168:171], v16 offset:32768
    ds_read_b128 v[172:175], v17 offset:32768
    s_add_u32 m0, s60, 81920
    s_add_u32 s61, s59, 5
    s_and_b32 s61, s61, 7
    s_mul_i32 s61, s61, 128
    buffer_load_dwordx4 v3, s[8:11], s61 offen offset:0 lds
    v_dot2_f32_bf16 v28, v144, s72, v28
    v_dot2_f32_bf16 v29, v144, v144, v29
    v_dot2_f32_bf16 v30, v145, s72, v30
    v_dot2_f32_bf16 v31, v145, v145, v31
    s_add_u32 s61, s61, 7168
    buffer_load_dwordx4 v4, s[8:11], s61 offen offset:1024 lds
    v_dot2_f32_bf16 v28, v146, s72, v28
    v_dot2_f32_bf16 v29, v146, v146, v29
    v_dot2_f32_bf16 v30, v147, s72, v30
    v_dot2_f32_bf16 v31, v147, v147, v31
    s_add_u32 s61, s61, 7168
    buffer_load_dwordx4 v3, s[8:11], s61 offen offset:2048 lds
    v_dot2_f32_bf16 v28, v148, s72, v28
    v_dot2_f32_bf16 v29, v148, v148, v29
    v_dot2_f32_bf16 v30, v149, s72, v30
    v_dot2_f32_bf16 v31, v149, v149, v31
    s_add_u32 s61, s61, 7168
    buffer_load_dwordx4 v4, s[8:11], s61 offen offset:3072 lds
    v_dot2_f32_bf16 v28, v150, s72, v28
    v_dot2_f32_bf16 v29, v150, v150, v29
    v_dot2_f32_bf16 v30, v151, s72, v30
    v_dot2_f32_bf16 v31, v151, v151, v31
    v_dot2_f32_bf16 v28, v152, s72, v28
    v_dot2_f32_bf16 v29, v152, v152, v29
    v_dot2_f32_bf16 v30, v153, s72, v30
    s_nop 0
L_pad_P_10:
    s_cbranch_execz L_ret_P
    v_dot2_f32_bf16 v31, v153, v153, v31
    v_dot2_f32_bf16 v28, v154, s72, v28
    v_dot2_f32_bf16 v29, v154, v154, v29
    v_dot2_f32_bf16 v30, v155, s72, v30
    v_dot2_f32_bf16 v31, v155, v155, v31
    v_dot2_f32_bf16 v28, v156, s72, v28
    v_dot2_f32_bf16 v29, v156, v156, v29
    v_dot2_f32_bf16 v30, v157, s72, v30
    v_dot2_f32_bf16 v31, v157, v157, v31
    v_dot2_f32_bf16 v28, v158, s72, v28
    v_dot2_f32_bf16 v29, v158, v158, v29
    v_dot2_f32_bf16 v30, v159, s72, v30
    v_dot2_f32_bf16 v31, v159, v159, v31
    s_waitcnt vmcnt(8)
    s_waitcnt lgkmcnt(0)
    ds_read_b128 v[176:179], v14 offset:49152
    ds_read_b128 v[180:183], v15 offset:49152
    ds_read_b128 v[184:187], v16 offset:49152
    ds_read_b128 v[188:191], v17 offset:49152
    s_add_u32 m0, s60, 98304
    s_add_u32 s61, s59, 6
    s_and_b32 s61, s61, 7
    s_mul_i32 s61, s61, 128
    buffer_load_dwordx4 v3, s[8:11], s61 offen offset:0 lds
    v_dot2_f32_bf16 v28, v160, s72, v28
    v_dot2_f32_bf16 v29, v160, v160, v29
    v_dot2_f32_bf16 v30, v161, s72, v30
    v_dot2_f32_bf16 v31, v161, v161, v31
    s_add_u32 s61, s61, 7168
    buffer_load_dwordx4 v4, s[8:11], s61 offen offset:1024 lds
    v_dot2_f32_bf16 v28, v162, s72, v28
    v_dot2_f32_bf16 v29, v162, v162, v29
    v_dot2_f32_bf16 v30, v163, s72, v30
    s_nop 0
L_pad_P_11:
    s_cbranch_execz L_ret_P
    v_dot2_f32_bf16 v31, v163, v163, v31
    s_add_u32 s61, s61, 7168
    buffer_load_dwordx4 v3, s[8:11], s61 offen offset:2048 lds
    v_dot2_f32_bf16 v28, v164, s72, v28
    v_dot2_f32_bf16 v29, v164, v164, v29
    v_dot2_f32_bf16 v30, v165, s72, v30
    v_dot2_f32_bf16 v31, v165, v165, v31
    s_add_u32 s61, s61, 7168
    buffer_load_dwordx4 v4, s[8:11], s61 offen offset:3072 lds
    v_dot2_f32_bf16 v28, v166, s72, v28
    v_dot2_f32_bf16 v29, v166, v166, v29
    v_dot2_f32_bf16 v30, v167, s72, v30
    v_dot2_f32_bf16 v31, v167, v167, v31
    v_dot2_f32_bf16 v28, v168, s72, v28
    v_dot2_f32_bf16 v29, v168, v168, v29
    v_dot2_f32_bf16 v30, v169, s72, v30
    v_dot2_f32_bf16 v31, v169, v169, v31
    v_dot2_f32_bf16 v28, v170, s72, v28
    v_dot2_f32_bf16 v29, v170, v170, v29
    v_dot2_f32_bf16 v30, v171, s72, v30
    v_dot2_f32_bf16 v31, v171, v171, v31
    v_dot2_f32_bf16 v28, v172, s72, v28
    v_dot2_f32_bf16 v29, v172, v172, v29
    v_dot2_f32_bf16 v30, v173, s72, v30
    v_dot2_f32_bf16 v31, v173, v173, v31
    v_dot2_f32_bf16 v28, v174, s72, v28
    v_dot2_f32_bf16 v29, v174, v174, v29
    v_dot2_f32_bf16 v30, v175, s72, v30
    v_dot2_f32_bf16 v31, v175, v175, v31
    s_waitcnt vmcnt(8)
    s_waitcnt lgkmcnt(0)
    v_add_u32 v40, 65536, v14
    s_nop 0
L_pad_P_12:
    s_cbranch_execz L_ret_P
    v_add_u32 v41, 65536, v15
    v_add_u32 v42, 65536, v16
    v_add_u32 v43, 65536, v17
    ds_read_b128 v[192:195], v40 offset:0
    ds_read_b128 v[196:199], v41 offset:0
    ds_read_b128 v[200:203], v42 offset:0
    ds_read_b128 v[204:207], v43 offset:0
    s_add_u32 m0, s60, 114688
    s_add_u32 s61, s59, 7
    s_and_b32 s61, s61, 7
    s_mul_i32 s61, s61, 128
    buffer_load_dwordx4 v3, s[8:11], s61 offen offset:0 lds
    v_dot2_f32_bf16 v28, v176, s72, v28
    v_dot2_f32_bf16 v29, v176, v176, v29
    v_dot2_f32_bf16 v30, v177, s72, v30
    v_dot2_f32_bf16 v31, v177, v177, v31
    s_add_u32 s61, s61, 7168
    buffer_load_dwordx4 v4, s[8:11], s61 offen offset:1024 lds
    v_dot2_f32_bf16 v28, v178, s72, v28
    v_dot2_f32_bf16 v29, v178, v178, v29
    v_dot2_f32_bf16 v30, v179, s72, v30
    v_dot2_f32_bf16 v31, v179, v179, v31
    s_add_u32 s61, s61, 7168
    buffer_load_dwordx4 v3, s[8:11], s61 offen offset:2048 lds
    v_dot2_f32_bf16 v28, v180, s72, v28
    v_dot2_f32_bf16 v29, v180, v180, v29
    v_dot2_f32_bf16 v30, v181, s72, v30
    v_dot2_f32_bf16 v31, v181, v181, v31
    s_add_u32 s61, s61, 7168
    buffer_load_dwordx4 v4, s[8:11], s61 offen offset:3072 lds
    v_dot2_f32_bf16 v28, v182, s72, v28
    v_dot2_f32_bf16 v29, v182, v182, v29
    s_nop 0
L_pad_P_13:
    s_cbranch_execz L_ret_P
    v_dot2_f32_bf16 v30, v183, s72, v30
    v_dot2_f32_bf16 v31, v183, v183, v31
    v_dot2_f32_bf16 v28, v184, s72, v28
    v_dot2_f32_bf16 v29, v184, v184, v29
    v_dot2_f32_bf16 v30, v185, s72, v30
    v_dot2_f32_bf16 v31, v185, v185, v31
    v_dot2_f32_bf16 v28, v186, s72, v28
    v_dot2_f32_bf16 v29, v186, v186, v29
    v_dot2_f32_bf16 v30, v187, s72, v30
    v_dot2_f32_bf16 v31, v187, v187, v31
    v_dot2_f32_bf16 v28, v188, s72, v28
    v_dot2_f32_bf16 v29, v188, v188, v29
    v_dot2_f32_bf16 v30, v189, s72, v30
    v_dot2_f32_bf16 v31, v189, v189, v31
    v_dot2_f32_bf16 v28, v190, s72, v28
    v_dot2_f32_bf16 v29, v190, v190, v29
    v_dot2_f32_bf16 v30, v191, s72, v30
    v_dot2_f32_bf16 v31, v191, v191, v31
    s_waitcnt vmcnt(8)
    s_waitcnt lgkmcnt(0)
    ds_read_b128 v[208:211], v40 offset:16384
    ds_read_b128 v[212:215], v41 offset:16384
    ds_read_b128 v[216:219], v42 offset:16384
    ds_read_b128 v[220:223], v43 offset:16384
    s_add_u32 m0, s60, 131072
    s_add_u32 s61, s3, 0
    s_and_b32 s61, s61, 7
    s_mul_i32 s61, s61, 229376
    s_add_u32 s61, s61, s4
    s_add_u32 s61, s61, s74
    buffer_load_dwordx4 v7, s[12:15], s61 offen offset:0 lds
    v_dot2_f32_bf16 v28, v192, s72, v28
    v_dot2_f32_bf16 v29, v192, v192, v29
    v_dot2_f32_bf16 v30, v193, s72, v30
    s_nop 0
L_pad_P_14:
    s_cbranch_execz L_ret_P
    v_dot2_f32_bf16 v31, v193, v193, v31
    s_add_u32 s61, s61, 27648
    buffer_load_dwordx4 v7, s[12:15], s61 offen offset:1024 lds
    v_dot2_f32_bf16 v28, v194, s72, v28
    v_dot2_f32_bf16 v29, v194, v194, v29
    v_dot2_f32_bf16 v30, v195, s72, v30
    v_dot2_f32_bf16 v31, v195, v195, v31
    s_add_u32 s61, s61, 27648
    buffer_load_dwordx4 v7, s[12:15], s61 offen offset:2048 lds
    v_dot2_f32_bf16 v28, v196, s72, v28
    v_dot2_f32_bf16 v29, v196, v196, v29
    v_dot2_f32_bf16 v30, v197, s72, v30
    v_dot2_f32_bf16 v31, v197, v197, v31
    s_add_u32 s61, s61, 27648
    buffer_load_dwordx4 v7, s[12:15], s61 offen offset:3072 lds
    v_dot2_f32_bf16 v28, v198, s72, v28
    v_dot2_f32_bf16 v29, v198, v198, v29
    v_dot2_f32_bf16 v30, v199, s72, v30
    v_dot2_f32_bf16 v31, v199, v199, v31
    v_dot2_f32_bf16 v28, v200, s72, v28
    v_dot2_f32_bf16 v29, v200, v200, v29
    v_dot2_f32_bf16 v30, v201, s72, v30
    v_dot2_f32_bf16 v31, v201, v201, v31
    v_dot2_f32_bf16 v28, v202, s72, v28
    v_dot2_f32_bf16 v29, v202, v202, v29
    v_dot2_f32_bf16 v30, v203, s72, v30
    v_dot2_f32_bf16 v31, v203, v203, v31
    v_dot2_f32_bf16 v28, v204, s72, v28
    v_dot2_f32_bf16 v29, v204, v204, v29
    v_dot2_f32_bf16 v30, v205, s72, v30
    v_dot2_f32_bf16 v31, v205, v205, v31
    s_nop 0
L_pad_P_15:
    s_cbranch_execz L_ret_P
    v_dot2_f32_bf16 v28, v206, s72, v28
    v_dot2_f32_bf16 v29, v206, v206, v29
    v_dot2_f32_bf16 v30, v207, s72, v30
    v_dot2_f32_bf16 v31, v207, v207, v31
    s_waitcnt vmcnt(8)
    s_waitcnt lgkmcnt(0)
    ds_read_b128 v[224:227], v40 offset:32768
    ds_read_b128 v[228:231], v41 offset:32768
    ds_read_b128 v[232:235], v42 offset:32768
    ds_read_b128 v[236:239], v43 offset:32768
    s_add_u32 m0, s60, 147456
    s_add_u32 s61, s3, 2
    s_and_b32 s61, s61, 7
    s_mul_i32 s61, s61, 229376
    s_add_u32 s61, s61, s4
    s_add_u32 s61, s61, s74
    buffer_load_dwordx4 v7, s[12:15], s61 offen offset:0 lds
    v_dot2_f32_bf16 v28, v208, s72, v28
    v_dot2_f32_bf16 v29, v208, v208, v29
    v_dot2_f32_bf16 v30, v209, s72, v30
    v_dot2_f32_bf16 v31, v209, v209, v31
    s_add_u32 s61, s61, 27648
    buffer_load_dwordx4 v7, s[12:15], s61 offen offset:1024 lds
    v_dot2_f32_bf16 v28, v210, s72, v28
    v_dot2_f32_bf16 v29, v210, v210, v29
    v_dot2_f32_bf16 v30, v211, s72, v30
    v_dot2_f32_bf16 v31, v211, v211, v31
    s_add_u32 s61, s61, 27648
    buffer_load_dwordx4 v7, s[12:15], s61 offen offset:2048 lds
    v_dot2_f32_bf16 v28, v212, s72, v28
    v_dot2_f32_bf16 v29, v212, v212, v29
    v_dot2_f32_bf16 v30, v213, s72, v30
    v_dot2_f32_bf16 v31, v213, v213, v31
    s_add_u32 s61, s61, 27648
    s_nop 0
L_pad_P_16:
    s_cbranch_execz L_ret_P
    buffer_load_dwordx4 v7, s[12:15], s61 offen offset:3072 lds
    v_dot2_f32_bf16 v28, v214, s72, v28
    v_dot2_f32_bf16 v29, v214, v214, v29
    v_dot2_f32_bf16 v30, v215, s72, v30
    v_dot2_f32_bf16 v31, v215, v215, v31
    v_dot2_f32_bf16 v28, v216, s72, v28
    v_dot2_f32_bf16 v29, v216, v216, v29
    v_dot2_f32_bf16 v30, v217, s72, v30
    v_dot2_f32_bf16 v31, v217, v217, v31
    v_dot2_f32_bf16 v28, v218, s72, v28
    v_dot2_f32_bf16 v29, v218, v218, v29
    v_dot2_f32_bf16 v30, v219, s72, v30
    v_dot2_f32_bf16 v31, v219, v219, v31
    v_dot2_f32_bf16 v28, v220, s72, v28
    v_dot2_f32_bf16 v29, v220, v220, v29
    v_dot2_f32_bf16 v30, v221, s72, v30
    v_dot2_f32_bf16 v31, v221, v221, v31
    v_dot2_f32_bf16 v28, v222, s72, v28
    v_dot2_f32_bf16 v29, v222, v222, v29
    v_dot2_f32_bf16 v30, v223, s72, v30
    v_dot2_f32_bf16 v31, v223, v223, v31
    s_waitcnt vmcnt(8)
    s_waitcnt lgkmcnt(0)
    ds_read_b128 v[240:243], v40 offset:49152
    ds_read_b128 v[244:247], v41 offset:49152
    ds_read_b128 v[248:251], v42 offset:49152
    ds_read_b128 v[252:255], v43 offset:49152
    s_add_u32 m0, s60, 0
    s_add_u32 s61, s3, 4
    s_and_b32 s61, s61, 7
    s_mul_i32 s61, s61, 229376
    s_add_u32 s61, s61, s4
    s_add_u32 s61, s61, s74
    buffer_load_dwordx4 v7, s[12:15], s61 offen offset:0 lds
    v_dot2_f32_bf16 v28, v224, s72, v28
L_pad_P_17:
    s_cbranch_execz L_ret_P
    v_dot2_f32_bf16 v29, v224, v224, v29
    v_dot2_f32_bf16 v30, v225, s72, v30
    v_dot2_f32_bf16 v31, v225, v225, v31
    s_add_u32 s61, s61, 27648
    buffer_load_dwordx4 v7, s[12:15], s61 offen offset:1024 lds
    v_dot2_f32_bf16 v28, v226, s72, v28
    v_dot2_f32_bf16 v29, v226, v226, v29
    v_dot2_f32_bf16 v30, v227, s72, v30
    v_dot2_f32_bf16 v31, v227, v227, v31
    s_add_u32 s61, s61, 27648
    buffer_load_dwordx4 v7, s[12:15], s61 offen offset:2048 lds
    v_dot2_f32_bf16 v28, v228, s72, v28
    v_dot2_f32_bf16 v29, v228, v228, v29
    v_dot2_f32_bf16 v30, v229, s72, v30
    v_dot2_f32_bf16 v31, v229, v229, v31
    s_add_u32 s61, s61, 27648
    buffer_load_dwordx4 v7, s[12:15], s61 offen offset:3072 lds
    v_dot2_f32_bf16 v28, v230, s72, v28
    v_dot2_f32_bf16 v29, v230, v230, v29
    v_dot2_f32_bf16 v30, v231, s72, v30
    v_dot2_f32_bf16 v31, v231, v231, v31
    v_dot2_f32_bf16 v28, v232, s72, v28
    v_dot2_f32_bf16 v29, v232, v232, v29
    v_dot2_f32_bf16 v30, v233, s72, v30
    v_dot2_f32_bf16 v31, v233, v233, v31
    v_dot2_f32_bf16 v28, v234, s72, v28
    v_dot2_f32_bf16 v29, v234, v234, v29
    v_dot2_f32_bf16 v30, v235, s72, v30
    v_dot2_f32_bf16 v31, v235, v235, v31
    v_dot2_f32_bf16 v28, v236, s72, v28
    v_dot2_f32_bf16 v29, v236, v236, v29
    s_nop 0
L_pad_P_18:
    s_cbranch_execz L_ret_P
    v_dot2_f32_bf16 v30, v237, s72, v30
    v_dot2_f32_bf16 v31, v237, v237, v31
    v_dot2_f32_bf16 v28, v238, s72, v28
    v_dot2_f32_bf16 v29, v238, v238, v29
    v_dot2_f32_bf16 v30, v239, s72, v30
    v_dot2_f32_bf16 v31, v239, v239, v31
    s_waitcnt lgkmcnt(0)
    v_dot2_f32_bf16 v28, v240, s72, v28
    v_dot2_f32_bf16 v29, v240, v240, v29
    v_dot2_f32_bf16 v30, v241, s72, v30
    v_dot2_f32_bf16 v31, v241, v241, v31
    v_dot2_f32_bf16 v28, v242, s72, v28
    v_dot2_f32_bf16 v29, v242, v242, v29
    v_dot2_f32_bf16 v30, v243, s72, v30
    v_dot2_f32_bf16 v31, v243, v243, v31
    v_dot2_f32_bf16 v28, v244, s72, v28
    v_dot2_f32_bf16 v29, v244, v244, v29
    v_dot2_f32_bf16 v30, v245, s72, v30
    v_dot2_f32_bf16 v31, v245, v245, v31
    v_dot2_f32_bf16 v28, v246, s72, v28
    v_dot2_f32_bf16 v29, v246, v246, v29
    v_dot2_f32_bf16 v30, v247, s72, v30
    v_dot2_f32_bf16 v31, v247, v247, v31
    v_dot2_f32_bf16 v28, v248, s72, v28
    v_dot2_f32_bf16 v29, v248, v248, v29
    v_dot2_f32_bf16 v30, v249, s72, v30
    v_dot2_f32_bf16 v31, v249, v249, v31
    v_dot2_f32_bf16 v28, v250, s72, v28
    v_dot2_f32_bf16 v29, v250, v250, v29
    v_dot2_f32_bf16 v30, v251, s72, v30
    v_dot2_f32_bf16 v31, v251, v251, v31
    v_dot2_f32_bf16 v28, v252, s72, v28
L_pad_P_19:
    s_cbranch_execz L_ret_P
    v_dot2_f32_bf16 v29, v252, v252, v29
    v_dot2_f32_bf16 v30, v253, s72, v30
    v_dot2_f32_bf16 v31, v253, v253, v31
    v_dot2_f32_bf16 v28, v254, s72, v28
    v_dot2_f32_bf16 v29, v254, v254, v29
    v_dot2_f32_bf16 v30, v255, s72, v30
    v_dot2_f32_bf16 v31, v255, v255, v31
    s_nop 2
    v_add_f32 v28, v28, v30
    v_add_f32 v29, v29, v31
    v_mov_b32 v32, v28
    v_mov_b32 v33, v29
    s_nop 1
    v_permlane32_swap_b32 v28, v32
    v_permlane32_swap_b32 v29, v33
    s_nop 1
    v_add_f32 v28, v28, v32
    v_add_f32 v29, v29, v33
    v_mul_f32 v28, 0x3b000000, v28
    v_mul_f32 v29, 0x3b000000, v29
    v_fma_f32 v29, -v28, v28, v29
    v_max_f32 v29, 0, v29
    v_cvt_pk_bf16_f32 v29, v29, v29
    v_lshlrev_b32 v29, 16, v29
    v_cvt_pk_bf16_f32 v28, v28, v28
    v_lshlrev_b32 v28, 16, v28
    v_sub_f32 v112, 0, v28
    v_sub_f32 v113, 0, v28
    v_sub_f32 v114, 0, v28
    v_sub_f32 v115, 0, v28
    v_sub_f32 v116, 0, v28
    v_sub_f32 v117, 0, v28
    v_sub_f32 v118, 0, v28
    v_sub_f32 v119, 0, v28
    v_sub_f32 v120, 0, v28
    v_sub_f32 v121, 0, v28
    v_sub_f32 v122, 0, v28
    v_sub_f32 v123, 0, v28
    v_sub_f32 v124, 0, v28
    v_sub_f32 v125, 0, v28
    v_sub_f32 v126, 0, v28
    v_sub_f32 v127, 0, v28
    v_add_f32 v29, 0x3727c5ac, v29
    v_cvt_pk_bf16_f32 v29, v29, v29
    v_lshlrev_b32 v29, 16, v29
    v_sqrt_f32 v29, v29
    s_nop 0
    v_cvt_pk_bf16_f32 v29, v29, v29
L_pad_P_20:
    s_cbranch_execz L_ret_P
    v_lshlrev_b32 v29, 16, v29
    v_rcp_f32 v30, v29
    s_nop 0
    v_mul_f32 v31, -v28, v30
    v_and_b32 v32, 31, v1
    v_mul_u32_u24 v32, 3584, v32
    s_mul_i32 s61, s65, 114688
    s_add_u32 s61, s61, s73
    s_add_u32 s61, s61, s77
    buffer_load_dword v0, v32, s[12:15], s61 offen
    s_bitcmp1_b32 s58, 0
    s_cbranch_scc1 L_nost
    s_lshl_b32 s62, s58, 13
    v_lshlrev_b32 v32, 3, v1
    s_lshr_b32 s61, s63, 7
    s_add_u32 s61, s61, 11534336
    s_add_u32 s61, s61, s62
    s_mov_b64 exec, 0xffffffff
    buffer_store_dwordx2 v[30:31], v32, s[16:19], s61 offen sc1
    s_mov_b64 exec, -1
L_nost:
    v_lshrrev_b32 v33, 16, v29
    v_cmp_gt_u32 vcc, 32, v1
    v_cndmask_b32 v33, 0, v33, vcc
    v_accvgpr_write_b32 a244, v33
    v_mfma_f32_32x32x16_bf16 v[96:111], a[208:211], v[128:131], v[112:127]
    v_mfma_f32_32x32x16_bf16 v[96:111], a[212:215], v[132:135], v[96:111]
    s_nop 15
    v_cvt_pk_bf16_f32 v128, v96, v97
    v_cvt_pk_bf16_f32 v129, v98, v99
    v_cvt_pk_bf16_f32 v130, v100, v101
    v_cvt_pk_bf16_f32 v131, v102, v103
    v_cvt_pk_bf16_f32 v132, v104, v105
    v_cvt_pk_bf16_f32 v133, v106, v107
    v_cvt_pk_bf16_f32 v134, v108, v109
    v_cvt_pk_bf16_f32 v135, v110, v111
R_F0:
    s_waitcnt vmcnt(9)
    s_barrier
    s_cmp_lg_u32 s56, 0
    s_cbranch_scc1 L_fl848
    s_and_b32 s61, s58, 1
    s_lshl_b32 s61, s61, 3
    s_lshl_b32 s61, 64, s61
    s_lshr_b32 s62, s58, 1
    s_lshl2_add_u32 s62, s57, s62
    s_lshl_b32 s62, s62, 2
L_pad_P_21:
    s_cbranch_execz L_ret_P
    v_mov_b32 v39, s61
    s_mov_b64 exec, 1
    buffer_atomic_add v39, off, s[36:39], s62 sc1
    s_mov_b64 exec, -1
L_fl848:
    v_add_u32 v20, 131072, v18
    v_add_u32 v21, 131072, v19
    ds_read_b64_tr_b16 v[40:41], v20 offset:0
    ds_read_b64_tr_b16 v[42:43], v20 offset:512
    ds_read_b64_tr_b16 v[44:45], v21 offset:0
    ds_read_b64_tr_b16 v[46:47], v21 offset:512
    ds_read_b64_tr_b16 v[48:49], v20 offset:2048
    ds_read_b64_tr_b16 v[50:51], v20 offset:2560
    ds_read_b64_tr_b16 v[52:53], v21 offset:2048
    ds_read_b64_tr_b16 v[54:55], v21 offset:2560
    s_waitcnt lgkmcnt(4)
    v_mfma_f32_32x32x16_bf16 v[96:111], a[208:211], v[136:139], v[112:127]
    ds_read_b64_tr_b16 v[56:57], v20 offset:4096
    v_mfma_f32_32x32x16_bf16 v[96:111], a[212:215], v[140:143], v[96:111]
    ds_read_b64_tr_b16 v[58:59], v20 offset:4608
    s_add_u32 m0, s60, 16384
    s_add_u32 s61, s3, 6
    s_and_b32 s61, s61, 7
    s_mul_i32 s61, s61, 229376
    s_add_u32 s61, s61, s4
    s_add_u32 s61, s61, s74
    buffer_load_dwordx4 v7, s[12:15], s61 offen offset:0 lds
    v_mfma_f32_32x32x16_bf16 v[64:79], a[224:227], a[244:247], 0
    ds_read_b64_tr_b16 v[60:61], v21 offset:4096
    v_mfma_f32_32x32x16_bf16 v[80:95], a[226:229], a[244:247], 0
    ds_read_b64_tr_b16 v[62:63], v21 offset:4608
    s_add_u32 s61, s61, 27648
    buffer_load_dwordx4 v7, s[12:15], s61 offen offset:1024 lds
    v_mfma_f32_32x32x16_bf16 v[64:79], v[40:43], v[128:131], v[64:79]
    v_mfma_f32_32x32x16_bf16 v[80:95], v[44:47], v[128:131], v[80:95]
    v_cvt_pk_bf16_f32 v136, v96, v97
    s_nop 0
L_pad_P_22:
    s_cbranch_execz L_ret_P
    v_cvt_pk_bf16_f32 v137, v98, v99
    v_cvt_pk_bf16_f32 v138, v100, v101
    v_cvt_pk_bf16_f32 v139, v102, v103
    s_add_u32 s61, s61, 27648
    buffer_load_dwordx4 v7, s[12:15], s61 offen offset:2048 lds
    s_waitcnt lgkmcnt(4)
    v_mfma_f32_32x32x16_bf16 v[64:79], v[48:51], v[132:135], v[64:79]
    v_cvt_pk_bf16_f32 v140, v104, v105
    v_cvt_pk_bf16_f32 v141, v106, v107
    v_cvt_pk_bf16_f32 v142, v108, v109
    v_cvt_pk_bf16_f32 v143, v110, v111
    ds_read_b64_tr_b16 v[40:41], v20 offset:6144
    ds_read_b64_tr_b16 v[42:43], v20 offset:6656
    v_mfma_f32_32x32x16_bf16 v[80:95], v[52:55], v[132:135], v[80:95]
    ds_read_b64_tr_b16 v[44:45], v21 offset:6144
    ds_read_b64_tr_b16 v[46:47], v21 offset:6656
    s_add_u32 s61, s61, 27648
    buffer_load_dwordx4 v7, s[12:15], s61 offen offset:3072 lds
    s_waitcnt lgkmcnt(4)
    v_mfma_f32_32x32x16_bf16 v[96:111], a[208:211], v[144:147], v[112:127]
    ds_read_b64_tr_b16 v[48:49], v20 offset:8192
    v_mfma_f32_32x32x16_bf16 v[96:111], a[212:215], v[148:151], v[96:111]
    ds_read_b64_tr_b16 v[50:51], v20 offset:8704
    s_add_u32 m0, s60, 32768
    s_lshl_b32 s61, s74, 9
    s_add_u32 s61, s61, s68
    s_add_u32 s61, s61, s69
    buffer_load_dwordx4 v9, s[20:23], s61 offen offset:0 lds
    v_mfma_f32_32x32x16_bf16 v[64:79], v[56:59], v[136:139], v[64:79]
    ds_read_b64_tr_b16 v[52:53], v21 offset:8192
    v_mfma_f32_32x32x16_bf16 v[80:95], v[60:63], v[136:139], v[80:95]
    v_cvt_pk_bf16_f32 v144, v96, v97
    v_cvt_pk_bf16_f32 v145, v98, v99
    v_cvt_pk_bf16_f32 v146, v100, v101
L_pad_P_23:
    s_cbranch_execz L_ret_P
    v_cvt_pk_bf16_f32 v147, v102, v103
    ds_read_b64_tr_b16 v[54:55], v21 offset:8704
    s_add_u32 s61, s61, 7168
    buffer_load_dwordx4 v9, s[20:23], s61 offen offset:1024 lds
    s_waitcnt lgkmcnt(4)
    v_mfma_f32_32x32x16_bf16 v[64:79], v[40:43], v[140:143], v[64:79]
    v_cvt_pk_bf16_f32 v148, v104, v105
    v_cvt_pk_bf16_f32 v149, v106, v107
    v_cvt_pk_bf16_f32 v150, v108, v109
    v_cvt_pk_bf16_f32 v151, v110, v111
    ds_read_b64_tr_b16 v[56:57], v20 offset:10240
    ds_read_b64_tr_b16 v[58:59], v20 offset:10752
    v_mfma_f32_32x32x16_bf16 v[80:95], v[44:47], v[140:143], v[80:95]
    ds_read_b64_tr_b16 v[60:61], v21 offset:10240
    ds_read_b64_tr_b16 v[62:63], v21 offset:10752
    s_add_u32 s61, s61, 7168
    buffer_load_dwordx4 v9, s[20:23], s61 offen offset:2048 lds
    s_waitcnt lgkmcnt(4)
    v_mfma_f32_32x32x16_bf16 v[96:111], a[208:211], v[152:155], v[112:127]
    ds_read_b64_tr_b16 v[40:41], v20 offset:12288
    v_mfma_f32_32x32x16_bf16 v[96:111], a[212:215], v[156:159], v[96:111]
    ds_read_b64_tr_b16 v[42:43], v20 offset:12800
    s_add_u32 s61, s61, 7168
    buffer_load_dwordx4 v9, s[20:23], s61 offen offset:3072 lds
    v_mfma_f32_32x32x16_bf16 v[64:79], v[48:51], v[144:147], v[64:79]
    ds_read_b64_tr_b16 v[44:45], v21 offset:12288
    v_mfma_f32_32x32x16_bf16 v[80:95], v[52:55], v[144:147], v[80:95]
    v_cvt_pk_bf16_f32 v152, v96, v97
    v_cvt_pk_bf16_f32 v153, v98, v99
    v_cvt_pk_bf16_f32 v154, v100, v101
    v_cvt_pk_bf16_f32 v155, v102, v103
    ds_read_b64_tr_b16 v[46:47], v21 offset:12800
    s_waitcnt lgkmcnt(4)
L_pad_P_24:
    s_cbranch_execz L_ret_P
    v_mfma_f32_32x32x16_bf16 v[64:79], v[56:59], v[148:151], v[64:79]
    v_cvt_pk_bf16_f32 v156, v104, v105
    v_cvt_pk_bf16_f32 v157, v106, v107
    v_cvt_pk_bf16_f32 v158, v108, v109
    v_cvt_pk_bf16_f32 v159, v110, v111
    ds_read_b64_tr_b16 v[48:49], v20 offset:14336
    ds_read_b64_tr_b16 v[50:51], v20 offset:14848
    v_mfma_f32_32x32x16_bf16 v[80:95], v[60:63], v[148:151], v[80:95]
    ds_read_b64_tr_b16 v[52:53], v21 offset:14336
    ds_read_b64_tr_b16 v[54:55], v21 offset:14848
    s_waitcnt lgkmcnt(4)
    v_mfma_f32_32x32x16_bf16 v[96:111], a[208:211], v[160:163], v[112:127]
    s_waitcnt vmcnt(13)
    s_barrier
    ds_read_b64_tr_b16 v[56:57], v20 offset:16384
    v_mfma_f32_32x32x16_bf16 v[96:111], a[212:215], v[164:167], v[96:111]
    ds_read_b64_tr_b16 v[58:59], v20 offset:16896
    s_add_u32 m0, s60, 49152
    s_add_u32 s61, s3, 0
    s_and_b32 s61, s61, 7
    s_mul_i32 s61, s61, 229376
    s_add_u32 s61, s61, s4
    s_add_u32 s61, s61, s75
    buffer_load_dwordx4 v7, s[12:15], s61 offen offset:0 lds
    v_mfma_f32_32x32x16_bf16 v[64:79], v[40:43], v[152:155], v[64:79]
    ds_read_b64_tr_b16 v[60:61], v21 offset:16384
    v_mfma_f32_32x32x16_bf16 v[80:95], v[44:47], v[152:155], v[80:95]
    v_cvt_pk_bf16_f32 v160, v96, v97
    v_cvt_pk_bf16_f32 v161, v98, v99
    v_cvt_pk_bf16_f32 v162, v100, v101
    v_cvt_pk_bf16_f32 v163, v102, v103
    ds_read_b64_tr_b16 v[62:63], v21 offset:16896
    s_add_u32 s61, s61, 27648
    buffer_load_dwordx4 v7, s[12:15], s61 offen offset:1024 lds
    s_waitcnt lgkmcnt(4)
    s_nop 0
L_pad_P_25:
    s_cbranch_execz L_ret_P
    v_mfma_f32_32x32x16_bf16 v[64:79], v[48:51], v[156:159], v[64:79]
    v_cvt_pk_bf16_f32 v164, v104, v105
    v_cvt_pk_bf16_f32 v165, v106, v107
    v_cvt_pk_bf16_f32 v166, v108, v109
    v_cvt_pk_bf16_f32 v167, v110, v111
    ds_read_b64_tr_b16 v[40:41], v20 offset:18432
    ds_read_b64_tr_b16 v[42:43], v20 offset:18944
    v_mfma_f32_32x32x16_bf16 v[80:95], v[52:55], v[156:159], v[80:95]
    ds_read_b64_tr_b16 v[44:45], v21 offset:18432
    ds_read_b64_tr_b16 v[46:47], v21 offset:18944
    s_add_u32 s61, s61, 27648
    buffer_load_dwordx4 v7, s[12:15], s61 offen offset:2048 lds
    s_waitcnt lgkmcnt(4)
    v_mfma_f32_32x32x16_bf16 v[96:111], a[208:211], v[168:171], v[112:127]
    ds_read_b64_tr_b16 v[48:49], v20 offset:20480
    v_mfma_f32_32x32x16_bf16 v[96:111], a[212:215], v[172:175], v[96:111]
    ds_read_b64_tr_b16 v[50:51], v20 offset:20992
    s_add_u32 s61, s61, 27648
    buffer_load_dwordx4 v7, s[12:15], s61 offen offset:3072 lds
    v_mfma_f32_32x32x16_bf16 v[64:79], v[56:59], v[160:163], v[64:79]
    ds_read_b64_tr_b16 v[52:53], v21 offset:20480
    v_mfma_f32_32x32x16_bf16 v[80:95], v[60:63], v[160:163], v[80:95]
    v_cvt_pk_bf16_f32 v168, v96, v97
    v_cvt_pk_bf16_f32 v169, v98, v99
    v_cvt_pk_bf16_f32 v170, v100, v101
    v_cvt_pk_bf16_f32 v171, v102, v103
    ds_read_b64_tr_b16 v[54:55], v21 offset:20992
    s_add_u32 m0, s60, 65536
    s_lshl_b32 s61, s75, 9
    s_add_u32 s61, s61, s68
    s_add_u32 s61, s61, s69
    buffer_load_dwordx4 v9, s[20:23], s61 offen offset:0 lds
    s_waitcnt lgkmcnt(4)
    v_mfma_f32_32x32x16_bf16 v[64:79], v[40:43], v[164:167], v[64:79]
L_pad_P_26:
    s_cbranch_execz L_ret_P
    v_cvt_pk_bf16_f32 v172, v104, v105
    v_cvt_pk_bf16_f32 v173, v106, v107
    v_cvt_pk_bf16_f32 v174, v108, v109
    v_cvt_pk_bf16_f32 v175, v110, v111
    ds_read_b64_tr_b16 v[56:57], v20 offset:22528
    ds_read_b64_tr_b16 v[58:59], v20 offset:23040
    v_mfma_f32_32x32x16_bf16 v[80:95], v[44:47], v[164:167], v[80:95]
    ds_read_b64_tr_b16 v[60:61], v21 offset:22528
    ds_read_b64_tr_b16 v[62:63], v21 offset:23040
    s_add_u32 s61, s61, 7168
    buffer_load_dwordx4 v9, s[20:23], s61 offen offset:1024 lds
    s_waitcnt lgkmcnt(4)
    v_mfma_f32_32x32x16_bf16 v[96:111], a[208:211], v[176:179], v[112:127]
    ds_read_b64_tr_b16 v[40:41], v20 offset:24576
    v_mfma_f32_32x32x16_bf16 v[96:111], a[212:215], v[180:183], v[96:111]
    ds_read_b64_tr_b16 v[42:43], v20 offset:25088
    s_add_u32 s61, s61, 7168
    buffer_load_dwordx4 v9, s[20:23], s61 offen offset:2048 lds
    v_mfma_f32_32x32x16_bf16 v[64:79], v[48:51], v[168:171], v[64:79]
    ds_read_b64_tr_b16 v[44:45], v21 offset:24576
    v_mfma_f32_32x32x16_bf16 v[80:95], v[52:55], v[168:171], v[80:95]
    v_cvt_pk_bf16_f32 v176, v96, v97
    v_cvt_pk_bf16_f32 v177, v98, v99
    v_cvt_pk_bf16_f32 v178, v100, v101
    v_cvt_pk_bf16_f32 v179, v102, v103
    ds_read_b64_tr_b16 v[46:47], v21 offset:25088
    s_add_u32 s61, s61, 7168
    buffer_load_dwordx4 v9, s[20:23], s61 offen offset:3072 lds
    s_waitcnt lgkmcnt(4)
    v_mfma_f32_32x32x16_bf16 v[64:79], v[56:59], v[172:175], v[64:79]
    v_cvt_pk_bf16_f32 v180, v104, v105
    v_cvt_pk_bf16_f32 v181, v106, v107
    s_nop 0
L_pad_P_27:
    s_cbranch_execz L_ret_P
    v_cvt_pk_bf16_f32 v182, v108, v109
    v_cvt_pk_bf16_f32 v183, v110, v111
    ds_read_b64_tr_b16 v[48:49], v20 offset:26624
    ds_read_b64_tr_b16 v[50:51], v20 offset:27136
    v_mfma_f32_32x32x16_bf16 v[80:95], v[60:63], v[172:175], v[80:95]
    ds_read_b64_tr_b16 v[52:53], v21 offset:26624
    ds_read_b64_tr_b16 v[54:55], v21 offset:27136
    s_waitcnt lgkmcnt(4)
    v_mfma_f32_32x32x16_bf16 v[96:111], a[208:211], v[184:187], v[112:127]
    ds_read_b64_tr_b16 v[56:57], v20 offset:28672
    v_mfma_f32_32x32x16_bf16 v[96:111], a[212:215], v[188:191], v[96:111]
    ds_read_b64_tr_b16 v[58:59], v20 offset:29184
    v_mfma_f32_32x32x16_bf16 v[64:79], v[40:43], v[176:179], v[64:79]
    ds_read_b64_tr_b16 v[60:61], v21 offset:28672
    v_mfma_f32_32x32x16_bf16 v[80:95], v[44:47], v[176:179], v[80:95]
    v_cvt_pk_bf16_f32 v184, v96, v97
    v_cvt_pk_bf16_f32 v185, v98, v99
    v_cvt_pk_bf16_f32 v186, v100, v101
    v_cvt_pk_bf16_f32 v187, v102, v103
    ds_read_b64_tr_b16 v[62:63], v21 offset:29184
    s_waitcnt lgkmcnt(4)
    v_mfma_f32_32x32x16_bf16 v[64:79], v[48:51], v[180:183], v[64:79]
    v_cvt_pk_bf16_f32 v188, v104, v105
    v_cvt_pk_bf16_f32 v189, v106, v107
    v_cvt_pk_bf16_f32 v190, v108, v109
    v_cvt_pk_bf16_f32 v191, v110, v111
    ds_read_b64_tr_b16 v[40:41], v20 offset:30720
    ds_read_b64_tr_b16 v[42:43], v20 offset:31232
    v_mfma_f32_32x32x16_bf16 v[80:95], v[52:55], v[180:183], v[80:95]
    ds_read_b64_tr_b16 v[44:45], v21 offset:30720
    ds_read_b64_tr_b16 v[46:47], v21 offset:31232
    s_waitcnt lgkmcnt(4)
    v_mfma_f32_32x32x16_bf16 v[96:111], a[208:211], v[192:195], v[112:127]
L_pad_P_28:
    s_cbranch_execz L_ret_P
    s_waitcnt vmcnt(17)
    s_barrier
    ds_read_b64_tr_b16 v[48:49], v18 offset:0
    v_mfma_f32_32x32x16_bf16 v[96:111], a[212:215], v[196:199], v[96:111]
    ds_read_b64_tr_b16 v[50:51], v18 offset:512
    s_add_u32 m0, s60, 81920
    s_add_u32 s61, s3, 2
    s_and_b32 s61, s61, 7
    s_mul_i32 s61, s61, 229376
    s_add_u32 s61, s61, s4
    s_add_u32 s61, s61, s75
    buffer_load_dwordx4 v7, s[12:15], s61 offen offset:0 lds
    v_mfma_f32_32x32x16_bf16 v[64:79], v[56:59], v[184:187], v[64:79]
    ds_read_b64_tr_b16 v[52:53], v19 offset:0
    v_mfma_f32_32x32x16_bf16 v[80:95], v[60:63], v[184:187], v[80:95]
    v_cvt_pk_bf16_f32 v192, v96, v97
    v_cvt_pk_bf16_f32 v193, v98, v99
    v_cvt_pk_bf16_f32 v194, v100, v101
    v_cvt_pk_bf16_f32 v195, v102, v103
    ds_read_b64_tr_b16 v[54:55], v19 offset:512
    s_add_u32 s61, s61, 27648
    buffer_load_dwordx4 v7, s[12:15], s61 offen offset:1024 lds
    s_waitcnt lgkmcnt(4)
    v_mfma_f32_32x32x16_bf16 v[64:79], v[40:43], v[188:191], v[64:79]
    v_cvt_pk_bf16_f32 v196, v104, v105
    v_cvt_pk_bf16_f32 v197, v106, v107
    v_cvt_pk_bf16_f32 v198, v108, v109
    v_cvt_pk_bf16_f32 v199, v110, v111
    ds_read_b64_tr_b16 v[56:57], v18 offset:2048
    ds_read_b64_tr_b16 v[58:59], v18 offset:2560
    v_mfma_f32_32x32x16_bf16 v[80:95], v[44:47], v[188:191], v[80:95]
    ds_read_b64_tr_b16 v[60:61], v19 offset:2048
    ds_read_b64_tr_b16 v[62:63], v19 offset:2560
    s_add_u32 s61, s61, 27648
    buffer_load_dwordx4 v7, s[12:15], s61 offen offset:2048 lds
L_pad_P_29:
    s_cbranch_execz L_ret_P
    s_waitcnt lgkmcnt(4)
    v_mfma_f32_32x32x16_bf16 v[96:111], a[208:211], v[200:203], v[112:127]
    ds_read_b64_tr_b16 v[40:41], v18 offset:4096
    v_mfma_f32_32x32x16_bf16 v[96:111], a[212:215], v[204:207], v[96:111]
    ds_read_b64_tr_b16 v[42:43], v18 offset:4608
    s_add_u32 s61, s61, 27648
    buffer_load_dwordx4 v7, s[12:15], s61 offen offset:3072 lds
    v_mfma_f32_32x32x16_bf16 v[64:79], v[48:51], v[192:195], v[64:79]
    ds_read_b64_tr_b16 v[44:45], v19 offset:4096
    v_mfma_f32_32x32x16_bf16 v[80:95], v[52:55], v[192:195], v[80:95]
    v_cvt_pk_bf16_f32 v200, v96, v97
    v_cvt_pk_bf16_f32 v201, v98, v99
    v_cvt_pk_bf16_f32 v202, v100, v101
    v_cvt_pk_bf16_f32 v203, v102, v103
    ds_read_b64_tr_b16 v[46:47], v19 offset:4608
    s_add_u32 m0, s60, 98304
    s_lshl_b32 s61, s76, 9
    s_add_u32 s61, s61, s68
    s_add_u32 s61, s61, s69
    buffer_load_dwordx4 v9, s[20:23], s61 offen offset:0 lds
    s_waitcnt lgkmcnt(4)
    v_mfma_f32_32x32x16_bf16 v[64:79], v[56:59], v[196:199], v[64:79]
    v_cvt_pk_bf16_f32 v204, v104, v105
    v_cvt_pk_bf16_f32 v205, v106, v107
    v_cvt_pk_bf16_f32 v206, v108, v109
    v_cvt_pk_bf16_f32 v207, v110, v111
    ds_read_b64_tr_b16 v[48:49], v18 offset:6144
    ds_read_b64_tr_b16 v[50:51], v18 offset:6656
    v_mfma_f32_32x32x16_bf16 v[80:95], v[60:63], v[196:199], v[80:95]
    ds_read_b64_tr_b16 v[52:53], v19 offset:6144
    ds_read_b64_tr_b16 v[54:55], v19 offset:6656
    s_add_u32 s61, s61, 7168
    buffer_load_dwordx4 v9, s[20:23], s61 offen offset:1024 lds
    s_waitcnt lgkmcnt(4)
    s_nop 0
L_pad_P_30:
    s_cbranch_execz L_ret_P
    v_mfma_f32_32x32x16_bf16 v[96:111], a[208:211], v[208:211], v[112:127]
    ds_read_b64_tr_b16 v[56:57], v18 offset:8192
    v_mfma_f32_32x32x16_bf16 v[96:111], a[212:215], v[212:215], v[96:111]
    ds_read_b64_tr_b16 v[58:59], v18 offset:8704
    s_add_u32 s61, s61, 7168
    buffer_load_dwordx4 v9, s[20:23], s61 offen offset:2048 lds
    v_mfma_f32_32x32x16_bf16 v[64:79], v[40:43], v[200:203], v[64:79]
    ds_read_b64_tr_b16 v[60:61], v19 offset:8192
    v_mfma_f32_32x32x16_bf16 v[80:95], v[44:47], v[200:203], v[80:95]
    v_cvt_pk_bf16_f32 v208, v96, v97
    v_cvt_pk_bf16_f32 v209, v98, v99
    v_cvt_pk_bf16_f32 v210, v100, v101
    v_cvt_pk_bf16_f32 v211, v102, v103
    ds_read_b64_tr_b16 v[62:63], v19 offset:8704
    s_add_u32 s61, s61, 7168
    buffer_load_dwordx4 v9, s[20:23], s61 offen offset:3072 lds
    s_waitcnt lgkmcnt(4)
    v_mfma_f32_32x32x16_bf16 v[64:79], v[48:51], v[204:207], v[64:79]
    v_cvt_pk_bf16_f32 v212, v104, v105
    v_cvt_pk_bf16_f32 v213, v106, v107
    v_cvt_pk_bf16_f32 v214, v108, v109
    v_cvt_pk_bf16_f32 v215, v110, v111
    ds_read_b64_tr_b16 v[40:41], v18 offset:10240
    ds_read_b64_tr_b16 v[42:43], v18 offset:10752
    v_mfma_f32_32x32x16_bf16 v[80:95], v[52:55], v[204:207], v[80:95]
    ds_read_b64_tr_b16 v[44:45], v19 offset:10240
    ds_read_b64_tr_b16 v[46:47], v19 offset:10752
    s_waitcnt lgkmcnt(4)
    v_mfma_f32_32x32x16_bf16 v[96:111], a[208:211], v[216:219], v[112:127]
    ds_read_b64_tr_b16 v[48:49], v18 offset:12288
    v_mfma_f32_32x32x16_bf16 v[96:111], a[212:215], v[220:223], v[96:111]
    ds_read_b64_tr_b16 v[50:51], v18 offset:12800
    s_nop 0
L_pad_P_31:
    s_cbranch_execz L_ret_P
    v_mfma_f32_32x32x16_bf16 v[64:79], v[56:59], v[208:211], v[64:79]
    ds_read_b64_tr_b16 v[52:53], v19 offset:12288
    v_mfma_f32_32x32x16_bf16 v[80:95], v[60:63], v[208:211], v[80:95]
    v_cvt_pk_bf16_f32 v216, v96, v97
    v_cvt_pk_bf16_f32 v217, v98, v99
    v_cvt_pk_bf16_f32 v218, v100, v101
    v_cvt_pk_bf16_f32 v219, v102, v103
    ds_read_b64_tr_b16 v[54:55], v19 offset:12800
    s_waitcnt lgkmcnt(4)
    v_mfma_f32_32x32x16_bf16 v[64:79], v[40:43], v[212:215], v[64:79]
    v_cvt_pk_bf16_f32 v220, v104, v105
    v_cvt_pk_bf16_f32 v221, v106, v107
    v_cvt_pk_bf16_f32 v222, v108, v109
    v_cvt_pk_bf16_f32 v223, v110, v111
    ds_read_b64_tr_b16 v[56:57], v18 offset:14336
    ds_read_b64_tr_b16 v[58:59], v18 offset:14848
    v_mfma_f32_32x32x16_bf16 v[80:95], v[44:47], v[212:215], v[80:95]
    ds_read_b64_tr_b16 v[60:61], v19 offset:14336
    ds_read_b64_tr_b16 v[62:63], v19 offset:14848
    s_waitcnt lgkmcnt(4)
    v_mfma_f32_32x32x16_bf16 v[96:111], a[208:211], v[224:227], v[112:127]
    s_waitcnt vmcnt(16)
    s_barrier
    ds_read_b64_tr_b16 v[40:41], v18 offset:16384
    ds_read_b64_tr_b16 a[0:1], v24 offset:32768
    ds_read_b64_tr_b16 a[2:3], v24 offset:33792
    ds_read_b64_tr_b16 a[4:5], v24 offset:34816
    ds_read_b64_tr_b16 a[6:7], v24 offset:35840
    v_mfma_f32_32x32x16_bf16 v[96:111], a[212:215], v[228:231], v[96:111]
    ds_read_b64_tr_b16 v[42:43], v18 offset:16896
    s_add_u32 m0, s60, 114688
    s_add_u32 s61, s3, 4
    s_and_b32 s61, s61, 7
    s_mul_i32 s61, s61, 229376
    s_add_u32 s61, s61, s4
L_pad_P_32:
    s_cbranch_execz L_ret_P
    s_add_u32 s61, s61, s75
    buffer_load_dwordx4 v7, s[12:15], s61 offen offset:0 lds
    ds_read_b64_tr_b16 a[8:9], v24 offset:40960
    ds_read_b64_tr_b16 a[10:11], v24 offset:41984
    v_mfma_f32_32x32x16_bf16 v[64:79], v[48:51], v[216:219], v[64:79]
    ds_read_b64_tr_b16 v[44:45], v19 offset:16384
    ds_read_b64_tr_b16 a[12:13], v24 offset:43008
    ds_read_b64_tr_b16 a[14:15], v24 offset:44032
    v_mfma_f32_32x32x16_bf16 v[80:95], v[52:55], v[216:219], v[80:95]
    v_cvt_pk_bf16_f32 v224, v96, v97
    v_cvt_pk_bf16_f32 v225, v98, v99
    v_cvt_pk_bf16_f32 v226, v100, v101
    v_cvt_pk_bf16_f32 v227, v102, v103
    ds_read_b64_tr_b16 v[46:47], v19 offset:16896
    s_add_u32 s61, s61, 27648
    buffer_load_dwordx4 v7, s[12:15], s61 offen offset:1024 lds
    s_waitcnt lgkmcnt(12)
    v_mfma_f32_32x32x16_bf16 v[64:79], v[56:59], v[220:223], v[64:79]
    v_cvt_pk_bf16_f32 v228, v104, v105
    v_cvt_pk_bf16_f32 v229, v106, v107
    v_cvt_pk_bf16_f32 v230, v108, v109
    v_cvt_pk_bf16_f32 v231, v110, v111
    ds_read_b64_tr_b16 v[48:49], v18 offset:18432
    ds_read_b64_tr_b16 v[50:51], v18 offset:18944
    v_mfma_f32_32x32x16_bf16 v[80:95], v[60:63], v[220:223], v[80:95]
    ds_read_b64_tr_b16 v[52:53], v19 offset:18432
    ds_read_b64_tr_b16 v[54:55], v19 offset:18944
    s_add_u32 s61, s61, 27648
    buffer_load_dwordx4 v7, s[12:15], s61 offen offset:2048 lds
    s_waitcnt lgkmcnt(4)
    v_mfma_f32_32x32x16_bf16 v[96:111], a[208:211], v[232:235], v[112:127]
    ds_read_b64_tr_b16 v[56:57], v18 offset:20480
    v_mfma_f32_32x32x16_bf16 v[96:111], a[212:215], v[236:239], v[96:111]
L_pad_P_33:
    s_cbranch_execz L_ret_P
    ds_read_b64_tr_b16 v[58:59], v18 offset:20992
    s_add_u32 s61, s61, 27648
    buffer_load_dwordx4 v7, s[12:15], s61 offen offset:3072 lds
    v_mfma_f32_32x32x16_bf16 v[64:79], v[40:43], v[224:227], v[64:79]
    ds_read_b64_tr_b16 v[60:61], v19 offset:20480
    v_mfma_f32_32x32x16_bf16 v[80:95], v[44:47], v[224:227], v[80:95]
    v_cvt_pk_bf16_f32 v232, v96, v97
    v_cvt_pk_bf16_f32 v233, v98, v99
    v_cvt_pk_bf16_f32 v234, v100, v101
    v_cvt_pk_bf16_f32 v235, v102, v103
    ds_read_b64_tr_b16 v[62:63], v19 offset:20992
    s_add_u32 m0, s60, 131072
    s_lshl_b32 s61, s77, 9
    s_xor_b32 s61, s61, s68
    s_add_u32 s61, s61, s69
    buffer_load_dwordx4 v9, s[20:23], s61 offen offset:0 lds
    s_waitcnt lgkmcnt(4)
    v_mfma_f32_32x32x16_bf16 v[64:79], v[48:51], v[228:231], v[64:79]
    v_cvt_pk_bf16_f32 v236, v104, v105
    v_cvt_pk_bf16_f32 v237, v106, v107
    v_cvt_pk_bf16_f32 v238, v108, v109
    v_cvt_pk_bf16_f32 v239, v110, v111
    ds_read_b64_tr_b16 v[40:41], v18 offset:22528
    ds_read_b64_tr_b16 v[42:43], v18 offset:23040
    v_mfma_f32_32x32x16_bf16 v[80:95], v[52:55], v[228:231], v[80:95]
    ds_read_b64_tr_b16 v[44:45], v19 offset:22528
    ds_read_b64_tr_b16 v[46:47], v19 offset:23040
    s_add_u32 s61, s61, 7168
    buffer_load_dwordx4 v9, s[20:23], s61 offen offset:1024 lds
    s_waitcnt lgkmcnt(4)
    v_mfma_f32_32x32x16_bf16 v[96:111], a[208:211], v[240:243], v[112:127]
    ds_read_b64_tr_b16 v[48:49], v18 offset:24576
    v_mfma_f32_32x32x16_bf16 v[96:111], a[212:215], v[244:247], v[96:111]
    ds_read_b64_tr_b16 v[50:51], v18 offset:25088
L_pad_P_34:
    s_cbranch_execz L_ret_P
    s_add_u32 s61, s61, 7168
    buffer_load_dwordx4 v9, s[20:23], s61 offen offset:2048 lds
    v_mfma_f32_32x32x16_bf16 v[64:79], v[56:59], v[232:235], v[64:79]
    ds_read_b64_tr_b16 v[52:53], v19 offset:24576
    v_mfma_f32_32x32x16_bf16 v[80:95], v[60:63], v[232:235], v[80:95]
    v_cvt_pk_bf16_f32 v240, v96, v97
    v_cvt_pk_bf16_f32 v241, v98, v99
    v_cvt_pk_bf16_f32 v242, v100, v101
    v_cvt_pk_bf16_f32 v243, v102, v103
    ds_read_b64_tr_b16 v[54:55], v19 offset:25088
    s_add_u32 s61, s61, 7168
    buffer_load_dwordx4 v9, s[20:23], s61 offen offset:3072 lds
    s_waitcnt lgkmcnt(4)
    v_mfma_f32_32x32x16_bf16 v[64:79], v[40:43], v[236:239], v[64:79]
    v_cvt_pk_bf16_f32 v244, v104, v105
    v_cvt_pk_bf16_f32 v245, v106, v107
    v_cvt_pk_bf16_f32 v246, v108, v109
    v_cvt_pk_bf16_f32 v247, v110, v111
    ds_read_b64_tr_b16 v[56:57], v18 offset:26624
    ds_read_b64_tr_b16 v[58:59], v18 offset:27136
    v_mfma_f32_32x32x16_bf16 v[80:95], v[44:47], v[236:239], v[80:95]
    ds_read_b64_tr_b16 v[60:61], v19 offset:26624
    ds_read_b64_tr_b16 v[62:63], v19 offset:27136
    s_waitcnt lgkmcnt(4)
    v_mfma_f32_32x32x16_bf16 v[96:111], a[208:211], v[248:251], v[112:127]
    ds_read_b64_tr_b16 v[40:41], v18 offset:28672
    v_mfma_f32_32x32x16_bf16 v[96:111], a[212:215], v[252:255], v[96:111]
    ds_read_b64_tr_b16 v[42:43], v18 offset:29184
    v_mfma_f32_32x32x16_bf16 v[64:79], v[48:51], v[240:243], v[64:79]
    ds_read_b64_tr_b16 v[44:45], v19 offset:28672
    v_mfma_f32_32x32x16_bf16 v[80:95], v[52:55], v[240:243], v[80:95]
    v_cvt_pk_bf16_f32 v248, v96, v97
    s_nop 0
L_pad_P_35:
    s_cbranch_execz L_ret_P
    v_cvt_pk_bf16_f32 v249, v98, v99
    v_cvt_pk_bf16_f32 v250, v100, v101
    v_cvt_pk_bf16_f32 v251, v102, v103
    ds_read_b64_tr_b16 v[46:47], v19 offset:29184
    s_waitcnt lgkmcnt(4)
    v_mfma_f32_32x32x16_bf16 v[64:79], v[56:59], v[244:247], v[64:79]
    v_cvt_pk_bf16_f32 v252, v104, v105
    v_cvt_pk_bf16_f32 v253, v106, v107
    v_cvt_pk_bf16_f32 v254, v108, v109
    v_cvt_pk_bf16_f32 v255, v110, v111
    ds_read_b64_tr_b16 v[48:49], v18 offset:30720
    ds_read_b64_tr_b16 v[50:51], v18 offset:31232
    v_mfma_f32_32x32x16_bf16 v[80:95], v[60:63], v[244:247], v[80:95]
    ds_read_b64_tr_b16 v[52:53], v19 offset:30720
    ds_read_b64_tr_b16 v[54:55], v19 offset:31232
    s_waitcnt lgkmcnt(4)
    v_mfma_f32_32x32x16_bf16 v[64:79], v[40:43], v[248:251], v[64:79]
    s_waitcnt vmcnt(16)
    s_barrier
    ds_read_b64_tr_b16 v[56:57], v18 offset:49152
    ds_read_b64_tr_b16 v[58:59], v18 offset:49664
    v_add_u32 v26, 65536, v24
    ds_read_b64_tr_b16 a[16:17], v26 offset:0
    ds_read_b64_tr_b16 a[18:19], v26 offset:1024
    ds_read_b64_tr_b16 a[20:21], v26 offset:2048
    ds_read_b64_tr_b16 a[22:23], v26 offset:3072
    v_mfma_f32_32x32x16_bf16 v[80:95], v[44:47], v[248:251], v[80:95]
    ds_read_b64_tr_b16 v[60:61], v19 offset:49152
    ds_read_b64_tr_b16 v[62:63], v19 offset:49664
    s_add_u32 m0, s60, 32768
    s_add_u32 s61, s3, 6
    s_and_b32 s61, s61, 7
    s_mul_i32 s61, s61, 229376
    s_add_u32 s61, s61, s4
    s_add_u32 s61, s61, s75
    s_nop 0
L_pad_P_36:
    s_cbranch_execz L_ret_P
    buffer_load_dwordx4 v7, s[12:15], s61 offen offset:0 lds
    ds_read_b64_tr_b16 a[24:25], v26 offset:8192
    ds_read_b64_tr_b16 a[26:27], v26 offset:9216
    s_waitcnt lgkmcnt(10)
    v_mfma_f32_32x32x16_bf16 v[64:79], v[48:51], v[252:255], v[64:79]
    ds_read_b64_tr_b16 v[40:41], v18 offset:51200
    ds_read_b64_tr_b16 v[42:43], v18 offset:51712
    ds_read_b64_tr_b16 a[28:29], v26 offset:10240
    ds_read_b64_tr_b16 a[30:31], v26 offset:11264
    v_mfma_f32_32x32x16_bf16 v[80:95], v[52:55], v[252:255], v[80:95]
    ds_read_b64_tr_b16 v[44:45], v19 offset:51200
    ds_read_b64_tr_b16 v[46:47], v19 offset:51712
    s_add_u32 s61, s61, 27648
    buffer_load_dwordx4 v7, s[12:15], s61 offen offset:1024 lds
    s_waitcnt lgkmcnt(8)
    v_mfma_f32_32x32x16_bf16 v[96:111], a[228:231], a[244:247], 0
    ds_read_b64_tr_b16 v[48:49], v18 offset:53248
    v_mfma_f32_32x32x16_bf16 v[112:127], a[230:233], a[244:247], 0
    ds_read_b64_tr_b16 v[50:51], v18 offset:53760
    s_add_u32 s61, s61, 27648
    buffer_load_dwordx4 v7, s[12:15], s61 offen offset:2048 lds
    v_mfma_f32_32x32x16_bf16 v[96:111], v[56:59], v[128:131], v[96:111]
    ds_read_b64_tr_b16 v[52:53], v19 offset:53248
    v_mfma_f32_32x32x16_bf16 v[112:127], v[60:63], v[128:131], v[112:127]
    ds_read_b64_tr_b16 v[54:55], v19 offset:53760
    s_add_u32 s61, s61, 27648
    buffer_load_dwordx4 v7, s[12:15], s61 offen offset:3072 lds
    s_waitcnt lgkmcnt(4)
    v_mfma_f32_32x32x16_bf16 v[96:111], v[40:43], v[132:135], v[96:111]
    ds_read_b64_tr_b16 v[56:57], v18 offset:55296
    ds_read_b64_tr_b16 v[58:59], v18 offset:55808
    v_mfma_f32_32x32x16_bf16 v[112:127], v[44:47], v[132:135], v[112:127]
    ds_read_b64_tr_b16 v[60:61], v19 offset:55296
L_pad_P_37:
    s_cbranch_execz L_ret_P
    ds_read_b64_tr_b16 v[62:63], v19 offset:55808
    s_add_u32 m0, s60, 0
    s_lshl_b32 s61, s74, 9
    s_xor_b32 s61, s61, 262144
    s_add_u32 s61, s61, s68
    s_add_u32 s61, s61, s69
    buffer_load_dwordx4 v9, s[20:23], s61 offen offset:0 lds
    s_waitcnt lgkmcnt(4)
    v_mfma_f32_32x32x16_bf16 v[96:111], v[48:51], v[136:139], v[96:111]
    ds_read_b64_tr_b16 v[40:41], v18 offset:57344
    ds_read_b64_tr_b16 v[42:43], v18 offset:57856
    v_mul_f32 v64, v30, v64
    v_mul_f32 v65, v30, v65
    v_mul_f32 v66, v30, v66
    v_mul_f32 v67, v30, v67
    v_mfma_f32_32x32x16_bf16 v[112:127], v[52:55], v[136:139], v[112:127]
    ds_read_b64_tr_b16 v[44:45], v19 offset:57344
    ds_read_b64_tr_b16 v[46:47], v19 offset:57856
    s_add_u32 s61, s61, 7168
    buffer_load_dwordx4 v9, s[20:23], s61 offen offset:1024 lds
    v_mul_f32 v68, v30, v68
    v_mul_f32 v69, v30, v69
    s_waitcnt lgkmcnt(4)
    v_mfma_f32_32x32x16_bf16 v[96:111], v[56:59], v[140:143], v[96:111]
    ds_read_b64_tr_b16 v[48:49], v18 offset:59392
    ds_read_b64_tr_b16 v[50:51], v18 offset:59904
    v_mul_f32 v70, v30, v70
    v_mul_f32 v71, v30, v71
    v_max_f32 v64, 0, v64
    v_max_f32 v65, 0, v65
    v_mfma_f32_32x32x16_bf16 v[112:127], v[60:63], v[140:143], v[112:127]
    ds_read_b64_tr_b16 v[52:53], v19 offset:59392
    ds_read_b64_tr_b16 v[54:55], v19 offset:59904
    s_add_u32 s61, s61, 7168
    buffer_load_dwordx4 v9, s[20:23], s61 offen offset:2048 lds
    v_max_f32 v66, 0, v66
    v_max_f32 v67, 0, v67
    s_waitcnt lgkmcnt(4)
    v_mfma_f32_32x32x16_bf16 v[96:111], v[40:43], v[144:147], v[96:111]
    ds_read_b64_tr_b16 v[56:57], v18 offset:61440
    ds_read_b64_tr_b16 v[58:59], v18 offset:61952
L_pad_P_38:
    s_cbranch_execz L_ret_P
    v_max_f32 v68, 0, v68
    v_max_f32 v69, 0, v69
    v_max_f32 v70, 0, v70
    v_max_f32 v71, 0, v71
    v_mfma_f32_32x32x16_bf16 v[112:127], v[44:47], v[144:147], v[112:127]
    ds_read_b64_tr_b16 v[60:61], v19 offset:61440
    ds_read_b64_tr_b16 v[62:63], v19 offset:61952
    s_add_u32 s61, s61, 7168
    buffer_load_dwordx4 v9, s[20:23], s61 offen offset:3072 lds
    v_mul_f32 v64, v64, v64
    v_mul_f32 v65, v65, v65
    s_waitcnt lgkmcnt(4)
    v_mfma_f32_32x32x16_bf16 v[96:111], v[48:51], v[148:151], v[96:111]
    ds_read_b64_tr_b16 v[40:41], v18 offset:63488
    ds_read_b64_tr_b16 v[42:43], v18 offset:64000
    v_mul_f32 v66, v66, v66
    v_mul_f32 v67, v67, v67
    v_mul_f32 v68, v68, v68
    v_mul_f32 v69, v69, v69
    v_mfma_f32_32x32x16_bf16 v[112:127], v[52:55], v[148:151], v[112:127]
    ds_read_b64_tr_b16 v[44:45], v19 offset:63488
    ds_read_b64_tr_b16 v[46:47], v19 offset:64000
    v_mul_f32 v70, v70, v70
    v_mul_f32 v71, v71, v71
    v_cvt_pk_bf16_f32 v64, v64, v65
    v_cvt_pk_bf16_f32 v65, v66, v67
    s_waitcnt lgkmcnt(4)
    v_mfma_f32_32x32x16_bf16 v[96:111], v[56:59], v[152:155], v[96:111]
    s_waitcnt vmcnt(16)
    s_barrier
    v_add_u32 v20, 65536, v18
    v_add_u32 v21, 65536, v19
    ds_read_b64_tr_b16 v[48:49], v20 offset:16384
    ds_read_b64_tr_b16 v[50:51], v20 offset:16896
    v_cvt_pk_bf16_f32 v66, v68, v69
    v_cvt_pk_bf16_f32 v67, v70, v71
    s_lshl_b32 s78, s74, 5
    s_add_u32 s78, s78, s71
    buffer_store_dwordx4 v[64:67], v2, s[16:19], s78 offen offset:0 sc1
    s_add_u32 s78, s60, 147456
    v_add_u32 v29, s78, v2
L_pad_P_39:
    s_cbranch_execz L_ret_P
    ds_write_b128 v29, v[64:67] offset:0
    v_mfma_f32_32x32x16_bf16 v[112:127], v[60:63], v[152:155], v[112:127]
    ds_read_b64_tr_b16 v[52:53], v21 offset:16384
    ds_read_b64_tr_b16 v[54:55], v21 offset:16896
    s_add_u32 m0, s60, 65536
    s_add_u32 s61, s3, 0
    s_and_b32 s61, s61, 7
    s_mul_i32 s61, s61, 229376
    s_add_u32 s61, s61, s4
    s_add_u32 s61, s61, s76
    buffer_load_dwordx4 v7, s[12:15], s61 offen offset:0 lds
    v_mul_f32 v72, v30, v72
    v_mul_f32 v73, v30, v73
    s_waitcnt lgkmcnt(5)
    v_mfma_f32_32x32x16_bf16 v[96:111], v[40:43], v[156:159], v[96:111]
    ds_read_b64_tr_b16 v[56:57], v20 offset:18432
    ds_read_b64_tr_b16 v[58:59], v20 offset:18944
    v_mul_f32 v74, v30, v74
    v_mul_f32 v75, v30, v75
    v_mul_f32 v76, v30, v76
    v_mul_f32 v77, v30, v77
    v_mfma_f32_32x32x16_bf16 v[112:127], v[44:47], v[156:159], v[112:127]
    ds_read_b64_tr_b16 v[60:61], v21 offset:18432
    ds_read_b64_tr_b16 v[62:63], v21 offset:18944
    s_add_u32 s61, s61, 27648
    buffer_load_dwordx4 v7, s[12:15], s61 offen offset:1024 lds
    v_mul_f32 v78, v30, v78
    v_mul_f32 v79, v30, v79
    s_waitcnt lgkmcnt(4)
    v_mfma_f32_32x32x16_bf16 v[96:111], v[48:51], v[160:163], v[96:111]
    ds_read_b64_tr_b16 v[40:41], v20 offset:20480
    ds_read_b64_tr_b16 v[42:43], v20 offset:20992
    v_max_f32 v72, 0, v72
    v_max_f32 v73, 0, v73
    v_max_f32 v74, 0, v74
    v_max_f32 v75, 0, v75
    v_mfma_f32_32x32x16_bf16 v[112:127], v[52:55], v[160:163], v[112:127]
    ds_read_b64_tr_b16 v[44:45], v21 offset:20480
    ds_read_b64_tr_b16 v[46:47], v21 offset:20992
    s_add_u32 s61, s61, 27648
    s_nop 0
L_pad_P_40:
    s_cbranch_execz L_ret_P
    buffer_load_dwordx4 v7, s[12:15], s61 offen offset:2048 lds
    v_max_f32 v76, 0, v76
    v_max_f32 v77, 0, v77
    s_waitcnt lgkmcnt(4)
    v_mfma_f32_32x32x16_bf16 v[96:111], v[56:59], v[164:167], v[96:111]
    ds_read_b64_tr_b16 v[48:49], v20 offset:22528
    ds_read_b64_tr_b16 v[50:51], v20 offset:23040
    v_max_f32 v78, 0, v78
    v_max_f32 v79, 0, v79
    v_mul_f32 v72, v72, v72
    v_mul_f32 v73, v73, v73
    v_mfma_f32_32x32x16_bf16 v[112:127], v[60:63], v[164:167], v[112:127]
    ds_read_b64_tr_b16 v[52:53], v21 offset:22528
    ds_read_b64_tr_b16 v[54:55], v21 offset:23040
    s_add_u32 s61, s61, 27648
    buffer_load_dwordx4 v7, s[12:15], s61 offen offset:3072 lds
    v_mul_f32 v74, v74, v74
    v_mul_f32 v75, v75, v75
    s_waitcnt lgkmcnt(4)
    v_mfma_f32_32x32x16_bf16 v[96:111], v[40:43], v[168:171], v[96:111]
    ds_read_b64_tr_b16 v[56:57], v20 offset:24576
    ds_read_b64_tr_b16 v[58:59], v20 offset:25088
    v_mul_f32 v76, v76, v76
    v_mul_f32 v77, v77, v77
    v_mul_f32 v78, v78, v78
    v_mul_f32 v79, v79, v79
    v_mfma_f32_32x32x16_bf16 v[112:127], v[44:47], v[168:171], v[112:127]
    ds_read_b64_tr_b16 v[60:61], v21 offset:24576
    ds_read_b64_tr_b16 v[62:63], v21 offset:25088
    s_add_u32 m0, s60, 16384
    s_lshl_b32 s61, s75, 9
    s_xor_b32 s61, s61, 262144
    s_add_u32 s61, s61, s68
    s_add_u32 s61, s61, s69
    buffer_load_dwordx4 v9, s[20:23], s61 offen offset:0 lds
    v_cvt_pk_bf16_f32 v72, v72, v73
    v_cvt_pk_bf16_f32 v73, v74, v75
    s_waitcnt lgkmcnt(4)
    v_mfma_f32_32x32x16_bf16 v[96:111], v[48:51], v[172:175], v[96:111]
    ds_read_b64_tr_b16 v[40:41], v20 offset:26624
    s_nop 0
L_pad_P_41:
    s_cbranch_execz L_ret_P
    ds_read_b64_tr_b16 v[42:43], v20 offset:27136
    v_cvt_pk_bf16_f32 v74, v76, v77
    v_cvt_pk_bf16_f32 v75, v78, v79
    s_lshl_b32 s78, s74, 5
    s_add_u32 s78, s78, s71
    buffer_store_dwordx4 v[72:75], v2, s[16:19], s78 offen offset:1024 sc1
    s_add_u32 s78, s60, 147456
    v_add_u32 v29, s78, v2
    ds_write_b128 v29, v[72:75] offset:1024
    v_mfma_f32_32x32x16_bf16 v[112:127], v[52:55], v[172:175], v[112:127]
    ds_read_b64_tr_b16 v[44:45], v21 offset:26624
    ds_read_b64_tr_b16 v[46:47], v21 offset:27136
    s_add_u32 s61, s61, 7168
    buffer_load_dwordx4 v9, s[20:23], s61 offen offset:1024 lds
    v_mul_f32 v80, v30, v80
    v_mul_f32 v81, v30, v81
    s_waitcnt lgkmcnt(5)
    v_mfma_f32_32x32x16_bf16 v[96:111], v[56:59], v[176:179], v[96:111]
    ds_read_b64_tr_b16 v[48:49], v20 offset:28672
    ds_read_b64_tr_b16 v[50:51], v20 offset:29184
    v_mul_f32 v82, v30, v82
    v_mul_f32 v83, v30, v83
    v_mul_f32 v84, v30, v84
    v_mul_f32 v85, v30, v85
    v_mfma_f32_32x32x16_bf16 v[112:127], v[60:63], v[176:179], v[112:127]
    ds_read_b64_tr_b16 v[52:53], v21 offset:28672
    ds_read_b64_tr_b16 v[54:55], v21 offset:29184
    s_add_u32 s61, s61, 7168
    buffer_load_dwordx4 v9, s[20:23], s61 offen offset:2048 lds
    v_mul_f32 v86, v30, v86
    v_mul_f32 v87, v30, v87
    s_waitcnt lgkmcnt(4)
    v_mfma_f32_32x32x16_bf16 v[96:111], v[40:43], v[180:183], v[96:111]
    ds_read_b64_tr_b16 v[56:57], v20 offset:30720
    ds_read_b64_tr_b16 v[58:59], v20 offset:31232
    s_add_u32 s61, s61, 7168
    buffer_load_dwordx4 v9, s[20:23], s61 offen offset:3072 lds
    v_max_f32 v80, 0, v80
    v_max_f32 v81, 0, v81
L_pad_P_42:
    s_cbranch_execz L_ret_P
    v_mfma_f32_32x32x16_bf16 v[112:127], v[44:47], v[180:183], v[112:127]
    ds_read_b64_tr_b16 v[60:61], v21 offset:30720
    ds_read_b64_tr_b16 v[62:63], v21 offset:31232
    v_max_f32 v82, 0, v82
    v_max_f32 v83, 0, v83
    v_max_f32 v84, 0, v84
    v_max_f32 v85, 0, v85
    s_waitcnt lgkmcnt(4)
    v_mfma_f32_32x32x16_bf16 v[96:111], v[48:51], v[184:187], v[96:111]
    s_waitcnt vmcnt(18)
    s_barrier
    ds_read_b64_tr_b16 v[40:41], v20 offset:49152
    ds_read_b64_tr_b16 v[42:43], v20 offset:49664
    v_max_f32 v86, 0, v86
    v_max_f32 v87, 0, v87
    v_mul_f32 v80, v80, v80
    v_mul_f32 v81, v81, v81
    v_mfma_f32_32x32x16_bf16 v[112:127], v[52:55], v[184:187], v[112:127]
    ds_read_b64_tr_b16 v[44:45], v21 offset:49152
    ds_read_b64_tr_b16 v[46:47], v21 offset:49664
    s_add_u32 m0, s60, 49152
    s_add_u32 s61, s3, 2
    s_and_b32 s61, s61, 7
    s_mul_i32 s61, s61, 229376
    s_add_u32 s61, s61, s4
    s_add_u32 s61, s61, s76
    buffer_load_dwordx4 v7, s[12:15], s61 offen offset:0 lds
    v_mul_f32 v82, v82, v82
    v_mul_f32 v83, v83, v83
    s_waitcnt lgkmcnt(4)
    v_mfma_f32_32x32x16_bf16 v[96:111], v[56:59], v[188:191], v[96:111]
    ds_read_b64_tr_b16 v[48:49], v20 offset:51200
    ds_read_b64_tr_b16 v[50:51], v20 offset:51712
    v_mul_f32 v84, v84, v84
    v_mul_f32 v85, v85, v85
    v_mul_f32 v86, v86, v86
    v_mul_f32 v87, v87, v87
    v_mfma_f32_32x32x16_bf16 v[112:127], v[60:63], v[188:191], v[112:127]
    ds_read_b64_tr_b16 v[52:53], v21 offset:51200
    ds_read_b64_tr_b16 v[54:55], v21 offset:51712
    s_add_u32 s61, s61, 27648
    buffer_load_dwordx4 v7, s[12:15], s61 offen offset:1024 lds
    s_nop 0
L_pad_P_43:
    s_cbranch_execz L_ret_P
    v_cvt_pk_bf16_f32 v80, v80, v81
    v_cvt_pk_bf16_f32 v81, v82, v83
    s_waitcnt lgkmcnt(4)
    v_mfma_f32_32x32x16_bf16 v[96:111], v[40:43], v[192:195], v[96:111]
    ds_read_b64_tr_b16 v[56:57], v20 offset:53248
    ds_read_b64_tr_b16 v[58:59], v20 offset:53760
    v_cvt_pk_bf16_f32 v82, v84, v85
    v_cvt_pk_bf16_f32 v83, v86, v87
    s_lshl_b32 s78, s74, 5
    s_add_u32 s78, s78, s71
    buffer_store_dwordx4 v[80:83], v2, s[16:19], s78 offen offset:2048 sc1
    s_add_u32 s78, s60, 147456
    v_add_u32 v29, s78, v2
    ds_write_b128 v29, v[80:83] offset:2048
    v_mfma_f32_32x32x16_bf16 v[112:127], v[44:47], v[192:195], v[112:127]
    ds_read_b64_tr_b16 v[60:61], v21 offset:53248
    ds_read_b64_tr_b16 v[62:63], v21 offset:53760
    s_add_u32 s61, s61, 27648
    buffer_load_dwordx4 v7, s[12:15], s61 offen offset:2048 lds
    v_mul_f32 v88, v30, v88
    v_mul_f32 v89, v30, v89
    s_waitcnt lgkmcnt(5)
    v_mfma_f32_32x32x16_bf16 v[96:111], v[48:51], v[196:199], v[96:111]
    ds_read_b64_tr_b16 v[40:41], v20 offset:55296
    ds_read_b64_tr_b16 v[42:43], v20 offset:55808
    v_mul_f32 v90, v30, v90
    v_mul_f32 v91, v30, v91
    v_mul_f32 v92, v30, v92
    v_mul_f32 v93, v30, v93
    v_mfma_f32_32x32x16_bf16 v[112:127], v[52:55], v[196:199], v[112:127]
    ds_read_b64_tr_b16 v[44:45], v21 offset:55296
    ds_read_b64_tr_b16 v[46:47], v21 offset:55808
    s_add_u32 s61, s61, 27648
    buffer_load_dwordx4 v7, s[12:15], s61 offen offset:3072 lds
    v_mul_f32 v94, v30, v94
    v_mul_f32 v95, v30, v95
    s_waitcnt lgkmcnt(4)
    v_mfma_f32_32x32x16_bf16 v[96:111], v[56:59], v[200:203], v[96:111]
    s_nop 0
L_pad_P_44:
    s_cbranch_execz L_ret_P
    ds_read_b64_tr_b16 v[48:49], v20 offset:57344
    ds_read_b64_tr_b16 v[50:51], v20 offset:57856
    v_max_f32 v88, 0, v88
    v_max_f32 v89, 0, v89
    v_max_f32 v90, 0, v90
    v_max_f32 v91, 0, v91
    v_mfma_f32_32x32x16_bf16 v[112:127], v[60:63], v[200:203], v[112:127]
    ds_read_b64_tr_b16 v[52:53], v21 offset:57344
    ds_read_b64_tr_b16 v[54:55], v21 offset:57856
    v_max_f32 v92, 0, v92
    v_max_f32 v93, 0, v93
    v_max_f32 v94, 0, v94
    v_max_f32 v95, 0, v95
    s_waitcnt lgkmcnt(4)
    v_mfma_f32_32x32x16_bf16 v[96:111], v[40:43], v[204:207], v[96:111]
    ds_read_b64_tr_b16 v[56:57], v20 offset:59392
    ds_read_b64_tr_b16 v[58:59], v20 offset:59904
    v_mul_f32 v88, v88, v88
    v_mul_f32 v89, v89, v89
    v_mul_f32 v90, v90, v90
    v_mul_f32 v91, v91, v91
    v_mfma_f32_32x32x16_bf16 v[112:127], v[44:47], v[204:207], v[112:127]
    ds_read_b64_tr_b16 v[60:61], v21 offset:59392
    ds_read_b64_tr_b16 v[62:63], v21 offset:59904
    v_mul_f32 v92, v92, v92
    v_mul_f32 v93, v93, v93
    v_mul_f32 v94, v94, v94
    v_mul_f32 v95, v95, v95
    s_waitcnt lgkmcnt(4)
    v_mfma_f32_32x32x16_bf16 v[96:111], v[48:51], v[208:211], v[96:111]
    ds_read_b64_tr_b16 v[40:41], v20 offset:61440
    ds_read_b64_tr_b16 v[42:43], v20 offset:61952
    v_cvt_pk_bf16_f32 v88, v88, v89
    v_cvt_pk_bf16_f32 v89, v90, v91
    v_cvt_pk_bf16_f32 v90, v92, v93
    v_cvt_pk_bf16_f32 v91, v94, v95
    v_mfma_f32_32x32x16_bf16 v[112:127], v[52:55], v[208:211], v[112:127]
    ds_read_b64_tr_b16 v[44:45], v21 offset:61440
    ds_read_b64_tr_b16 v[46:47], v21 offset:61952
    s_lshl_b32 s78, s74, 5
    s_add_u32 s78, s78, s71
    s_nop 0
L_pad_P_45:
    s_cbranch_execz L_ret_P
    buffer_store_dwordx4 v[88:91], v2, s[16:19], s78 offen offset:3072 sc1
    s_add_u32 s78, s60, 147456
    v_add_u32 v29, s78, v2
    ds_write_b128 v29, v[88:91] offset:3072
    s_add_u32 s78, s66, 1
    s_and_b32 s78, s78, 3
    s_mul_i32 s78, s78, 24576
    s_add_u32 s78, s78, s100
    buffer_store_dwordx4 a[248:251], v2, s[16:19], s78 offen offset:0 sc1
    s_add_u32 s78, s66, 1
    s_and_b32 s78, s78, 3
    s_mul_i32 s78, s78, 24576
    s_add_u32 s78, s78, s100
    buffer_store_dwordx4 a[248:251], v2, s[16:19], s78 offen offset:1024 sc1
    s_waitcnt lgkmcnt(5)
    v_mfma_f32_32x32x16_bf16 v[96:111], v[56:59], v[212:215], v[96:111]
    ds_read_b64_tr_b16 v[48:49], v20 offset:63488
    ds_read_b64_tr_b16 v[50:51], v20 offset:64000
    s_add_u32 s78, s66, 2
    s_and_b32 s78, s78, 3
    s_mul_i32 s78, s78, 24576
    s_add_u32 s78, s78, s100
    s_add_u32 s78, s78, 8192
    buffer_store_dwordx4 a[248:251], v2, s[16:19], s78 offen offset:0 sc1
    s_add_u32 s78, s66, 2
    s_and_b32 s78, s78, 3
    s_mul_i32 s78, s78, 24576
    s_add_u32 s78, s78, s100
    s_add_u32 s78, s78, 8192
    buffer_store_dwordx4 a[248:251], v2, s[16:19], s78 offen offset:1024 sc1
    s_add_u32 s78, s66, 3
    s_and_b32 s78, s78, 3
    s_mul_i32 s78, s78, 24576
    s_add_u32 s78, s78, s100
    s_add_u32 s78, s78, 16384
    buffer_store_dwordx4 a[248:251], v2, s[16:19], s78 offen offset:0 sc1
    s_add_u32 s78, s66, 3
    s_and_b32 s78, s78, 3
    s_mul_i32 s78, s78, 24576
    s_add_u32 s78, s78, s100
    s_add_u32 s78, s78, 16384
    s_nop 0
L_pad_P_46:
    s_cbranch_execz L_ret_P
    buffer_store_dwordx4 a[248:251], v2, s[16:19], s78 offen offset:1024 sc1
    v_mfma_f32_32x32x16_bf16 v[112:127], v[60:63], v[212:215], v[112:127]
    ds_read_b64_tr_b16 v[52:53], v21 offset:63488
    ds_read_b64_tr_b16 v[54:55], v21 offset:64000
    ds_read_b64_tr_b16 a[32:33], v26 offset:32768
    ds_read_b64_tr_b16 a[34:35], v26 offset:33792
    ds_read_b64_tr_b16 a[36:37], v26 offset:34816
    ds_read_b64_tr_b16 a[38:39], v26 offset:35840
    s_waitcnt lgkmcnt(9)
    v_mfma_f32_32x32x16_bf16 v[96:111], v[40:43], v[216:219], v[96:111]
    s_waitcnt vmcnt(22)
    s_barrier
    ds_read_b64_tr_b16 v[56:57], v18 offset:32768
    ds_read_b64_tr_b16 v[58:59], v18 offset:33280
    ds_read_b64_tr_b16 a[40:41], v26 offset:40960
    ds_read_b64_tr_b16 a[42:43], v26 offset:41984
    ds_read_b64_tr_b16 a[44:45], v26 offset:43008
    ds_read_b64_tr_b16 a[46:47], v26 offset:44032
    v_mfma_f32_32x32x16_bf16 v[112:127], v[44:47], v[216:219], v[112:127]
    ds_read_b64_tr_b16 v[60:61], v19 offset:32768
    ds_read_b64_tr_b16 v[62:63], v19 offset:33280
    s_add_u32 m0, s60, 81920
    s_xor_b32 s61, s70, 0
    buffer_load_dwordx4 v5, s[24:27], s61 offen offset:0 lds
    v_add_u32 v26, 131072, v24
    ds_read_b64_tr_b16 a[48:49], v26 offset:0
    ds_read_b64_tr_b16 a[50:51], v26 offset:1024
    s_waitcnt lgkmcnt(14)
    v_mfma_f32_32x32x16_bf16 v[96:111], v[48:51], v[220:223], v[96:111]
    ds_read_b64_tr_b16 v[40:41], v18 offset:34816
    ds_read_b64_tr_b16 v[42:43], v18 offset:35328
    ds_read_b64_tr_b16 a[52:53], v26 offset:2048
    ds_read_b64_tr_b16 a[54:55], v26 offset:3072
    ds_read_b64_tr_b16 a[56:57], v26 offset:8192
L_pad_P_47:
    s_cbranch_execz L_ret_P
    ds_read_b64_tr_b16 a[58:59], v26 offset:9216
    v_mfma_f32_32x32x16_bf16 v[112:127], v[52:55], v[220:223], v[112:127]
    ds_read_b64_tr_b16 v[44:45], v19 offset:34816
    ds_read_b64_tr_b16 v[46:47], v19 offset:35328
    s_add_u32 s61, s61, 7168
    buffer_load_dwordx4 v6, s[24:27], s61 offen offset:1024 lds
    ds_read_b64_tr_b16 a[60:61], v26 offset:10240
    ds_read_b64_tr_b16 a[62:63], v26 offset:11264
    s_waitcnt lgkmcnt(12)
    v_mfma_f32_32x32x16_bf16 v[96:111], v[56:59], v[224:227], v[96:111]
    ds_read_b64_tr_b16 v[48:49], v18 offset:36864
    ds_read_b64_tr_b16 v[50:51], v18 offset:37376
    ds_read_b64_tr_b16 a[64:65], v24 offset:0
    ds_read_b64_tr_b16 a[66:67], v24 offset:1024
    ds_read_b64_tr_b16 a[68:69], v24 offset:2048
    ds_read_b64_tr_b16 a[70:71], v24 offset:3072
    v_mfma_f32_32x32x16_bf16 v[112:127], v[60:63], v[224:227], v[112:127]
    ds_read_b64_tr_b16 v[52:53], v19 offset:36864
    ds_read_b64_tr_b16 v[54:55], v19 offset:37376
    s_add_u32 s61, s61, 7168
    buffer_load_dwordx4 v5, s[24:27], s61 offen offset:2048 lds
    ds_read_b64_tr_b16 a[72:73], v24 offset:8192
    ds_read_b64_tr_b16 a[74:75], v24 offset:9216
    s_waitcnt lgkmcnt(12)
    v_mfma_f32_32x32x16_bf16 v[96:111], v[40:43], v[228:231], v[96:111]
    ds_read_b64_tr_b16 v[56:57], v18 offset:38912
    ds_read_b64_tr_b16 v[58:59], v18 offset:39424
    ds_read_b64_tr_b16 a[76:77], v24 offset:10240
    ds_read_b64_tr_b16 a[78:79], v24 offset:11264
    v_mfma_f32_32x32x16_bf16 v[112:127], v[44:47], v[228:231], v[112:127]
    ds_read_b64_tr_b16 v[60:61], v19 offset:38912
    ds_read_b64_tr_b16 v[62:63], v19 offset:39424
    s_nop 0
L_pad_P_48:
    s_cbranch_execz L_ret_P
    s_add_u32 s61, s61, 7168
    buffer_load_dwordx4 v6, s[24:27], s61 offen offset:3072 lds
    s_waitcnt lgkmcnt(8)
    v_mfma_f32_32x32x16_bf16 v[96:111], v[48:51], v[232:235], v[96:111]
    ds_read_b64_tr_b16 v[40:41], v18 offset:40960
    ds_read_b64_tr_b16 v[42:43], v18 offset:41472
    v_mfma_f32_32x32x16_bf16 v[112:127], v[52:55], v[232:235], v[112:127]
    ds_read_b64_tr_b16 v[44:45], v19 offset:40960
    ds_read_b64_tr_b16 v[46:47], v19 offset:41472
    s_waitcnt lgkmcnt(4)
    v_mfma_f32_32x32x16_bf16 v[96:111], v[56:59], v[236:239], v[96:111]
    ds_read_b64_tr_b16 v[48:49], v18 offset:43008
    ds_read_b64_tr_b16 v[50:51], v18 offset:43520
    v_mfma_f32_32x32x16_bf16 v[112:127], v[60:63], v[236:239], v[112:127]
    ds_read_b64_tr_b16 v[52:53], v19 offset:43008
    ds_read_b64_tr_b16 v[54:55], v19 offset:43520
    s_waitcnt lgkmcnt(4)
    v_mfma_f32_32x32x16_bf16 v[96:111], v[40:43], v[240:243], v[96:111]
    ds_read_b64_tr_b16 v[56:57], v18 offset:45056
    ds_read_b64_tr_b16 v[58:59], v18 offset:45568
    v_mfma_f32_32x32x16_bf16 v[112:127], v[44:47], v[240:243], v[112:127]
    ds_read_b64_tr_b16 v[60:61], v19 offset:45056
    ds_read_b64_tr_b16 v[62:63], v19 offset:45568
    s_waitcnt lgkmcnt(4)
    v_mfma_f32_32x32x16_bf16 v[96:111], v[48:51], v[244:247], v[96:111]
    ds_read_b64_tr_b16 v[40:41], v18 offset:47104
    ds_read_b64_tr_b16 v[42:43], v18 offset:47616
    v_mfma_f32_32x32x16_bf16 v[112:127], v[52:55], v[244:247], v[112:127]
    ds_read_b64_tr_b16 v[44:45], v19 offset:47104
    ds_read_b64_tr_b16 v[46:47], v19 offset:47616
    s_waitcnt lgkmcnt(4)
    v_mfma_f32_32x32x16_bf16 v[96:111], v[56:59], v[248:251], v[96:111]
    s_waitcnt vmcnt(10)
    s_barrier
    s_cmp_lg_u32 s56, 0
    s_cbranch_scc1 L_fs1859
L_pad_P_49:
    s_cbranch_execz L_ret_P
    s_xor_b32 s78, s101, 4
    v_mov_b32 v37, 1
    s_mov_b64 exec, 1
    buffer_store_dword v37, off, s[16:19], s78 sc1
    s_mov_b64 exec, -1
L_fs1859:
    ds_read_b64_tr_b16 v[48:49], v20 offset:0
    ds_read_b64_tr_b16 v[50:51], v20 offset:512
    ds_read_b64_tr_b16 a[80:81], v24 offset:16384
    ds_read_b64_tr_b16 a[82:83], v24 offset:17408
    ds_read_b64_tr_b16 a[84:85], v24 offset:18432
    ds_read_b64_tr_b16 a[86:87], v24 offset:19456
    v_mfma_f32_32x32x16_bf16 v[112:127], v[60:63], v[248:251], v[112:127]
    ds_read_b64_tr_b16 v[52:53], v21 offset:0
    ds_read_b64_tr_b16 v[54:55], v21 offset:512
    s_add_u32 m0, s60, 131072
    s_add_u32 s61, s3, 4
    s_and_b32 s61, s61, 7
    s_mul_i32 s61, s61, 229376
    s_add_u32 s61, s61, s4
    s_add_u32 s61, s61, s76
    buffer_load_dwordx4 v7, s[12:15], s61 offen offset:0 lds
    ds_read_b64_tr_b16 a[88:89], v24 offset:24576
    ds_read_b64_tr_b16 a[90:91], v24 offset:25600
    s_waitcnt lgkmcnt(10)
    v_mfma_f32_32x32x16_bf16 v[96:111], v[40:43], v[252:255], v[96:111]
    ds_read_b64_tr_b16 v[56:57], v20 offset:2048
    ds_read_b64_tr_b16 v[58:59], v20 offset:2560
    ds_read_b64_tr_b16 a[92:93], v24 offset:26624
    ds_read_b64_tr_b16 a[94:95], v24 offset:27648
    v_mfma_f32_32x32x16_bf16 v[112:127], v[44:47], v[252:255], v[112:127]
    ds_read_b64_tr_b16 v[60:61], v21 offset:2048
    ds_read_b64_tr_b16 v[62:63], v21 offset:2560
    s_add_u32 s61, s61, 27648
    buffer_load_dwordx4 v7, s[12:15], s61 offen offset:1024 lds
    s_waitcnt lgkmcnt(8)
    v_mfma_f32_32x32x16_bf16 v[64:79], a[232:235], a[244:247], 0
    s_nop 0
L_pad_P_50:
    s_cbranch_execz L_ret_P
    ds_read_b64_tr_b16 v[40:41], v20 offset:4096
    v_mfma_f32_32x32x16_bf16 v[80:95], a[234:237], a[244:247], 0
    ds_read_b64_tr_b16 v[42:43], v20 offset:4608
    s_add_u32 s61, s61, 27648
    buffer_load_dwordx4 v7, s[12:15], s61 offen offset:2048 lds
    v_mfma_f32_32x32x16_bf16 v[64:79], v[48:51], v[128:131], v[64:79]
    ds_read_b64_tr_b16 v[44:45], v21 offset:4096
    v_mfma_f32_32x32x16_bf16 v[80:95], v[52:55], v[128:131], v[80:95]
    ds_read_b64_tr_b16 v[46:47], v21 offset:4608
    s_add_u32 s61, s61, 27648
    buffer_load_dwordx4 v7, s[12:15], s61 offen offset:3072 lds
    s_waitcnt lgkmcnt(4)
    v_mfma_f32_32x32x16_bf16 v[64:79], v[56:59], v[132:135], v[64:79]
    ds_read_b64_tr_b16 v[48:49], v20 offset:6144
    ds_read_b64_tr_b16 v[50:51], v20 offset:6656
    v_mfma_f32_32x32x16_bf16 v[80:95], v[60:63], v[132:135], v[80:95]
    ds_read_b64_tr_b16 v[52:53], v21 offset:6144
    ds_read_b64_tr_b16 v[54:55], v21 offset:6656
    s_add_u32 m0, s60, 0
    s_xor_b32 s61, s70, 0
    buffer_load_dwordx4 v5, s[28:31], s61 offen offset:0 lds
    s_waitcnt lgkmcnt(4)
    v_mfma_f32_32x32x16_bf16 v[64:79], v[40:43], v[136:139], v[64:79]
    ds_read_b64_tr_b16 v[56:57], v20 offset:8192
    ds_read_b64_tr_b16 v[58:59], v20 offset:8704
    v_mul_f32 v96, v30, v96
    v_mul_f32 v97, v30, v97
    v_mul_f32 v98, v30, v98
    v_mul_f32 v99, v30, v99
    v_mfma_f32_32x32x16_bf16 v[80:95], v[44:47], v[136:139], v[80:95]
    ds_read_b64_tr_b16 v[60:61], v21 offset:8192
    ds_read_b64_tr_b16 v[62:63], v21 offset:8704
    s_add_u32 s61, s61, 7168
    buffer_load_dwordx4 v6, s[28:31], s61 offen offset:1024 lds
    v_mul_f32 v100, v30, v100
    v_mul_f32 v101, v30, v101
    s_waitcnt lgkmcnt(4)
L_pad_P_51:
    s_cbranch_execz L_ret_P
    v_mfma_f32_32x32x16_bf16 v[64:79], v[48:51], v[140:143], v[64:79]
    ds_read_b64_tr_b16 v[40:41], v20 offset:10240
    ds_read_b64_tr_b16 v[42:43], v20 offset:10752
    v_mul_f32 v102, v30, v102
    v_mul_f32 v103, v30, v103
    v_max_f32 v96, 0, v96
    v_max_f32 v97, 0, v97
    v_mfma_f32_32x32x16_bf16 v[80:95], v[52:55], v[140:143], v[80:95]
    ds_read_b64_tr_b16 v[44:45], v21 offset:10240
    ds_read_b64_tr_b16 v[46:47], v21 offset:10752
    s_add_u32 s61, s61, 7168
    buffer_load_dwordx4 v5, s[28:31], s61 offen offset:2048 lds
    v_max_f32 v98, 0, v98
    v_max_f32 v99, 0, v99
    s_waitcnt lgkmcnt(4)
    v_mfma_f32_32x32x16_bf16 v[64:79], v[56:59], v[144:147], v[64:79]
    ds_read_b64_tr_b16 v[48:49], v20 offset:12288
    ds_read_b64_tr_b16 v[50:51], v20 offset:12800
    v_max_f32 v100, 0, v100
    v_max_f32 v101, 0, v101
    v_max_f32 v102, 0, v102
    v_max_f32 v103, 0, v103
    v_mfma_f32_32x32x16_bf16 v[80:95], v[60:63], v[144:147], v[80:95]
    ds_read_b64_tr_b16 v[52:53], v21 offset:12288
    ds_read_b64_tr_b16 v[54:55], v21 offset:12800
    s_add_u32 s61, s61, 7168
    buffer_load_dwordx4 v6, s[28:31], s61 offen offset:3072 lds
    v_mul_f32 v96, v96, v96
    v_mul_f32 v97, v97, v97
    s_waitcnt lgkmcnt(4)
    v_mfma_f32_32x32x16_bf16 v[64:79], v[40:43], v[148:151], v[64:79]
    ds_read_b64_tr_b16 v[56:57], v20 offset:14336
    ds_read_b64_tr_b16 v[58:59], v20 offset:14848
    v_mul_f32 v98, v98, v98
    v_mul_f32 v99, v99, v99
    v_mul_f32 v100, v100, v100
    v_mul_f32 v101, v101, v101
    v_mfma_f32_32x32x16_bf16 v[80:95], v[44:47], v[148:151], v[80:95]
    ds_read_b64_tr_b16 v[60:61], v21 offset:14336
    ds_read_b64_tr_b16 v[62:63], v21 offset:14848
    v_mul_f32 v102, v102, v102
L_pad_P_52:
    s_cbranch_execz L_ret_P
    v_mul_f32 v103, v103, v103
    v_cvt_pk_bf16_f32 v96, v96, v97
    v_cvt_pk_bf16_f32 v97, v98, v99
    s_waitcnt lgkmcnt(4)
    v_mfma_f32_32x32x16_bf16 v[64:79], v[48:51], v[152:155], v[64:79]
    s_barrier
    ds_read_b64_tr_b16 v[40:41], v18 offset:49152
    ds_read_b64_tr_b16 v[42:43], v18 offset:49664
    v_cvt_pk_bf16_f32 v98, v100, v101
    v_cvt_pk_bf16_f32 v99, v102, v103
    s_lshl_b32 s78, s75, 5
    s_add_u32 s78, s78, s71
    buffer_store_dwordx4 v[96:99], v2, s[16:19], s78 offen offset:0 sc1
    s_add_u32 s78, s60, 98304
    v_add_u32 v29, s78, v2
    ds_write_b128 v29, v[96:99] offset:0
    v_mfma_f32_32x32x16_bf16 v[80:95], v[52:55], v[152:155], v[80:95]
    ds_read_b64_tr_b16 v[44:45], v19 offset:49152
    ds_read_b64_tr_b16 v[46:47], v19 offset:49664
    s_add_u32 m0, s60, 114688
    s_add_u32 s61, s3, 6
    s_and_b32 s61, s61, 7
    s_mul_i32 s61, s61, 229376
    s_add_u32 s61, s61, s4
    s_add_u32 s61, s61, s76
    buffer_load_dwordx4 v7, s[12:15], s61 offen offset:0 lds
    v_mul_f32 v104, v30, v104
    v_mul_f32 v105, v30, v105
    s_waitcnt lgkmcnt(5)
    v_mfma_f32_32x32x16_bf16 v[64:79], v[56:59], v[156:159], v[64:79]
    ds_read_b64_tr_b16 v[48:49], v18 offset:51200
    ds_read_b64_tr_b16 v[50:51], v18 offset:51712
    v_mul_f32 v106, v30, v106
    v_mul_f32 v107, v30, v107
    v_mul_f32 v108, v30, v108
    v_mul_f32 v109, v30, v109
    v_mfma_f32_32x32x16_bf16 v[80:95], v[60:63], v[156:159], v[80:95]
    ds_read_b64_tr_b16 v[52:53], v19 offset:51200
    ds_read_b64_tr_b16 v[54:55], v19 offset:51712
    s_add_u32 s61, s61, 27648
L_pad_P_53:
    s_cbranch_execz L_ret_P
    buffer_load_dwordx4 v7, s[12:15], s61 offen offset:1024 lds
    v_mul_f32 v110, v30, v110
    v_mul_f32 v111, v30, v111
    s_waitcnt lgkmcnt(4)
    v_mfma_f32_32x32x16_bf16 v[64:79], v[40:43], v[160:163], v[64:79]
    ds_read_b64_tr_b16 v[56:57], v18 offset:53248
    ds_read_b64_tr_b16 v[58:59], v18 offset:53760
    v_max_f32 v104, 0, v104
    v_max_f32 v105, 0, v105
    v_max_f32 v106, 0, v106
    v_max_f32 v107, 0, v107
    v_mfma_f32_32x32x16_bf16 v[80:95], v[44:47], v[160:163], v[80:95]
    ds_read_b64_tr_b16 v[60:61], v19 offset:53248
    ds_read_b64_tr_b16 v[62:63], v19 offset:53760
    s_add_u32 s61, s61, 27648
    buffer_load_dwordx4 v7, s[12:15], s61 offen offset:2048 lds
    v_max_f32 v108, 0, v108
    v_max_f32 v109, 0, v109
    s_waitcnt lgkmcnt(4)
    v_mfma_f32_32x32x16_bf16 v[64:79], v[48:51], v[164:167], v[64:79]
    ds_read_b64_tr_b16 v[40:41], v18 offset:55296
    ds_read_b64_tr_b16 v[42:43], v18 offset:55808
    v_max_f32 v110, 0, v110
    v_max_f32 v111, 0, v111
    v_mul_f32 v104, v104, v104
    v_mul_f32 v105, v105, v105
    v_mfma_f32_32x32x16_bf16 v[80:95], v[52:55], v[164:167], v[80:95]
    ds_read_b64_tr_b16 v[44:45], v19 offset:55296
    ds_read_b64_tr_b16 v[46:47], v19 offset:55808
    s_add_u32 s61, s61, 27648
    buffer_load_dwordx4 v7, s[12:15], s61 offen offset:3072 lds
    v_mul_f32 v106, v106, v106
    v_mul_f32 v107, v107, v107
    s_waitcnt lgkmcnt(4)
    v_mfma_f32_32x32x16_bf16 v[64:79], v[56:59], v[168:171], v[64:79]
    ds_read_b64_tr_b16 v[48:49], v18 offset:57344
    ds_read_b64_tr_b16 v[50:51], v18 offset:57856
    v_mul_f32 v108, v108, v108
    v_mul_f32 v109, v109, v109
    v_mul_f32 v110, v110, v110
    v_mul_f32 v111, v111, v111
    v_mfma_f32_32x32x16_bf16 v[80:95], v[60:63], v[168:171], v[80:95]
L_pad_P_54:
    s_cbranch_execz L_ret_P
    ds_read_b64_tr_b16 v[52:53], v19 offset:57344
    ds_read_b64_tr_b16 v[54:55], v19 offset:57856
    s_add_u32 m0, s60, 16384
    s_add_u32 s61, s5, 0
    s_and_b32 s61, s61, 7
    s_mul_i32 s61, s61, 229376
    s_add_u32 s61, s61, s73
    s_add_u32 s61, s61, s77
    buffer_load_dwordx4 v8, s[12:15], s61 offen offset:0 lds
    v_cvt_pk_bf16_f32 v104, v104, v105
    v_cvt_pk_bf16_f32 v105, v106, v107
    s_waitcnt lgkmcnt(4)
    v_mfma_f32_32x32x16_bf16 v[64:79], v[40:43], v[172:175], v[64:79]
    ds_read_b64_tr_b16 v[56:57], v18 offset:59392
    ds_read_b64_tr_b16 v[58:59], v18 offset:59904
    v_cvt_pk_bf16_f32 v106, v108, v109
    v_cvt_pk_bf16_f32 v107, v110, v111
    s_lshl_b32 s78, s75, 5
    s_add_u32 s78, s78, s71
    buffer_store_dwordx4 v[104:107], v2, s[16:19], s78 offen offset:1024 sc1
    s_add_u32 s78, s60, 98304
    v_add_u32 v29, s78, v2
    ds_write_b128 v29, v[104:107] offset:1024
    v_mfma_f32_32x32x16_bf16 v[80:95], v[44:47], v[172:175], v[80:95]
    ds_read_b64_tr_b16 v[60:61], v19 offset:59392
    ds_read_b64_tr_b16 v[62:63], v19 offset:59904
    s_add_u32 s61, s61, 56320
    buffer_load_dwordx4 v8, s[12:15], s61 offen offset:1024 lds
    v_mul_f32 v112, v30, v112
    v_mul_f32 v113, v30, v113
    s_waitcnt lgkmcnt(5)
    v_mfma_f32_32x32x16_bf16 v[64:79], v[48:51], v[176:179], v[64:79]
    ds_read_b64_tr_b16 v[40:41], v18 offset:61440
    ds_read_b64_tr_b16 v[42:43], v18 offset:61952
    v_mul_f32 v114, v30, v114
    v_mul_f32 v115, v30, v115
    v_mul_f32 v116, v30, v116
    v_mul_f32 v117, v30, v117
    v_mfma_f32_32x32x16_bf16 v[80:95], v[52:55], v[176:179], v[80:95]
L_pad_P_55:
    s_cbranch_execz L_ret_P
    ds_read_b64_tr_b16 v[44:45], v19 offset:61440
    ds_read_b64_tr_b16 v[46:47], v19 offset:61952
    s_add_u32 s61, s61, 56320
    buffer_load_dwordx4 v8, s[12:15], s61 offen offset:2048 lds
    v_mul_f32 v118, v30, v118
    v_mul_f32 v119, v30, v119
    s_waitcnt lgkmcnt(4)
    v_mfma_f32_32x32x16_bf16 v[64:79], v[56:59], v[180:183], v[64:79]
    ds_read_b64_tr_b16 v[48:49], v18 offset:63488
    ds_read_b64_tr_b16 v[50:51], v18 offset:64000
    s_add_u32 s61, s61, 56320
    buffer_load_dwordx4 v8, s[12:15], s61 offen offset:3072 lds
    v_max_f32 v112, 0, v112
    v_max_f32 v113, 0, v113
    v_mfma_f32_32x32x16_bf16 v[80:95], v[60:63], v[180:183], v[80:95]
    ds_read_b64_tr_b16 v[52:53], v19 offset:63488
    ds_read_b64_tr_b16 v[54:55], v19 offset:64000
    v_max_f32 v114, 0, v114
    v_max_f32 v115, 0, v115
    v_max_f32 v116, 0, v116
    v_max_f32 v117, 0, v117
    s_waitcnt lgkmcnt(4)
    v_mfma_f32_32x32x16_bf16 v[64:79], v[40:43], v[184:187], v[64:79]
    s_waitcnt vmcnt(14)
    s_barrier
    v_add_u32 v20, 131072, v18
    v_add_u32 v21, 131072, v19
    ds_read_b64_tr_b16 v[56:57], v20 offset:0
    ds_read_b64_tr_b16 v[58:59], v20 offset:512
    v_max_f32 v118, 0, v118
    v_max_f32 v119, 0, v119
    v_mul_f32 v112, v112, v112
    v_mul_f32 v113, v113, v113
    v_mfma_f32_32x32x16_bf16 v[80:95], v[44:47], v[184:187], v[80:95]
    ds_read_b64_tr_b16 v[60:61], v21 offset:0
    ds_read_b64_tr_b16 v[62:63], v21 offset:512
    s_add_u32 m0, s60, 32768
    s_add_u32 s61, s5, 4
    s_and_b32 s61, s61, 7
    s_mul_i32 s61, s61, 229376
    s_add_u32 s61, s61, s73
L_pad_P_56:
    s_cbranch_execz L_ret_P
    s_add_u32 s61, s61, s77
    buffer_load_dwordx4 v8, s[12:15], s61 offen offset:0 lds
    v_mul_f32 v114, v114, v114
    v_mul_f32 v115, v115, v115
    s_waitcnt lgkmcnt(4)
    v_mfma_f32_32x32x16_bf16 v[64:79], v[48:51], v[188:191], v[64:79]
    ds_read_b64_tr_b16 v[40:41], v20 offset:2048
    ds_read_b64_tr_b16 v[42:43], v20 offset:2560
    v_mul_f32 v116, v116, v116
    v_mul_f32 v117, v117, v117
    v_mul_f32 v118, v118, v118
    v_mul_f32 v119, v119, v119
    v_mfma_f32_32x32x16_bf16 v[80:95], v[52:55], v[188:191], v[80:95]
    ds_read_b64_tr_b16 v[44:45], v21 offset:2048
    ds_read_b64_tr_b16 v[46:47], v21 offset:2560
    s_add_u32 s61, s61, 56320
    buffer_load_dwordx4 v8, s[12:15], s61 offen offset:1024 lds
    v_cvt_pk_bf16_f32 v112, v112, v113
    v_cvt_pk_bf16_f32 v113, v114, v115
    s_waitcnt lgkmcnt(4)
    v_mfma_f32_32x32x16_bf16 v[64:79], v[56:59], v[192:195], v[64:79]
    ds_read_b64_tr_b16 v[48:49], v20 offset:4096
    ds_read_b64_tr_b16 v[50:51], v20 offset:4608
    v_cvt_pk_bf16_f32 v114, v116, v117
    v_cvt_pk_bf16_f32 v115, v118, v119
    s_lshl_b32 s78, s75, 5
    s_add_u32 s78, s78, s71
    buffer_store_dwordx4 v[112:115], v2, s[16:19], s78 offen offset:2048 sc1
    s_add_u32 s78, s60, 98304
    v_add_u32 v29, s78, v2
    ds_write_b128 v29, v[112:115] offset:2048
    v_mfma_f32_32x32x16_bf16 v[80:95], v[60:63], v[192:195], v[80:95]
    ds_read_b64_tr_b16 v[52:53], v21 offset:4096
    ds_read_b64_tr_b16 v[54:55], v21 offset:4608
    s_add_u32 s61, s61, 56320
    buffer_load_dwordx4 v8, s[12:15], s61 offen offset:2048 lds
    v_mul_f32 v120, v30, v120
    v_mul_f32 v121, v30, v121
    s_waitcnt lgkmcnt(5)
L_pad_P_57:
    s_cbranch_execz L_ret_P
    v_mfma_f32_32x32x16_bf16 v[64:79], v[40:43], v[196:199], v[64:79]
    ds_read_b64_tr_b16 v[56:57], v20 offset:6144
    ds_read_b64_tr_b16 v[58:59], v20 offset:6656
    v_mul_f32 v122, v30, v122
    v_mul_f32 v123, v30, v123
    v_mul_f32 v124, v30, v124
    v_mul_f32 v125, v30, v125
    v_mfma_f32_32x32x16_bf16 v[80:95], v[44:47], v[196:199], v[80:95]
    ds_read_b64_tr_b16 v[60:61], v21 offset:6144
    ds_read_b64_tr_b16 v[62:63], v21 offset:6656
    s_add_u32 s61, s61, 56320
    buffer_load_dwordx4 v8, s[12:15], s61 offen offset:3072 lds
    v_mul_f32 v126, v30, v126
    v_mul_f32 v127, v30, v127
    s_waitcnt lgkmcnt(4)
    v_mfma_f32_32x32x16_bf16 v[64:79], v[48:51], v[200:203], v[64:79]
    ds_read_b64_tr_b16 v[40:41], v20 offset:8192
    ds_read_b64_tr_b16 v[42:43], v20 offset:8704
    v_max_f32 v120, 0, v120
    v_max_f32 v121, 0, v121
    v_max_f32 v122, 0, v122
    v_max_f32 v123, 0, v123
    v_mfma_f32_32x32x16_bf16 v[80:95], v[52:55], v[200:203], v[80:95]
    ds_read_b64_tr_b16 v[44:45], v21 offset:8192
    ds_read_b64_tr_b16 v[46:47], v21 offset:8704
    s_add_u32 m0, s60, 65536
    s_xor_b32 s61, s70, 128
    buffer_load_dwordx4 v5, s[24:27], s61 offen offset:0 lds
    v_max_f32 v124, 0, v124
    v_max_f32 v125, 0, v125
    s_waitcnt lgkmcnt(4)
    v_mfma_f32_32x32x16_bf16 v[64:79], v[56:59], v[204:207], v[64:79]
    ds_read_b64_tr_b16 v[48:49], v20 offset:10240
    ds_read_b64_tr_b16 v[50:51], v20 offset:10752
    v_max_f32 v126, 0, v126
    v_max_f32 v127, 0, v127
    v_mul_f32 v120, v120, v120
    v_mul_f32 v121, v121, v121
    v_mfma_f32_32x32x16_bf16 v[80:95], v[60:63], v[204:207], v[80:95]
    ds_read_b64_tr_b16 v[52:53], v21 offset:10240
    s_nop 0
L_pad_P_58:
    s_cbranch_execz L_ret_P
    ds_read_b64_tr_b16 v[54:55], v21 offset:10752
    s_add_u32 s61, s61, 7168
    buffer_load_dwordx4 v6, s[24:27], s61 offen offset:1024 lds
    v_mul_f32 v122, v122, v122
    v_mul_f32 v123, v123, v123
    s_waitcnt lgkmcnt(4)
    v_mfma_f32_32x32x16_bf16 v[64:79], v[40:43], v[208:211], v[64:79]
    ds_read_b64_tr_b16 v[56:57], v20 offset:12288
    ds_read_b64_tr_b16 v[58:59], v20 offset:12800
    v_mul_f32 v124, v124, v124
    v_mul_f32 v125, v125, v125
    v_mul_f32 v126, v126, v126
    v_mul_f32 v127, v127, v127
    v_mfma_f32_32x32x16_bf16 v[80:95], v[44:47], v[208:211], v[80:95]
    ds_read_b64_tr_b16 v[60:61], v21 offset:12288
    ds_read_b64_tr_b16 v[62:63], v21 offset:12800
    s_add_u32 s61, s61, 7168
    buffer_load_dwordx4 v5, s[24:27], s61 offen offset:2048 lds
    v_cvt_pk_bf16_f32 v120, v120, v121
    v_cvt_pk_bf16_f32 v121, v122, v123
    s_waitcnt lgkmcnt(4)
    v_mfma_f32_32x32x16_bf16 v[64:79], v[48:51], v[212:215], v[64:79]
    ds_read_b64_tr_b16 v[40:41], v20 offset:14336
    ds_read_b64_tr_b16 v[42:43], v20 offset:14848
    s_add_u32 s61, s61, 7168
    buffer_load_dwordx4 v6, s[24:27], s61 offen offset:3072 lds
    v_cvt_pk_bf16_f32 v122, v124, v125
    v_cvt_pk_bf16_f32 v123, v126, v127
    v_mfma_f32_32x32x16_bf16 v[80:95], v[52:55], v[212:215], v[80:95]
    ds_read_b64_tr_b16 v[44:45], v21 offset:14336
    ds_read_b64_tr_b16 v[46:47], v21 offset:14848
    s_lshl_b32 s78, s75, 5
    s_add_u32 s78, s78, s71
    buffer_store_dwordx4 v[120:123], v2, s[16:19], s78 offen offset:3072 sc1
    s_add_u32 s78, s60, 98304
    v_add_u32 v29, s78, v2
    ds_write_b128 v29, v[120:123] offset:3072
L_pad_P_59:
    s_cbranch_execz L_ret_P
    s_add_u32 s79, s60, 81920
    v_add_u32 v28, s79, v10
    ds_read_b128 a[112:115], v28
    s_add_u32 s79, s60, 81920
    v_add_u32 v28, s79, v11
    ds_read_b128 a[116:119], v28
    s_waitcnt lgkmcnt(7)
    v_mfma_f32_32x32x16_bf16 v[64:79], v[56:59], v[216:219], v[64:79]
    s_waitcnt vmcnt(15)
    s_barrier
    v_add_u32 v20, 65536, v18
    v_add_u32 v21, 65536, v19
    ds_read_b64_tr_b16 v[48:49], v20 offset:49152
    ds_read_b64_tr_b16 v[50:51], v20 offset:49664
    s_add_u32 s79, s60, 81920
    v_add_u32 v28, s79, v12
    ds_read_b128 a[120:123], v28
    s_add_u32 s79, s60, 81920
    v_add_u32 v28, s79, v13
    ds_read_b128 a[124:127], v28
    s_lshl_b32 s78, s57, 4
    buffer_load_dwordx4 v[32:35], off, s[36:39], s78 sc1
    s_add_u32 s79, s60, 0
    v_add_u32 v28, s79, v10
    ds_read_b128 a[128:131], v28
    v_mfma_f32_32x32x16_bf16 v[80:95], v[60:63], v[216:219], v[80:95]
    ds_read_b64_tr_b16 v[52:53], v21 offset:49152
    ds_read_b64_tr_b16 v[54:55], v21 offset:49664
    s_add_u32 m0, s60, 49152
    s_xor_b32 s61, s70, 128
    buffer_load_dwordx4 v5, s[28:31], s61 offen offset:0 lds
    s_add_u32 s79, s60, 0
    v_add_u32 v28, s79, v11
    ds_read_b128 a[132:135], v28
    s_add_u32 s79, s60, 0
    v_add_u32 v28, s79, v12
    ds_read_b128 a[136:139], v28
    s_waitcnt lgkmcnt(12)
    v_mfma_f32_32x32x16_bf16 v[64:79], v[40:43], v[220:223], v[64:79]
L_pad_P_60:
    s_cbranch_execz L_ret_P
    ds_read_b64_tr_b16 v[56:57], v20 offset:51200
    ds_read_b64_tr_b16 v[58:59], v20 offset:51712
    s_add_u32 s79, s60, 0
    v_add_u32 v28, s79, v13
    ds_read_b128 a[140:143], v28
    v_mfma_f32_32x32x16_bf16 v[80:95], v[44:47], v[220:223], v[80:95]
    ds_read_b64_tr_b16 v[60:61], v21 offset:51200
    ds_read_b64_tr_b16 v[62:63], v21 offset:51712
    s_add_u32 s61, s61, 7168
    buffer_load_dwordx4 v6, s[28:31], s61 offen offset:1024 lds
    s_waitcnt lgkmcnt(7)
    v_mfma_f32_32x32x16_bf16 v[64:79], v[48:51], v[224:227], v[64:79]
    ds_read_b64_tr_b16 v[40:41], v20 offset:53248
    ds_read_b64_tr_b16 v[42:43], v20 offset:53760
    v_mfma_f32_32x32x16_bf16 v[80:95], v[52:55], v[224:227], v[80:95]
    ds_read_b64_tr_b16 v[44:45], v21 offset:53248
    ds_read_b64_tr_b16 v[46:47], v21 offset:53760
    s_add_u32 s61, s61, 7168
    buffer_load_dwordx4 v5, s[28:31], s61 offen offset:2048 lds
    s_waitcnt lgkmcnt(4)
    v_mfma_f32_32x32x16_bf16 v[64:79], v[56:59], v[228:231], v[64:79]
    ds_read_b64_tr_b16 v[48:49], v20 offset:55296
    ds_read_b64_tr_b16 v[50:51], v20 offset:55808
    v_mfma_f32_32x32x16_bf16 v[80:95], v[60:63], v[228:231], v[80:95]
    ds_read_b64_tr_b16 v[52:53], v21 offset:55296
    ds_read_b64_tr_b16 v[54:55], v21 offset:55808
    s_add_u32 s61, s61, 7168
    buffer_load_dwordx4 v6, s[28:31], s61 offen offset:3072 lds
    s_waitcnt lgkmcnt(4)
    v_mfma_f32_32x32x16_bf16 v[64:79], v[40:43], v[232:235], v[64:79]
    ds_read_b64_tr_b16 v[56:57], v20 offset:57344
    ds_read_b64_tr_b16 v[58:59], v20 offset:57856
    v_mfma_f32_32x32x16_bf16 v[80:95], v[44:47], v[232:235], v[80:95]
    ds_read_b64_tr_b16 v[60:61], v21 offset:57344
L_pad_P_61:
    s_cbranch_execz L_ret_P
    ds_read_b64_tr_b16 v[62:63], v21 offset:57856
    s_waitcnt lgkmcnt(4)
    v_mfma_f32_32x32x16_bf16 v[64:79], v[48:51], v[236:239], v[64:79]
    ds_read_b64_tr_b16 v[40:41], v20 offset:59392
    ds_read_b64_tr_b16 v[42:43], v20 offset:59904
    v_mfma_f32_32x32x16_bf16 v[80:95], v[52:55], v[236:239], v[80:95]
    ds_read_b64_tr_b16 v[44:45], v21 offset:59392
    ds_read_b64_tr_b16 v[46:47], v21 offset:59904
    s_waitcnt lgkmcnt(4)
    v_mfma_f32_32x32x16_bf16 v[64:79], v[56:59], v[240:243], v[64:79]
    ds_read_b64_tr_b16 v[48:49], v20 offset:61440
    ds_read_b64_tr_b16 v[50:51], v20 offset:61952
    v_mfma_f32_32x32x16_bf16 v[80:95], v[60:63], v[240:243], v[80:95]
    ds_read_b64_tr_b16 v[52:53], v21 offset:61440
    ds_read_b64_tr_b16 v[54:55], v21 offset:61952
    s_waitcnt lgkmcnt(4)
    v_mfma_f32_32x32x16_bf16 v[64:79], v[40:43], v[244:247], v[64:79]
    ds_read_b64_tr_b16 v[56:57], v20 offset:63488
    ds_read_b64_tr_b16 v[58:59], v20 offset:64000
    v_mfma_f32_32x32x16_bf16 v[80:95], v[44:47], v[244:247], v[80:95]
    ds_read_b64_tr_b16 v[60:61], v21 offset:63488
    ds_read_b64_tr_b16 v[62:63], v21 offset:64000
    s_waitcnt lgkmcnt(4)
    v_mfma_f32_32x32x16_bf16 v[64:79], v[48:51], v[248:251], v[64:79]
    s_cmp_lg_u32 s56, 0
    s_cbranch_scc1 L_f4f_ok
    s_waitcnt vmcnt(4)
    v_and_b32 v32, v32, v33
    v_and_b32 v34, v34, v35
    v_and_b32 v32, v32, v34
    s_nop 0
    v_readfirstlane_b32 s61, v32
    s_and_b32 s61, s61, 0x40404040
    s_cmp_eq_u32 s61, 0x40404040
    s_cbranch_scc1 L_f4f_ok
    s_mov_b32 s65, 0x40000
L_f4f:
    s_lshl_b32 s78, s57, 4
    buffer_load_dwordx4 v[32:35], off, s[36:39], s78 sc1
    s_waitcnt vmcnt(0)
L_pad_P_62:
    s_cbranch_execz L_ret_P
    v_and_b32 v32, v32, v33
    v_and_b32 v34, v34, v35
    v_and_b32 v32, v32, v34
    s_nop 0
    v_readfirstlane_b32 s61, v32
    s_and_b32 s61, s61, 0x40404040
    s_cmp_eq_u32 s61, 0x40404040
    s_cbranch_scc1 L_f4f_ok
    s_sleep 1
    s_sub_u32 s65, s65, 1
    s_cbranch_scc0 L_f4f
L_f4f_ok:
    s_waitcnt vmcnt(5)
    s_barrier
    s_cmp_lg_u32 s56, 0
    s_cbranch_scc1 L_fs2381
    s_xor_b32 s78, s101, 4
    v_mov_b32 v37, 2
    s_mov_b64 exec, 1
    buffer_store_dword v37, off, s[16:19], s78 sc1
    s_mov_b64 exec, -1
L_fs2381:
    ds_read_b64_tr_b16 v[40:41], v22 offset:16384
    ds_read_b64_tr_b16 v[42:43], v22 offset:16640
    v_mfma_f32_32x32x16_bf16 v[80:95], v[52:55], v[248:251], v[80:95]
    ds_read_b64_tr_b16 v[44:45], v22 offset:17408
    ds_read_b64_tr_b16 v[46:47], v22 offset:17664
    s_add_u32 m0, s60, 0
    s_lshl_b32 s61, s76, 9
    s_xor_b32 s61, s61, 262144
    s_add_u32 s61, s61, s68
    s_add_u32 s61, s61, s69
    buffer_load_dwordx4 v9, s[20:23], s61 offen offset:0 lds
    s_waitcnt lgkmcnt(4)
    v_mfma_f32_32x32x16_bf16 v[64:79], v[56:59], v[252:255], v[64:79]
    ds_read_b64_tr_b16 v[48:49], v22 offset:18432
    ds_read_b64_tr_b16 v[50:51], v22 offset:18688
    v_mfma_f32_32x32x16_bf16 v[80:95], v[60:63], v[252:255], v[80:95]
    ds_read_b64_tr_b16 v[52:53], v22 offset:19456
    ds_read_b64_tr_b16 v[54:55], v22 offset:19712
    s_add_u32 s61, s61, 7168
    buffer_load_dwordx4 v9, s[20:23], s61 offen offset:1024 lds
    s_waitcnt lgkmcnt(4)
    v_mfma_f32_32x32x16_bf16 v[96:111], a[236:239], a[244:247], 0
    ds_read_b64_tr_b16 v[56:57], v22 offset:20480
L_pad_P_63:
    s_cbranch_execz L_ret_P
    ds_read_b64_tr_b16 v[58:59], v22 offset:20736
    v_mfma_f32_32x32x16_bf16 v[96:111], v[40:43], v[128:131], v[96:111]
    ds_read_b64_tr_b16 v[60:61], v22 offset:21504
    s_add_u32 s61, s61, 7168
    buffer_load_dwordx4 v9, s[20:23], s61 offen offset:2048 lds
    v_mfma_f32_32x32x16_bf16 v[96:111], v[44:47], v[132:135], v[96:111]
    ds_read_b64_tr_b16 v[62:63], v22 offset:21760
    s_waitcnt lgkmcnt(4)
    v_mfma_f32_32x32x16_bf16 v[96:111], v[48:51], v[136:139], v[96:111]
    ds_read_b64_tr_b16 v[40:41], v22 offset:22528
    ds_read_b64_tr_b16 v[42:43], v22 offset:22784
    v_mfma_f32_32x32x16_bf16 v[96:111], v[52:55], v[140:143], v[96:111]
    ds_read_b64_tr_b16 v[44:45], v22 offset:23552
    ds_read_b64_tr_b16 v[46:47], v22 offset:23808
    s_add_u32 s61, s61, 7168
    buffer_load_dwordx4 v9, s[20:23], s61 offen offset:3072 lds
    s_waitcnt lgkmcnt(4)
    v_mfma_f32_32x32x16_bf16 v[96:111], v[56:59], v[144:147], v[96:111]
    ds_read_b64_tr_b16 v[48:49], v22 offset:24576
    ds_read_b64_tr_b16 v[50:51], v22 offset:24832
    v_mul_f32 v64, v30, v64
    v_mul_f32 v65, v30, v65
    v_mul_f32 v66, v30, v66
    v_mul_f32 v67, v30, v67
    v_mfma_f32_32x32x16_bf16 v[96:111], v[60:63], v[148:151], v[96:111]
    ds_read_b64_tr_b16 v[52:53], v22 offset:25600
    ds_read_b64_tr_b16 v[54:55], v22 offset:25856
    v_mul_f32 v68, v30, v68
    v_mul_f32 v69, v30, v69
    v_mul_f32 v70, v30, v70
    v_mul_f32 v71, v30, v71
    s_waitcnt lgkmcnt(4)
    v_mfma_f32_32x32x16_bf16 v[96:111], v[40:43], v[152:155], v[96:111]
    ds_read_b64_tr_b16 v[56:57], v22 offset:26624
    ds_read_b64_tr_b16 v[58:59], v22 offset:26880
    v_max_f32 v64, 0, v64
    v_max_f32 v65, 0, v65
    v_max_f32 v66, 0, v66
    v_max_f32 v67, 0, v67
L_pad_G_0:
    s_cbranch_execz L_ret_G
    v_mfma_f32_32x32x16_bf16 v[96:111], v[44:47], v[156:159], v[96:111]
    ds_read_b64_tr_b16 v[60:61], v22 offset:27648
    ds_read_b64_tr_b16 v[62:63], v22 offset:27904
    v_max_f32 v68, 0, v68
    v_max_f32 v69, 0, v69
    v_max_f32 v70, 0, v70
    v_max_f32 v71, 0, v71
    s_waitcnt lgkmcnt(4)
    v_mfma_f32_32x32x16_bf16 v[96:111], v[48:51], v[160:163], v[96:111]
    ds_read_b64_tr_b16 v[40:41], v22 offset:28672
    ds_read_b64_tr_b16 v[42:43], v22 offset:28928
    v_mul_f32 v64, v64, v64
    v_mul_f32 v65, v65, v65
    v_mul_f32 v66, v66, v66
    v_mul_f32 v67, v67, v67
    v_mfma_f32_32x32x16_bf16 v[96:111], v[52:55], v[164:167], v[96:111]
    ds_read_b64_tr_b16 v[44:45], v22 offset:29696
    ds_read_b64_tr_b16 v[46:47], v22 offset:29952
    v_mul_f32 v68, v68, v68
    v_mul_f32 v69, v69, v69
    v_mul_f32 v70, v70, v70
    v_mul_f32 v71, v71, v71
    s_waitcnt lgkmcnt(4)
    v_mfma_f32_32x32x16_bf16 v[96:111], v[56:59], v[168:171], v[96:111]
    ds_read_b64_tr_b16 v[48:49], v22 offset:30720
    ds_read_b64_tr_b16 v[50:51], v22 offset:30976
    v_cvt_pk_bf16_f32 v64, v64, v65
    v_cvt_pk_bf16_f32 v65, v66, v67
    v_cvt_pk_bf16_f32 v66, v68, v69
    v_cvt_pk_bf16_f32 v67, v70, v71
    v_mfma_f32_32x32x16_bf16 v[96:111], v[60:63], v[172:175], v[96:111]
    ds_read_b64_tr_b16 v[52:53], v22 offset:31744
    ds_read_b64_tr_b16 v[54:55], v22 offset:32000
    s_lshl_b32 s78, s76, 5
    s_add_u32 s78, s78, s71
    buffer_store_dwordx4 v[64:67], v2, s[16:19], s78 offen offset:0 sc1
    s_add_u32 s78, s60, 81920
    v_add_u32 v29, s78, v2
    ds_write_b128 v29, v[64:67] offset:0
    v_mul_f32 v72, v30, v72
    v_mul_f32 v73, v30, v73
L_pad_G_1:
    s_cbranch_execz L_ret_G
    s_waitcnt lgkmcnt(5)
    v_mfma_f32_32x32x16_bf16 v[96:111], v[40:43], v[176:179], v[96:111]
    s_barrier
    ds_read_b64_tr_b16 v[56:57], v22 offset:32768
    ds_read_b64_tr_b16 v[58:59], v22 offset:33024
    buffer_load_dword v38, off, s[16:19], s101 sc1
    v_mul_f32 v74, v30, v74
    v_mul_f32 v75, v30, v75
    v_mul_f32 v76, v30, v76
    v_mfma_f32_32x32x16_bf16 v[96:111], v[44:47], v[180:183], v[96:111]
    ds_read_b64_tr_b16 v[60:61], v22 offset:33792
    ds_read_b64_tr_b16 v[62:63], v22 offset:34048
    v_mul_f32 v77, v30, v77
    v_mul_f32 v78, v30, v78
    v_mul_f32 v79, v30, v79
    v_max_f32 v72, 0, v72
    s_waitcnt lgkmcnt(5)
    v_mfma_f32_32x32x16_bf16 v[96:111], v[48:51], v[184:187], v[96:111]
    ds_read_b64_tr_b16 v[40:41], v22 offset:34816
    ds_read_b64_tr_b16 v[42:43], v22 offset:35072
    v_max_f32 v73, 0, v73
    v_max_f32 v74, 0, v74
    v_max_f32 v75, 0, v75
    v_max_f32 v76, 0, v76
    v_mfma_f32_32x32x16_bf16 v[96:111], v[52:55], v[188:191], v[96:111]
    ds_read_b64_tr_b16 v[44:45], v22 offset:35840
    ds_read_b64_tr_b16 v[46:47], v22 offset:36096
    v_max_f32 v77, 0, v77
    v_max_f32 v78, 0, v78
    v_max_f32 v79, 0, v79
    v_mul_f32 v72, v72, v72
    s_waitcnt lgkmcnt(4)
    v_mfma_f32_32x32x16_bf16 v[96:111], v[56:59], v[192:195], v[96:111]
    ds_read_b64_tr_b16 v[48:49], v22 offset:36864
    ds_read_b64_tr_b16 v[50:51], v22 offset:37120
    v_mul_f32 v73, v73, v73
    v_mul_f32 v74, v74, v74
    v_mul_f32 v75, v75, v75
    v_mul_f32 v76, v76, v76
    v_mfma_f32_32x32x16_bf16 v[96:111], v[60:63], v[196:199], v[96:111]
    ds_read_b64_tr_b16 v[52:53], v22 offset:37888
    ds_read_b64_tr_b16 v[54:55], v22 offset:38144
    v_mul_f32 v77, v77, v77
    v_mul_f32 v78, v78, v78
L_pad_G_2:
    s_cbranch_execz L_ret_G
    v_mul_f32 v79, v79, v79
    v_cvt_pk_bf16_f32 v72, v72, v73
    s_waitcnt lgkmcnt(4)
    v_mfma_f32_32x32x16_bf16 v[96:111], v[40:43], v[200:203], v[96:111]
    ds_read_b64_tr_b16 v[56:57], v22 offset:38912
    ds_read_b64_tr_b16 v[58:59], v22 offset:39168
    v_cvt_pk_bf16_f32 v73, v74, v75
    v_cvt_pk_bf16_f32 v74, v76, v77
    v_cvt_pk_bf16_f32 v75, v78, v79
    s_lshl_b32 s78, s76, 5
    s_add_u32 s78, s78, s71
    buffer_store_dwordx4 v[72:75], v2, s[16:19], s78 offen offset:1024 sc1
    v_mfma_f32_32x32x16_bf16 v[96:111], v[44:47], v[204:207], v[96:111]
    ds_read_b64_tr_b16 v[60:61], v22 offset:39936
    ds_read_b64_tr_b16 v[62:63], v22 offset:40192
    s_add_u32 s78, s60, 81920
    v_add_u32 v29, s78, v2
    ds_write_b128 v29, v[72:75] offset:1024
    v_mul_f32 v80, v30, v80
    v_mul_f32 v81, v30, v81
    v_mul_f32 v82, v30, v82
    s_waitcnt lgkmcnt(5)
    v_mfma_f32_32x32x16_bf16 v[96:111], v[48:51], v[208:211], v[96:111]
    ds_read_b64_tr_b16 v[40:41], v22 offset:40960
    ds_read_b64_tr_b16 v[42:43], v22 offset:41216
    v_mul_f32 v83, v30, v83
    v_mul_f32 v84, v30, v84
    v_mul_f32 v85, v30, v85
    v_mul_f32 v86, v30, v86
    v_mfma_f32_32x32x16_bf16 v[96:111], v[52:55], v[212:215], v[96:111]
    ds_read_b64_tr_b16 v[44:45], v22 offset:41984
    ds_read_b64_tr_b16 v[46:47], v22 offset:42240
    v_mul_f32 v87, v30, v87
    v_max_f32 v80, 0, v80
    v_max_f32 v81, 0, v81
    v_max_f32 v82, 0, v82
    s_waitcnt lgkmcnt(5)
    v_mfma_f32_32x32x16_bf16 v[96:111], v[56:59], v[216:219], v[96:111]
    ds_read_b64_tr_b16 v[48:49], v22 offset:43008
    ds_read_b64_tr_b16 v[50:51], v22 offset:43264
    v_max_f32 v83, 0, v83
L_pad_G_3:
    s_cbranch_execz L_ret_G
    v_max_f32 v84, 0, v84
    v_max_f32 v85, 0, v85
    v_max_f32 v86, 0, v86
    v_mfma_f32_32x32x16_bf16 v[96:111], v[60:63], v[220:223], v[96:111]
    ds_read_b64_tr_b16 v[52:53], v22 offset:44032
    ds_read_b64_tr_b16 v[54:55], v22 offset:44288
    v_max_f32 v87, 0, v87
    v_mul_f32 v80, v80, v80
    v_mul_f32 v81, v81, v81
    v_mul_f32 v82, v82, v82
    s_waitcnt lgkmcnt(4)
    v_mfma_f32_32x32x16_bf16 v[96:111], v[40:43], v[224:227], v[96:111]
    ds_read_b64_tr_b16 v[56:57], v22 offset:45056
    ds_read_b64_tr_b16 v[58:59], v22 offset:45312
    v_mul_f32 v83, v83, v83
    v_mul_f32 v84, v84, v84
    v_mul_f32 v85, v85, v85
    v_mul_f32 v86, v86, v86
    v_mfma_f32_32x32x16_bf16 v[96:111], v[44:47], v[228:231], v[96:111]
    ds_read_b64_tr_b16 v[60:61], v22 offset:46080
    ds_read_b64_tr_b16 v[62:63], v22 offset:46336
    v_mul_f32 v87, v87, v87
    v_cvt_pk_bf16_f32 v80, v80, v81
    v_cvt_pk_bf16_f32 v81, v82, v83
    v_cvt_pk_bf16_f32 v82, v84, v85
    s_waitcnt lgkmcnt(4)
    v_mfma_f32_32x32x16_bf16 v[96:111], v[48:51], v[232:235], v[96:111]
    ds_read_b64_tr_b16 v[40:41], v22 offset:47104
    ds_read_b64_tr_b16 v[42:43], v22 offset:47360
    v_cvt_pk_bf16_f32 v83, v86, v87
    s_lshl_b32 s78, s76, 5
    s_add_u32 s78, s78, s71
    buffer_store_dwordx4 v[80:83], v2, s[16:19], s78 offen offset:2048 sc1
    s_add_u32 s78, s60, 81920
    v_add_u32 v29, s78, v2
    ds_write_b128 v29, v[80:83] offset:2048
    v_mul_f32 v88, v30, v88
    v_mfma_f32_32x32x16_bf16 v[96:111], v[52:55], v[236:239], v[96:111]
    ds_read_b64_tr_b16 v[44:45], v22 offset:48128
    ds_read_b64_tr_b16 v[46:47], v22 offset:48384
    v_mul_f32 v89, v30, v89
L_pad_G_4:
    s_cbranch_execz L_ret_G
    v_mul_f32 v90, v30, v90
    v_mul_f32 v91, v30, v91
    v_mul_f32 v92, v30, v92
    s_waitcnt lgkmcnt(5)
    v_mfma_f32_32x32x16_bf16 v[96:111], v[56:59], v[240:243], v[96:111]
    v_mul_f32 v93, v30, v93
    v_mul_f32 v94, v30, v94
    v_mul_f32 v95, v30, v95
    v_max_f32 v88, 0, v88
    v_mfma_f32_32x32x16_bf16 v[96:111], v[60:63], v[244:247], v[96:111]
    v_max_f32 v89, 0, v89
    v_max_f32 v90, 0, v90
    v_max_f32 v91, 0, v91
    v_max_f32 v92, 0, v92
    s_waitcnt lgkmcnt(0)
    v_mfma_f32_32x32x16_bf16 v[96:111], v[40:43], v[248:251], v[96:111]
    v_max_f32 v93, 0, v93
    v_max_f32 v94, 0, v94
    v_max_f32 v95, 0, v95
    v_mul_f32 v88, v88, v88
    v_mfma_f32_32x32x16_bf16 v[96:111], v[44:47], v[252:255], v[96:111]
    v_mul_f32 v89, v89, v89
    v_mul_f32 v90, v90, v90
    v_mul_f32 v91, v91, v91
    v_mul_f32 v92, v92, v92
    v_mul_f32 v93, v93, v93
    v_mul_f32 v94, v94, v94
    v_mul_f32 v95, v95, v95
    v_cvt_pk_bf16_f32 v88, v88, v89
    v_cvt_pk_bf16_f32 v89, v90, v91
    v_cvt_pk_bf16_f32 v90, v92, v93
    v_cvt_pk_bf16_f32 v91, v94, v95
    s_lshl_b32 s78, s76, 5
    s_add_u32 s78, s78, s71
    buffer_store_dwordx4 v[88:91], v2, s[16:19], s78 offen offset:3072 sc1
    s_add_u32 s78, s60, 81920
    v_add_u32 v29, s78, v2
    ds_write_b128 v29, v[88:91] offset:3072
    s_add_u32 s79, s60, 65536
    v_add_u32 v28, s79, v10
    ds_read_b128 a[144:147], v28
    s_add_u32 s79, s60, 65536
    v_add_u32 v28, s79, v11
    ds_read_b128 a[148:151], v28
    s_add_u32 s79, s60, 65536
    v_add_u32 v28, s79, v12
    s_nop 0
L_pad_G_5:
    s_cbranch_execz L_ret_G
    ds_read_b128 a[152:155], v28
    s_add_u32 s79, s60, 65536
    v_add_u32 v28, s79, v13
    ds_read_b128 a[156:159], v28
R_F1:
    v_lshrrev_b32 v221, 2, v1
    v_lshlrev_b32 v221, 10, v221
    v_and_b32 v240, 48, v2
    v_add_u32 v221, v221, v240
    s_add_u32 s78, s66, 0
    s_and_b32 s78, s78, 3
    s_lshl_b32 s78, s78, 12
    v_add_u32 v240, s78, v2
    s_add_u32 s78, s66, 1
    s_and_b32 s78, s78, 3
    s_lshl_b32 s78, s78, 12
    v_add_u32 v241, s78, v2
    s_add_u32 s78, s66, 2
    s_and_b32 s78, s78, 3
    s_lshl_b32 s78, s78, 12
    v_add_u32 v242, s78, v2
    s_add_u32 s78, s66, 3
    s_and_b32 s78, s78, 3
    s_lshl_b32 s78, s78, 12
    v_add_u32 v243, s78, v2
    s_nop 7
    v_mul_f32 v96, v30, v96
    v_mul_f32 v97, v30, v97
    v_mul_f32 v98, v30, v98
    v_mul_f32 v99, v30, v99
    v_mul_f32 v100, v30, v100
    v_mul_f32 v101, v30, v101
    v_mul_f32 v102, v30, v102
    v_mul_f32 v103, v30, v103
    v_max_f32 v96, 0, v96
    v_max_f32 v97, 0, v97
    v_max_f32 v98, 0, v98
    v_max_f32 v99, 0, v99
    v_max_f32 v100, 0, v100
    v_max_f32 v101, 0, v101
    v_max_f32 v102, 0, v102
    v_max_f32 v103, 0, v103
    v_mul_f32 v96, v96, v96
    v_mul_f32 v97, v97, v97
    v_mul_f32 v98, v98, v98
    v_mul_f32 v99, v99, v99
    v_mul_f32 v100, v100, v100
    v_mul_f32 v101, v101, v101
    v_mul_f32 v102, v102, v102
    v_mul_f32 v103, v103, v103
    v_cvt_pk_bf16_f32 v96, v96, v97
    v_cvt_pk_bf16_f32 v97, v98, v99
    v_cvt_pk_bf16_f32 v98, v100, v101
    v_cvt_pk_bf16_f32 v99, v102, v103
    s_lshl_b32 s78, s77, 5
    s_add_u32 s78, s78, s71
    s_nop 0
L_pad_G_6:
    s_cbranch_execz L_ret_G
    buffer_store_dwordx4 v[96:99], v2, s[16:19], s78 offen offset:0 sc1
    s_add_u32 s78, s60, 131072
    v_add_u32 v29, s78, v2
    ds_write_b128 v29, v[96:99] offset:0
    v_mul_f32 v104, v30, v104
    v_mul_f32 v105, v30, v105
    v_mul_f32 v106, v30, v106
    v_mul_f32 v107, v30, v107
    v_mul_f32 v108, v30, v108
    v_mul_f32 v109, v30, v109
    v_mul_f32 v110, v30, v110
    v_mul_f32 v111, v30, v111
    v_max_f32 v104, 0, v104
    v_max_f32 v105, 0, v105
    v_max_f32 v106, 0, v106
    v_max_f32 v107, 0, v107
    v_max_f32 v108, 0, v108
    v_max_f32 v109, 0, v109
    v_max_f32 v110, 0, v110
    v_max_f32 v111, 0, v111
    v_mul_f32 v104, v104, v104
    v_mul_f32 v105, v105, v105
    v_mul_f32 v106, v106, v106
    v_mul_f32 v107, v107, v107
    v_mul_f32 v108, v108, v108
    v_mul_f32 v109, v109, v109
    v_mul_f32 v110, v110, v110
    v_mul_f32 v111, v111, v111
    v_cvt_pk_bf16_f32 v104, v104, v105
    v_cvt_pk_bf16_f32 v105, v106, v107
    v_cvt_pk_bf16_f32 v106, v108, v109
    v_cvt_pk_bf16_f32 v107, v110, v111
    s_lshl_b32 s78, s77, 5
    s_add_u32 s78, s78, s71
    buffer_store_dwordx4 v[104:107], v2, s[16:19], s78 offen offset:1024 sc1
    s_add_u32 s78, s60, 131072
    v_add_u32 v29, s78, v2
    ds_write_b128 v29, v[104:107] offset:1024
    s_cmp_lg_u32 s56, 0
    s_cbranch_scc1 L_g1f_ok
    s_waitcnt vmcnt(5)
    v_readfirstlane_b32 s61, v38
    s_cmp_ge_u32 s61, 2
    s_cbranch_scc1 L_g1f_ok
    s_mov_b32 s65, 0x40000
L_g1f:
    buffer_load_dword v38, off, s[16:19], s101 sc1
    s_waitcnt vmcnt(0)
    v_readfirstlane_b32 s61, v38
    s_cmp_ge_u32 s61, 2
    s_cbranch_scc1 L_g1f_ok
    s_sleep 1
L_pad_G_7:
    s_cbranch_execz L_ret_G
    s_sub_u32 s65, s65, 1
    s_cbranch_scc0 L_g1f
L_g1f_ok:
    s_waitcnt lgkmcnt(0)
    s_waitcnt vmcnt(7)
    s_barrier
    v_add_u32 v244, 131072, v240
    v_add_u32 v245, 131072, v241
    v_add_u32 v246, 131072, v242
    v_add_u32 v247, 131072, v243
    ds_read_b128 v[40:43], v244 offset:16384
    ds_read_b128 v[44:47], v245 offset:16384
    ds_read_b128 v[48:51], v246 offset:16384
    ds_read_b128 v[52:55], v247 offset:16384
    s_waitcnt lgkmcnt(2)
    v_mfma_f32_32x32x16_bf16 v[128:143], a[0:3], v[40:43], 0
    ds_read_b128 v[56:59], v244 offset:17408
    buffer_load_dwordx2 v[112:113], off, s[16:19], s82 offset:8 sc1
    s_add_u32 s79, s60, 49152
    v_add_u32 v28, s79, v10
    ds_read_b128 a[160:163], v28
    s_add_u32 s79, s60, 49152
    v_add_u32 v28, s79, v11
    ds_read_b128 a[164:167], v28
    s_add_u32 s79, s60, 49152
    v_add_u32 v28, s79, v12
    ds_read_b128 a[168:171], v28
    v_mfma_f32_32x32x16_bf16 v[144:159], a[0:3], v[44:47], 0
    ds_read_b128 v[60:63], v245 offset:17408
    s_add_u32 m0, s60, 114688
    s_xor_b32 s61, s74, 512
    s_lshl_b32 s61, s61, 5
    s_add_u32 s61, s61, s71
    buffer_load_dwordx4 v2, s[16:19], s61 offen offset:0 sc1 lds
    s_add_u32 s79, s60, 49152
    v_add_u32 v28, s79, v13
    ds_read_b128 a[172:175], v28
    ds_read_b64_tr_b16 a[96:97], v24 offset:0
    s_waitcnt lgkmcnt(7)
L_pad_G_8:
    s_cbranch_execz L_ret_G
    v_mfma_f32_32x32x16_bf16 v[160:175], a[0:3], v[48:51], 0
    ds_read_b128 v[40:43], v246 offset:17408
    ds_read_b64_tr_b16 a[98:99], v24 offset:1024
    ds_read_b64_tr_b16 a[100:101], v24 offset:2048
    ds_read_b64_tr_b16 a[102:103], v24 offset:3072
    ds_read_b64_tr_b16 a[104:105], v24 offset:8192
    v_mfma_f32_32x32x16_bf16 v[176:191], a[0:3], v[52:55], 0
    ds_read_b128 v[44:47], v247 offset:17408
    buffer_load_dwordx4 v2, s[16:19], s61 offen offset:1024 sc1 lds
    ds_read_b64_tr_b16 a[106:107], v24 offset:9216
    ds_read_b64_tr_b16 a[108:109], v24 offset:10240
    s_waitcnt lgkmcnt(10)
    v_mfma_f32_32x32x16_bf16 v[128:143], a[4:7], v[56:59], v[128:143]
    ds_read_b128 v[48:51], v244 offset:18432
    ds_read_b64_tr_b16 a[110:111], v24 offset:11264
    v_mfma_f32_32x32x16_bf16 v[144:159], a[4:7], v[60:63], v[144:159]
    ds_read_b128 v[52:55], v245 offset:18432
    buffer_load_dwordx4 v2, s[16:19], s61 offen offset:2048 sc1 lds
    s_waitcnt lgkmcnt(5)
    v_mfma_f32_32x32x16_bf16 v[160:175], a[4:7], v[40:43], v[160:175]
    ds_read_b128 v[56:59], v246 offset:18432
    buffer_load_dwordx4 v2, s[16:19], s61 offen offset:3072 sc1 lds
    v_mfma_f32_32x32x16_bf16 v[176:191], a[4:7], v[44:47], v[176:191]
    ds_read_b128 v[60:63], v247 offset:18432
    s_add_u32 m0, s60, 65536
    s_xor_b32 s61, s75, 512
    s_lshl_b32 s61, s61, 5
    s_add_u32 s61, s61, s71
    buffer_load_dwordx4 v2, s[16:19], s61 offen offset:0 sc1 lds
    s_waitcnt lgkmcnt(2)
    v_mfma_f32_32x32x16_bf16 v[128:143], a[8:11], v[48:51], v[128:143]
    ds_read_b128 v[40:43], v244 offset:19456
    buffer_load_dwordx4 v2, s[16:19], s61 offen offset:1024 sc1 lds
    v_mfma_f32_32x32x16_bf16 v[144:159], a[8:11], v[52:55], v[144:159]
L_pad_G_9:
    s_cbranch_execz L_ret_G
    ds_read_b128 v[44:47], v245 offset:19456
    buffer_load_dwordx4 v2, s[16:19], s61 offen offset:2048 sc1 lds
    s_waitcnt lgkmcnt(2)
    v_mfma_f32_32x32x16_bf16 v[160:175], a[8:11], v[56:59], v[160:175]
    ds_read_b128 v[48:51], v246 offset:19456
    buffer_load_dwordx4 v2, s[16:19], s61 offen offset:3072 sc1 lds
    v_mfma_f32_32x32x16_bf16 v[176:191], a[8:11], v[60:63], v[176:191]
    ds_read_b128 v[52:55], v247 offset:19456
    s_waitcnt lgkmcnt(2)
    v_mfma_f32_32x32x16_bf16 v[128:143], a[12:15], v[40:43], v[128:143]
    s_barrier
    v_add_u32 v244, 65536, v240
    v_add_u32 v245, 65536, v241
    v_add_u32 v246, 65536, v242
    v_add_u32 v247, 65536, v243
    ds_read_b128 v[56:59], v244 offset:32768
    v_mfma_f32_32x32x16_bf16 v[144:159], a[12:15], v[44:47], v[144:159]
    ds_read_b128 v[60:63], v245 offset:32768
    s_waitcnt lgkmcnt(2)
    v_mfma_f32_32x32x16_bf16 v[160:175], a[12:15], v[48:51], v[160:175]
    ds_read_b128 v[40:43], v246 offset:32768
    v_mfma_f32_32x32x16_bf16 v[176:191], a[12:15], v[52:55], v[176:191]
    ds_read_b128 v[44:47], v247 offset:32768
    s_waitcnt lgkmcnt(2)
    v_mfma_f32_32x32x16_bf16 v[128:143], a[16:19], v[56:59], v[128:143]
    ds_read_b128 v[48:51], v244 offset:33792
    v_mfma_f32_32x32x16_bf16 v[144:159], a[16:19], v[60:63], v[144:159]
    ds_read_b128 v[52:55], v245 offset:33792
    s_waitcnt lgkmcnt(2)
    v_mfma_f32_32x32x16_bf16 v[160:175], a[16:19], v[40:43], v[160:175]
    ds_read_b128 v[56:59], v246 offset:33792
    v_mfma_f32_32x32x16_bf16 v[176:191], a[16:19], v[44:47], v[176:191]
    ds_read_b128 v[60:63], v247 offset:33792
    s_waitcnt lgkmcnt(2)
    v_mfma_f32_32x32x16_bf16 v[128:143], a[20:23], v[48:51], v[128:143]
L_pad_G_10:
    s_cbranch_execz L_ret_G
    ds_read_b128 v[40:43], v244 offset:34816
    v_mfma_f32_32x32x16_bf16 v[144:159], a[20:23], v[52:55], v[144:159]
    ds_read_b128 v[44:47], v245 offset:34816
    s_waitcnt lgkmcnt(2)
    v_mfma_f32_32x32x16_bf16 v[160:175], a[20:23], v[56:59], v[160:175]
    ds_read_b128 v[48:51], v246 offset:34816
    v_mfma_f32_32x32x16_bf16 v[176:191], a[20:23], v[60:63], v[176:191]
    ds_read_b128 v[52:55], v247 offset:34816
    s_waitcnt lgkmcnt(2)
    v_mfma_f32_32x32x16_bf16 v[128:143], a[24:27], v[40:43], v[128:143]
    ds_read_b128 v[56:59], v244 offset:35840
    v_mfma_f32_32x32x16_bf16 v[144:159], a[24:27], v[44:47], v[144:159]
    ds_read_b128 v[60:63], v245 offset:35840
    s_waitcnt lgkmcnt(2)
    v_mfma_f32_32x32x16_bf16 v[160:175], a[24:27], v[48:51], v[160:175]
    ds_read_b128 v[40:43], v246 offset:35840
    v_mfma_f32_32x32x16_bf16 v[176:191], a[24:27], v[52:55], v[176:191]
    ds_read_b128 v[44:47], v247 offset:35840
    s_waitcnt lgkmcnt(2)
    v_mfma_f32_32x32x16_bf16 v[128:143], a[28:31], v[56:59], v[128:143]
    s_waitcnt vmcnt(11)
    s_cmp_lg_u32 s56, 0
    s_cbranch_scc1 L_gtf0_ok
    s_waitcnt vmcnt(8)
    v_min_u32 v112, v112, v113
    s_nop 0
    v_readfirstlane_b32 s61, v112
    s_cmp_ge_u32 s61, 1
    s_cbranch_scc1 L_gtf0_ok
    s_mov_b32 s65, 0x40000
L_gtf0:
    buffer_load_dwordx2 v[112:113], off, s[16:19], s82 offset:8 sc1
    s_waitcnt vmcnt(0)
    v_min_u32 v112, v112, v113
    s_nop 0
    v_readfirstlane_b32 s61, v112
    s_cmp_ge_u32 s61, 1
    s_cbranch_scc1 L_gtf0_ok
    s_sleep 1
    s_sub_u32 s65, s65, 1
    s_cbranch_scc0 L_gtf0
L_gtf0_ok:
    s_barrier
    s_cmp_lg_u32 s56, 0
    s_cbranch_scc1 L_fs2923
    s_xor_b32 s78, s101, 4
    v_mov_b32 v37, 3
L_pad_G_11:
    s_cbranch_execz L_ret_G
    s_mov_b64 exec, 1
    buffer_store_dword v37, off, s[16:19], s78 sc1
    s_mov_b64 exec, -1
L_fs2923:
    ds_read_b128 v[48:51], v244 offset:16384
    s_add_u32 m0, s60, 16384
    s_xor_b32 s61, s83, 0
    buffer_load_dwordx4 v2, s[16:19], s61 offen offset:0 sc1 lds
    v_mfma_f32_32x32x16_bf16 v[144:159], a[28:31], v[60:63], v[144:159]
    ds_read_b128 v[52:55], v245 offset:16384
    buffer_load_dwordx4 v2, s[16:19], s61 offen offset:1024 sc1 lds
    s_waitcnt lgkmcnt(2)
    v_mfma_f32_32x32x16_bf16 v[160:175], a[28:31], v[40:43], v[160:175]
    ds_read_b128 v[56:59], v246 offset:16384
    buffer_load_dwordx4 v2, s[16:19], s61 offen offset:2048 sc1 lds
    v_mfma_f32_32x32x16_bf16 v[176:191], a[28:31], v[44:47], v[176:191]
    ds_read_b128 v[60:63], v247 offset:16384
    buffer_load_dwordx4 v2, s[16:19], s61 offen offset:3072 sc1 lds
    s_waitcnt lgkmcnt(2)
    v_mfma_f32_32x32x16_bf16 v[128:143], a[32:35], v[48:51], v[128:143]
    ds_read_b128 v[40:43], v244 offset:17408
    s_add_u32 m0, s60, 49152
    s_xor_b32 s61, s83, 4096
    buffer_load_dwordx4 v2, s[16:19], s61 offen offset:0 sc1 lds
    v_mfma_f32_32x32x16_bf16 v[144:159], a[32:35], v[52:55], v[144:159]
    ds_read_b128 v[44:47], v245 offset:17408
    buffer_load_dwordx4 v2, s[16:19], s61 offen offset:1024 sc1 lds
    s_waitcnt lgkmcnt(2)
    v_mfma_f32_32x32x16_bf16 v[160:175], a[32:35], v[56:59], v[160:175]
    ds_read_b128 v[48:51], v246 offset:17408
    buffer_load_dwordx4 v2, s[16:19], s61 offen offset:2048 sc1 lds
    v_mfma_f32_32x32x16_bf16 v[176:191], a[32:35], v[60:63], v[176:191]
    ds_read_b128 v[52:55], v247 offset:17408
    buffer_load_dwordx4 v2, s[16:19], s61 offen offset:3072 sc1 lds
    s_waitcnt lgkmcnt(2)
    v_mfma_f32_32x32x16_bf16 v[128:143], a[36:39], v[40:43], v[128:143]
L_pad_G_12:
    s_cbranch_execz L_ret_G
    ds_read_b128 v[56:59], v244 offset:18432
    s_add_u32 m0, s60, 0
    s_xor_b32 s61, s83, 8192
    buffer_load_dwordx4 v2, s[16:19], s61 offen offset:0 sc1 lds
    v_mfma_f32_32x32x16_bf16 v[144:159], a[36:39], v[44:47], v[144:159]
    ds_read_b128 v[60:63], v245 offset:18432
    buffer_load_dwordx4 v2, s[16:19], s61 offen offset:1024 sc1 lds
    s_waitcnt lgkmcnt(2)
    v_mfma_f32_32x32x16_bf16 v[160:175], a[36:39], v[48:51], v[160:175]
    ds_read_b128 v[40:43], v246 offset:18432
    buffer_load_dwordx4 v2, s[16:19], s61 offen offset:2048 sc1 lds
    v_mfma_f32_32x32x16_bf16 v[176:191], a[36:39], v[52:55], v[176:191]
    ds_read_b128 v[44:47], v247 offset:18432
    buffer_load_dwordx4 v2, s[16:19], s61 offen offset:3072 sc1 lds
    s_waitcnt lgkmcnt(2)
    v_mfma_f32_32x32x16_bf16 v[128:143], a[40:43], v[56:59], v[128:143]
    ds_read_b128 v[48:51], v244 offset:19456
    s_add_u32 m0, s60, 32768
    s_xor_b32 s61, s83, 12288
    buffer_load_dwordx4 v2, s[16:19], s61 offen offset:0 sc1 lds
    v_mfma_f32_32x32x16_bf16 v[144:159], a[40:43], v[60:63], v[144:159]
    ds_read_b128 v[52:55], v245 offset:19456
    buffer_load_dwordx4 v2, s[16:19], s61 offen offset:1024 sc1 lds
    s_waitcnt lgkmcnt(2)
    v_mfma_f32_32x32x16_bf16 v[160:175], a[40:43], v[40:43], v[160:175]
    ds_read_b128 v[56:59], v246 offset:19456
    buffer_load_dwordx4 v2, s[16:19], s61 offen offset:2048 sc1 lds
    v_mfma_f32_32x32x16_bf16 v[176:191], a[40:43], v[44:47], v[176:191]
    ds_read_b128 v[60:63], v247 offset:19456
    buffer_load_dwordx4 v2, s[16:19], s61 offen offset:3072 sc1 lds
    s_waitcnt lgkmcnt(2)
    v_mfma_f32_32x32x16_bf16 v[128:143], a[44:47], v[48:51], v[128:143]
    s_waitcnt vmcnt(25)
    s_barrier
    s_cmp_lg_u32 s56, 0
    s_cbranch_scc1 L_fs2997
L_pad_G_13:
    s_cbranch_execz L_ret_G
    s_xor_b32 s78, s101, 4
    v_mov_b32 v37, 4
    s_mov_b64 exec, 1
    buffer_store_dword v37, off, s[16:19], s78 sc1
    s_mov_b64 exec, -1
L_fs2997:
    v_add_u32 v244, 131072, v240
    v_add_u32 v245, 131072, v241
    v_add_u32 v246, 131072, v242
    v_add_u32 v247, 131072, v243
    ds_read_b128 v[40:43], v245 offset:0
    v_mfma_f32_32x32x16_bf16 v[144:159], a[44:47], v[52:55], v[144:159]
    ds_read_b128 v[44:47], v246 offset:0
    s_waitcnt lgkmcnt(2)
    v_mfma_f32_32x32x16_bf16 v[160:175], a[44:47], v[56:59], v[160:175]
    ds_read_b128 v[48:51], v247 offset:0
    v_mfma_f32_32x32x16_bf16 v[176:191], a[44:47], v[60:63], v[176:191]
    ds_read_b128 v[52:55], v245 offset:1024
    s_waitcnt lgkmcnt(2)
    v_mfma_f32_32x32x16_bf16 v[144:159], a[48:51], v[40:43], v[144:159]
    ds_read_b128 v[56:59], v246 offset:1024
    v_mfma_f32_32x32x16_bf16 v[160:175], a[48:51], v[44:47], v[160:175]
    ds_read_b128 v[60:63], v247 offset:1024
    s_waitcnt lgkmcnt(2)
    v_mfma_f32_32x32x16_bf16 v[176:191], a[48:51], v[48:51], v[176:191]
    s_waitcnt vmcnt(20)
    s_barrier
    v_add_u32 v244, 65536, v240
    v_add_u32 v245, 65536, v241
    v_add_u32 v246, 65536, v242
    v_add_u32 v247, 65536, v243
    ds_read_b128 v[40:43], v245 offset:49152
    v_mfma_f32_32x32x16_bf16 v[144:159], a[52:55], v[52:55], v[144:159]
    ds_read_b128 v[44:47], v246 offset:49152
    s_add_u32 m0, s60, 147456
    s_lshl2_add_u32 s61, s57, s66
    s_lshl_b32 s61, s61, 9
    s_lshl2_add_u32 s79, s67, s56
    s_add_u32 s61, s61, s79
L_pad_G_14:
    s_cbranch_execz L_ret_G
    s_lshl_b32 s61, s61, 6
    buffer_load_dwordx4 v221, s[8:11], s61 offen offset:0 lds
    s_waitcnt lgkmcnt(2)
    v_mfma_f32_32x32x16_bf16 v[160:175], a[52:55], v[56:59], v[160:175]
    ds_read_b128 v[48:51], v247 offset:49152
    v_mfma_f32_32x32x16_bf16 v[176:191], a[52:55], v[60:63], v[176:191]
    ds_read_b128 v[52:55], v245 offset:50176
    s_add_u32 s61, s61, 15360
    buffer_load_dwordx4 v221, s[8:11], s61 offen offset:1024 lds
    s_waitcnt lgkmcnt(2)
    v_mfma_f32_32x32x16_bf16 v[144:159], a[64:67], v[40:43], v[144:159]
    ds_read_b128 v[56:59], v246 offset:50176
    buffer_load_dword v114, off, s[16:19], s101 sc1
    v_mfma_f32_32x32x16_bf16 v[160:175], a[64:67], v[44:47], v[160:175]
    ds_read_b128 v[60:63], v247 offset:50176
    s_waitcnt lgkmcnt(2)
    v_mfma_f32_32x32x16_bf16 v[176:191], a[64:67], v[48:51], v[176:191]
    ds_read_b128 v[40:43], v245 offset:51200
    v_and_b32 v218, 31, v1
    s_lshl2_add_u32 s78, s57, s66
    v_lshl_add_u32 v218, s78, 5, v218
    v_lshlrev_b32 v216, 3, v218
    s_lshl_b32 s78, s66, 14
    s_add_u32 s78, s78, 11534336
    buffer_load_dwordx2 v[216:217], v216, s[16:19], s78 offen sc1
    v_and_b32 v219, 15, v1
    s_lshl2_add_u32 s78, s67, s56
    s_lshl_b32 s78, s78, 6
    v_lshl_add_u32 v219, v219, 2, s78
    global_load_dword v200, v219, s[48:49]
    global_load_dword v208, v219, s[46:47]
    v_mfma_f32_32x32x16_bf16 v[144:159], a[68:71], v[52:55], v[144:159]
    ds_read_b128 v[44:47], v246 offset:51200
    s_waitcnt lgkmcnt(2)
    v_mfma_f32_32x32x16_bf16 v[160:175], a[68:71], v[56:59], v[160:175]
    ds_read_b128 v[48:51], v247 offset:51200
    v_mfma_f32_32x32x16_bf16 v[176:191], a[68:71], v[60:63], v[176:191]
    s_nop 0
L_pad_G_15:
    s_cbranch_execz L_ret_G
    ds_read_b128 v[52:55], v245 offset:52224
    s_waitcnt lgkmcnt(2)
    v_mfma_f32_32x32x16_bf16 v[144:159], a[72:75], v[40:43], v[144:159]
    ds_read_b128 v[56:59], v246 offset:52224
    v_mfma_f32_32x32x16_bf16 v[160:175], a[72:75], v[44:47], v[160:175]
    ds_read_b128 v[60:63], v247 offset:52224
    s_waitcnt lgkmcnt(2)
    v_mfma_f32_32x32x16_bf16 v[176:191], a[72:75], v[48:51], v[176:191]
    s_waitcnt vmcnt(22)
    s_barrier
    ds_read_b128 v[40:43], v245 offset:0
    v_mfma_f32_32x32x16_bf16 v[144:159], a[76:79], v[52:55], v[144:159]
    ds_read_b128 v[44:47], v246 offset:0
    s_waitcnt lgkmcnt(2)
    v_mfma_f32_32x32x16_bf16 v[160:175], a[76:79], v[56:59], v[160:175]
    ds_read_b128 v[48:51], v247 offset:0
    v_mfma_f32_32x32x16_bf16 v[176:191], a[76:79], v[60:63], v[176:191]
    ds_read_b128 v[52:55], v245 offset:1024
    s_waitcnt lgkmcnt(2)
    v_mfma_f32_32x32x16_bf16 v[144:159], a[80:83], v[40:43], v[144:159]
    ds_read_b128 v[56:59], v246 offset:1024
    v_mfma_f32_32x32x16_bf16 v[160:175], a[80:83], v[44:47], v[160:175]
    ds_read_b128 v[60:63], v247 offset:1024
    s_waitcnt lgkmcnt(2)
    v_mfma_f32_32x32x16_bf16 v[176:191], a[80:83], v[48:51], v[176:191]
    ds_read_b128 v[40:43], v245 offset:2048
    v_mfma_f32_32x32x16_bf16 v[144:159], a[84:87], v[52:55], v[144:159]
    ds_read_b128 v[44:47], v246 offset:2048
    s_waitcnt lgkmcnt(2)
    v_mfma_f32_32x32x16_bf16 v[160:175], a[84:87], v[56:59], v[160:175]
    ds_read_b128 v[48:51], v247 offset:2048
    v_mfma_f32_32x32x16_bf16 v[176:191], a[84:87], v[60:63], v[176:191]
    ds_read_b128 v[52:55], v245 offset:3072
    s_waitcnt lgkmcnt(2)
    v_mfma_f32_32x32x16_bf16 v[144:159], a[88:91], v[40:43], v[144:159]
    ds_read_b128 v[56:59], v246 offset:3072
L_pad_G_16:
    s_cbranch_execz L_ret_G
    v_mfma_f32_32x32x16_bf16 v[160:175], a[88:91], v[44:47], v[160:175]
    ds_read_b128 v[60:63], v247 offset:3072
    s_waitcnt lgkmcnt(2)
    v_mfma_f32_32x32x16_bf16 v[176:191], a[88:91], v[48:51], v[176:191]
    s_cmp_lg_u32 s56, 0
    s_cbranch_scc1 L_gtf1_ok
    s_waitcnt vmcnt(3)
    v_readfirstlane_b32 s61, v114
    s_cmp_ge_u32 s61, 3
    s_cbranch_scc1 L_gtf1_ok
    s_mov_b32 s65, 0x40000
L_gtf1:
    buffer_load_dword v114, off, s[16:19], s101 sc1
    s_waitcnt vmcnt(0)
    v_readfirstlane_b32 s61, v114
    s_cmp_ge_u32 s61, 3
    s_cbranch_scc1 L_gtf1_ok
    s_sleep 1
    s_sub_u32 s65, s65, 1
    s_cbranch_scc0 L_gtf1
L_gtf1_ok:
    s_waitcnt vmcnt(18)
    s_barrier
    ds_read_b128 v[40:43], v241 offset:16384
    s_add_u32 m0, s60, 98304
    s_xor_b32 s61, s76, 512
    s_lshl_b32 s61, s61, 5
    s_add_u32 s61, s61, s71
    buffer_load_dwordx4 v2, s[16:19], s61 offen offset:0 sc1 lds
    v_mfma_f32_32x32x16_bf16 v[144:159], a[92:95], v[52:55], v[144:159]
    ds_read_b128 v[44:47], v242 offset:16384
    buffer_load_dwordx4 v2, s[16:19], s61 offen offset:1024 sc1 lds
    s_waitcnt lgkmcnt(2)
    v_mfma_f32_32x32x16_bf16 v[160:175], a[92:95], v[56:59], v[160:175]
    ds_read_b128 v[48:51], v243 offset:16384
    v_mfma_f32_32x32x16_bf16 v[176:191], a[92:95], v[60:63], v[176:191]
    ds_read_b128 v[52:55], v241 offset:17408
    buffer_load_dwordx4 v2, s[16:19], s61 offen offset:2048 sc1 lds
    s_waitcnt lgkmcnt(2)
    v_mfma_f32_32x32x16_bf16 v[144:159], a[112:115], v[40:43], v[144:159]
    ds_read_b128 v[56:59], v242 offset:17408
    v_mfma_f32_32x32x16_bf16 v[160:175], a[112:115], v[44:47], v[160:175]
    ds_read_b128 v[60:63], v243 offset:17408
    s_nop 0
L_pad_G_17:
    s_cbranch_execz L_ret_G
    buffer_load_dwordx4 v2, s[16:19], s61 offen offset:3072 sc1 lds
    s_waitcnt lgkmcnt(2)
    v_mfma_f32_32x32x16_bf16 v[176:191], a[112:115], v[48:51], v[176:191]
    ds_read_b128 v[40:43], v241 offset:18432
    v_mfma_f32_32x32x16_bf16 v[144:159], a[116:119], v[52:55], v[144:159]
    ds_read_b128 v[44:47], v242 offset:18432
    s_waitcnt lgkmcnt(2)
    v_mfma_f32_32x32x16_bf16 v[160:175], a[116:119], v[56:59], v[160:175]
    ds_read_b128 v[48:51], v243 offset:18432
    v_mfma_f32_32x32x16_bf16 v[176:191], a[116:119], v[60:63], v[176:191]
    ds_read_b128 v[52:55], v241 offset:19456
    s_waitcnt lgkmcnt(2)
    v_mfma_f32_32x32x16_bf16 v[144:159], a[120:123], v[40:43], v[144:159]
    ds_read_b128 v[56:59], v242 offset:19456
    v_mfma_f32_32x32x16_bf16 v[160:175], a[120:123], v[44:47], v[160:175]
    ds_read_b128 v[60:63], v243 offset:19456
    s_waitcnt lgkmcnt(2)
    v_mfma_f32_32x32x16_bf16 v[176:191], a[120:123], v[48:51], v[176:191]
    s_waitcnt vmcnt(18)
    s_barrier
    ds_read_b128 v[40:43], v241 offset:49152
    buffer_load_dword v116, off, s[16:19], s101 sc1
    v_mfma_f32_32x32x16_bf16 v[144:159], a[124:127], v[52:55], v[144:159]
    ds_read_b128 v[44:47], v242 offset:49152
    s_waitcnt lgkmcnt(2)
    v_mfma_f32_32x32x16_bf16 v[160:175], a[124:127], v[56:59], v[160:175]
    ds_read_b128 v[48:51], v243 offset:49152
    v_mfma_f32_32x32x16_bf16 v[176:191], a[124:127], v[60:63], v[176:191]
    ds_read_b128 v[52:55], v241 offset:50176
    s_waitcnt lgkmcnt(2)
    v_mfma_f32_32x32x16_bf16 v[144:159], a[128:131], v[40:43], v[144:159]
    ds_read_b128 v[56:59], v242 offset:50176
    v_mfma_f32_32x32x16_bf16 v[160:175], a[128:131], v[44:47], v[160:175]
    ds_read_b128 v[60:63], v243 offset:50176
    s_waitcnt lgkmcnt(2)
    v_mfma_f32_32x32x16_bf16 v[176:191], a[128:131], v[48:51], v[176:191]
L_pad_G_18:
    s_cbranch_execz L_ret_G
    ds_read_b128 v[40:43], v241 offset:51200
    v_mfma_f32_32x32x16_bf16 v[144:159], a[132:135], v[52:55], v[144:159]
    ds_read_b128 v[44:47], v242 offset:51200
    s_waitcnt lgkmcnt(2)
    v_mfma_f32_32x32x16_bf16 v[160:175], a[132:135], v[56:59], v[160:175]
    ds_read_b128 v[48:51], v243 offset:51200
    v_mfma_f32_32x32x16_bf16 v[176:191], a[132:135], v[60:63], v[176:191]
    ds_read_b128 v[52:55], v241 offset:52224
    s_waitcnt lgkmcnt(2)
    v_mfma_f32_32x32x16_bf16 v[144:159], a[136:139], v[40:43], v[144:159]
    ds_read_b128 v[56:59], v242 offset:52224
    v_mfma_f32_32x32x16_bf16 v[160:175], a[136:139], v[44:47], v[160:175]
    ds_read_b128 v[60:63], v243 offset:52224
    s_waitcnt lgkmcnt(2)
    v_mfma_f32_32x32x16_bf16 v[176:191], a[136:139], v[48:51], v[176:191]
    s_cmp_lg_u32 s56, 0
    s_cbranch_scc1 L_gtf2_ok
    s_waitcnt vmcnt(0)
    v_readfirstlane_b32 s61, v116
    s_cmp_ge_u32 s61, 4
    s_cbranch_scc1 L_gtf2_ok
    s_mov_b32 s65, 0x40000
L_gtf2:
    buffer_load_dword v116, off, s[16:19], s101 sc1
    s_waitcnt vmcnt(0)
    v_readfirstlane_b32 s61, v116
    s_cmp_ge_u32 s61, 4
    s_cbranch_scc1 L_gtf2_ok
    s_sleep 1
    s_sub_u32 s65, s65, 1
    s_cbranch_scc0 L_gtf2
L_gtf2_ok:
    s_waitcnt vmcnt(15)
    s_barrier
    ds_read_b128 v[40:43], v241 offset:0
    v_mfma_f32_32x32x16_bf16 v[144:159], a[140:143], v[52:55], v[144:159]
    ds_read_b128 v[44:47], v242 offset:0
    s_add_u32 m0, s60, 81920
    s_xor_b32 s61, s77, 64
    s_lshl_b32 s61, s61, 5
    s_add_u32 s61, s61, s71
    buffer_load_dwordx4 v2, s[16:19], s61 offen offset:0 sc1 lds
    s_waitcnt lgkmcnt(2)
    v_mfma_f32_32x32x16_bf16 v[160:175], a[140:143], v[56:59], v[160:175]
    s_nop 0
L_pad_G_19:
    s_cbranch_execz L_ret_G
    ds_read_b128 v[48:51], v243 offset:0
    v_mfma_f32_32x32x16_bf16 v[176:191], a[140:143], v[60:63], v[176:191]
    ds_read_b128 v[52:55], v241 offset:1024
    buffer_load_dwordx4 v2, s[16:19], s61 offen offset:1024 sc1 lds
    s_waitcnt lgkmcnt(2)
    v_mfma_f32_32x32x16_bf16 v[144:159], a[144:147], v[40:43], v[144:159]
    ds_read_b128 v[56:59], v242 offset:1024
    v_mfma_f32_32x32x16_bf16 v[160:175], a[144:147], v[44:47], v[160:175]
    ds_read_b128 v[60:63], v243 offset:1024
    s_waitcnt lgkmcnt(2)
    v_mfma_f32_32x32x16_bf16 v[176:191], a[144:147], v[48:51], v[176:191]
    ds_read_b128 v[40:43], v241 offset:2048
    v_mfma_f32_32x32x16_bf16 v[144:159], a[148:151], v[52:55], v[144:159]
    ds_read_b128 v[44:47], v242 offset:2048
    s_waitcnt lgkmcnt(2)
    v_mfma_f32_32x32x16_bf16 v[160:175], a[148:151], v[56:59], v[160:175]
    ds_read_b128 v[48:51], v243 offset:2048
    v_mfma_f32_32x32x16_bf16 v[176:191], a[148:151], v[60:63], v[176:191]
    ds_read_b128 v[52:55], v241 offset:3072
    s_waitcnt lgkmcnt(2)
    v_mfma_f32_32x32x16_bf16 v[144:159], a[152:155], v[40:43], v[144:159]
    ds_read_b128 v[56:59], v242 offset:3072
    v_mfma_f32_32x32x16_bf16 v[160:175], a[152:155], v[44:47], v[160:175]
    ds_read_b128 v[60:63], v243 offset:3072
    s_waitcnt lgkmcnt(2)
    v_mfma_f32_32x32x16_bf16 v[176:191], a[152:155], v[48:51], v[176:191]
    s_waitcnt vmcnt(13)
    s_barrier
    ds_read_b128 v[40:43], v241 offset:32768
    v_mfma_f32_32x32x16_bf16 v[144:159], a[156:159], v[52:55], v[144:159]
    ds_read_b128 v[44:47], v242 offset:32768
    s_waitcnt lgkmcnt(2)
    v_mfma_f32_32x32x16_bf16 v[160:175], a[156:159], v[56:59], v[160:175]
    ds_read_b128 v[48:51], v243 offset:32768
    v_mfma_f32_32x32x16_bf16 v[176:191], a[156:159], v[60:63], v[176:191]
    s_nop 0
L_pad_G_20:
    s_cbranch_execz L_ret_G
    ds_read_b128 v[52:55], v241 offset:33792
    s_waitcnt lgkmcnt(2)
    v_mfma_f32_32x32x16_bf16 v[144:159], a[160:163], v[40:43], v[144:159]
    ds_read_b128 v[56:59], v242 offset:33792
    v_mfma_f32_32x32x16_bf16 v[160:175], a[160:163], v[44:47], v[160:175]
    ds_read_b128 v[60:63], v243 offset:33792
    s_waitcnt lgkmcnt(2)
    v_mfma_f32_32x32x16_bf16 v[176:191], a[160:163], v[48:51], v[176:191]
    ds_read_b128 v[40:43], v241 offset:34816
    v_mfma_f32_32x32x16_bf16 v[144:159], a[164:167], v[52:55], v[144:159]
    ds_read_b128 v[44:47], v242 offset:34816
    s_waitcnt lgkmcnt(2)
    v_mfma_f32_32x32x16_bf16 v[160:175], a[164:167], v[56:59], v[160:175]
    ds_read_b128 v[48:51], v243 offset:34816
    v_mfma_f32_32x32x16_bf16 v[176:191], a[164:167], v[60:63], v[176:191]
    ds_read_b128 v[52:55], v241 offset:35840
    s_waitcnt lgkmcnt(2)
    v_mfma_f32_32x32x16_bf16 v[144:159], a[168:171], v[40:43], v[144:159]
    ds_read_b128 v[56:59], v242 offset:35840
    s_xor_b32 s78, s101, 4
    s_andn2_b32 s78, s78, 0x300
    v_and_b32 v220, 3, v1
    v_lshlrev_b32 v220, 8, v220
    buffer_load_dword v220, v220, s[16:19], s78 offen sc1
    v_mfma_f32_32x32x16_bf16 v[160:175], a[168:171], v[44:47], v[160:175]
    ds_read_b128 v[60:63], v243 offset:35840
    s_waitcnt lgkmcnt(2)
    v_mfma_f32_32x32x16_bf16 v[176:191], a[168:171], v[48:51], v[176:191]
    s_waitcnt vmcnt(4)
    s_barrier
    ds_read_b128 v[40:43], v245 offset:32768
    v_mfma_f32_32x32x16_bf16 v[144:159], a[172:175], v[52:55], v[144:159]
    ds_read_b128 v[44:47], v246 offset:32768
    s_waitcnt lgkmcnt(2)
    v_mfma_f32_32x32x16_bf16 v[160:175], a[172:175], v[56:59], v[160:175]
    ds_read_b128 v[48:51], v247 offset:32768
    v_mfma_f32_32x32x16_bf16 v[176:191], a[172:175], v[60:63], v[176:191]
L_pad_G_21:
    s_cbranch_execz L_ret_G
    ds_read_b128 v[52:55], v245 offset:33792
    s_waitcnt lgkmcnt(2)
    v_mfma_f32_32x32x16_bf16 v[144:159], a[96:99], v[40:43], v[144:159]
    ds_read_b128 v[56:59], v246 offset:33792
    v_mfma_f32_32x32x16_bf16 v[160:175], a[96:99], v[44:47], v[160:175]
    ds_read_b128 v[60:63], v247 offset:33792
    s_waitcnt lgkmcnt(2)
    v_mfma_f32_32x32x16_bf16 v[176:191], a[96:99], v[48:51], v[176:191]
    ds_read_b128 v[40:43], v245 offset:34816
    v_mfma_f32_32x32x16_bf16 v[144:159], a[100:103], v[52:55], v[144:159]
    ds_read_b128 v[44:47], v246 offset:34816
    s_waitcnt lgkmcnt(2)
    v_mfma_f32_32x32x16_bf16 v[160:175], a[100:103], v[56:59], v[160:175]
    ds_read_b128 v[48:51], v247 offset:34816
    v_mfma_f32_32x32x16_bf16 v[176:191], a[100:103], v[60:63], v[176:191]
    ds_read_b128 v[52:55], v245 offset:35840
    s_waitcnt lgkmcnt(2)
    v_mfma_f32_32x32x16_bf16 v[144:159], a[104:107], v[40:43], v[144:159]
    ds_read_b128 v[56:59], v246 offset:35840
    v_mfma_f32_32x32x16_bf16 v[160:175], a[104:107], v[44:47], v[160:175]
    ds_read_b128 v[60:63], v247 offset:35840
    s_waitcnt lgkmcnt(2)
    v_mfma_f32_32x32x16_bf16 v[176:191], a[104:107], v[48:51], v[176:191]
    s_waitcnt vmcnt(1)
    s_barrier
    ds_read_b128 v[40:43], v245 offset:16384
    v_mfma_f32_32x32x16_bf16 v[144:159], a[108:111], v[52:55], v[144:159]
    ds_read_b128 v[44:47], v246 offset:16384
    s_waitcnt lgkmcnt(2)
    v_mfma_f32_32x32x16_bf16 v[160:175], a[108:111], v[56:59], v[160:175]
    ds_read_b128 v[48:51], v247 offset:16384
    v_mfma_f32_32x32x16_bf16 v[176:191], a[108:111], v[60:63], v[176:191]
    ds_read_b128 v[52:55], v245 offset:17408
    s_waitcnt lgkmcnt(2)
    v_mfma_f32_32x32x16_bf16 v[144:159], a[56:59], v[40:43], v[144:159]
    ds_read_b128 v[56:59], v246 offset:17408
L_pad_G_22:
    s_cbranch_execz L_ret_G
    v_mfma_f32_32x32x16_bf16 v[160:175], a[56:59], v[44:47], v[160:175]
    ds_read_b128 v[60:63], v247 offset:17408
    s_waitcnt lgkmcnt(2)
    v_mfma_f32_32x32x16_bf16 v[176:191], a[56:59], v[48:51], v[176:191]
    v_mfma_f32_32x32x16_bf16 v[144:159], a[60:63], v[52:55], v[144:159]
    s_waitcnt lgkmcnt(0)
    v_mfma_f32_32x32x16_bf16 v[160:175], a[60:63], v[56:59], v[160:175]
    v_mfma_f32_32x32x16_bf16 v[176:191], a[60:63], v[60:63], v[176:191]
    s_nop 15
    s_add_u32 s78, s66, 1
    s_and_b32 s78, s78, 3
    s_mul_i32 s78, s78, 24576
    s_add_u32 s78, s78, s100
    v_cvt_pk_bf16_f32 v144, v144, v145
    v_cvt_pk_bf16_f32 v145, v146, v147
    v_cvt_pk_bf16_f32 v146, v148, v149
    v_cvt_pk_bf16_f32 v147, v150, v151
    v_min_u32 v144, -2, v144
    v_min_u32 v145, -2, v145
    v_min_u32 v146, -2, v146
    v_min_u32 v147, -2, v147
    buffer_store_dwordx4 v[144:147], v2, s[16:19], s78 offen offset:0 sc1
    v_cvt_pk_bf16_f32 v148, v152, v153
    v_cvt_pk_bf16_f32 v149, v154, v155
    v_cvt_pk_bf16_f32 v150, v156, v157
    v_cvt_pk_bf16_f32 v151, v158, v159
    v_min_u32 v148, -2, v148
    v_min_u32 v149, -2, v149
    v_min_u32 v150, -2, v150
    v_min_u32 v151, -2, v151
    buffer_store_dwordx4 v[148:151], v2, s[16:19], s78 offen offset:1024 sc1
    s_add_u32 s78, s66, 2
    s_and_b32 s78, s78, 3
    s_mul_i32 s78, s78, 24576
    s_add_u32 s78, s78, s100
    s_add_u32 s78, s78, 8192
    s_nop 7
    v_cvt_pk_bf16_f32 v160, v160, v161
    v_cvt_pk_bf16_f32 v161, v162, v163
    v_cvt_pk_bf16_f32 v162, v164, v165
    s_nop 0
L_pad_G_23:
    s_cbranch_execz L_ret_G
    v_cvt_pk_bf16_f32 v163, v166, v167
    v_min_u32 v160, -2, v160
    v_min_u32 v161, -2, v161
    v_min_u32 v162, -2, v162
    v_min_u32 v163, -2, v163
    buffer_store_dwordx4 v[160:163], v2, s[16:19], s78 offen offset:0 sc1
    v_cvt_pk_bf16_f32 v164, v168, v169
    v_cvt_pk_bf16_f32 v165, v170, v171
    v_cvt_pk_bf16_f32 v166, v172, v173
    v_cvt_pk_bf16_f32 v167, v174, v175
    v_min_u32 v164, -2, v164
    v_min_u32 v165, -2, v165
    v_min_u32 v166, -2, v166
    v_min_u32 v167, -2, v167
    buffer_store_dwordx4 v[164:167], v2, s[16:19], s78 offen offset:1024 sc1
    s_add_u32 s78, s66, 3
    s_and_b32 s78, s78, 3
    s_mul_i32 s78, s78, 24576
    s_add_u32 s78, s78, s100
    s_add_u32 s78, s78, 16384
    v_cvt_pk_bf16_f32 v176, v176, v177
    v_cvt_pk_bf16_f32 v177, v178, v179
    v_cvt_pk_bf16_f32 v178, v180, v181
    v_cvt_pk_bf16_f32 v179, v182, v183
    v_min_u32 v176, -2, v176
    v_min_u32 v177, -2, v177
    v_min_u32 v178, -2, v178
    v_min_u32 v179, -2, v179
    buffer_store_dwordx4 v[176:179], v2, s[16:19], s78 offen offset:0 sc1
    v_cvt_pk_bf16_f32 v180, v184, v185
    v_cvt_pk_bf16_f32 v181, v186, v187
    v_cvt_pk_bf16_f32 v182, v188, v189
    v_cvt_pk_bf16_f32 v183, v190, v191
    v_min_u32 v180, -2, v180
    v_min_u32 v181, -2, v181
    v_min_u32 v182, -2, v182
    v_min_u32 v183, -2, v183
    buffer_store_dwordx4 v[180:183], v2, s[16:19], s78 offen offset:1024 sc1
    s_waitcnt vmcnt(6)
    v_cmp_gt_u32 vcc, 4, v220
    s_cmp_eq_u64 vcc, 0
    s_cbranch_scc1 L_pnf_ok
    s_mov_b32 s65, 0x40000
L_pnf:
L_pad_G_24:
    s_cbranch_execz L_ret_G
    s_xor_b32 s78, s101, 4
    s_andn2_b32 s78, s78, 0x300
    v_and_b32 v220, 3, v1
    v_lshlrev_b32 v220, 8, v220
    buffer_load_dword v220, v220, s[16:19], s78 offen sc1
    s_waitcnt vmcnt(0)
    v_cmp_gt_u32 vcc, 4, v220
    s_cmp_eq_u64 vcc, 0
    s_cbranch_scc1 L_pnf_ok
    s_sleep 2
    s_sub_u32 s65, s65, 1
    s_cbranch_scc0 L_pnf
L_pnf_ok:
    s_mul_i32 s3, s66, 24576
    s_add_u32 s3, s3, s100
    s_add_u32 s4, s3, 8192
    s_add_u32 s5, s3, 16384
    s_add_u32 s78, s60, 147456
    v_and_b32 v218, 31, v1
    v_lshrrev_b32 v219, 5, v1
    v_lshlrev_b32 v219, 3, v219
    v_and_b32 v96, 15, v1
    v_lshl_add_u32 v96, v96, 2, s78
    v_add_u32 v97, s78, v219
    ds_write_b32 v96, v200 offset:2048
    ds_write_b32 v96, v208 offset:2112
    s_waitcnt lgkmcnt(0)
    ds_read_b64 v[200:201], v97 offset:2048
    ds_read_b64 v[202:203], v97 offset:2064
    ds_read_b64 v[204:205], v97 offset:2080
    ds_read_b64 v[206:207], v97 offset:2096
    ds_read_b64 v[208:209], v97 offset:2112
    ds_read_b64 v[210:211], v97 offset:2128
    ds_read_b64 v[212:213], v97 offset:2144
    ds_read_b64 v[214:215], v97 offset:2160
    v_lshl_add_u32 v219, v218, 6, v97
    ds_read_b64 v[192:193], v219 offset:0
    ds_read_b64 v[194:195], v219 offset:16
    ds_read_b64 v[196:197], v219 offset:32
    ds_read_b64 v[198:199], v219 offset:48
    s_lshl2_add_u32 s6, s57, s66
    s_lshl_b32 s6, s6, 9
L_pad_G_25:
    s_cbranch_execz L_ret_G
    s_lshl2_add_u32 s79, s67, s56
    s_add_u32 s6, s6, s79
    s_lshl_b32 s6, s6, 7
    s_waitcnt lgkmcnt(0)
    ds_read_b128 v[40:43], v240 offset:0
    ds_read_b128 v[44:47], v240 offset:1024
    ds_read_b128 v[48:51], v240 offset:2048
    ds_read_b128 v[52:55], v240 offset:3072
    s_waitcnt lgkmcnt(2)
    v_mfma_f32_32x32x16_bf16 v[128:143], a[144:147], v[40:43], v[128:143]
    ds_read_b128 v[56:59], v240 offset:16384
    v_lshlrev_b32 v96, 16, v192
    v_lshlrev_b32 v97, 16, v200
    v_lshlrev_b32 v98, 16, v208
    v_fma_f32 v99, v96, v216, v217
    v_add_f32 v96, v96, v98
    v_mfma_f32_32x32x16_bf16 v[128:143], a[148:151], v[44:47], v[128:143]
    ds_read_b128 v[60:63], v240 offset:17408
    v_cvt_pk_bf16_f32 v99, v99, v99
    v_lshlrev_b32 v99, 16, v99
    v_mul_f32 v99, v99, v97
    v_cvt_pk_bf16_f32 v99, v99, v99
    v_lshlrev_b32 v99, 16, v99
    s_waitcnt lgkmcnt(2)
    v_mfma_f32_32x32x16_bf16 v[128:143], a[152:155], v[48:51], v[128:143]
    ds_read_b128 v[40:43], v240 offset:18432
    v_add_f32 v224, v96, v99
    v_and_b32 v100, 0xffff0000, v192
    v_and_b32 v101, 0xffff0000, v200
    v_and_b32 v102, 0xffff0000, v208
    v_fma_f32 v103, v100, v216, v217
    v_mfma_f32_32x32x16_bf16 v[128:143], a[156:159], v[52:55], v[128:143]
    ds_read_b128 v[44:47], v240 offset:19456
    v_add_f32 v100, v100, v102
    v_cvt_pk_bf16_f32 v103, v103, v103
    v_lshlrev_b32 v103, 16, v103
    v_mul_f32 v103, v103, v101
    v_cvt_pk_bf16_f32 v103, v103, v103
    s_waitcnt lgkmcnt(2)
    v_mfma_f32_32x32x16_bf16 v[128:143], a[112:115], v[56:59], v[128:143]
    s_nop 0
L_pad_G_26:
    s_cbranch_execz L_ret_G
    ds_read_b128 v[48:51], v240 offset:32768
    v_lshlrev_b32 v103, 16, v103
    v_add_f32 v225, v100, v103
    v_lshlrev_b32 v96, 16, v193
    v_lshlrev_b32 v97, 16, v201
    v_lshlrev_b32 v98, 16, v209
    v_mfma_f32_32x32x16_bf16 v[128:143], a[116:119], v[60:63], v[128:143]
    ds_read_b128 v[52:55], v240 offset:33792
    v_fma_f32 v99, v96, v216, v217
    v_add_f32 v96, v96, v98
    v_cvt_pk_bf16_f32 v99, v99, v99
    v_lshlrev_b32 v99, 16, v99
    v_mul_f32 v99, v99, v97
    s_waitcnt lgkmcnt(2)
    v_mfma_f32_32x32x16_bf16 v[128:143], a[120:123], v[40:43], v[128:143]
    ds_read_b128 v[56:59], v240 offset:34816
    v_cvt_pk_bf16_f32 v99, v99, v99
    v_lshlrev_b32 v99, 16, v99
    v_add_f32 v226, v96, v99
    v_and_b32 v100, 0xffff0000, v193
    v_and_b32 v101, 0xffff0000, v201
    v_mfma_f32_32x32x16_bf16 v[128:143], a[124:127], v[44:47], v[128:143]
    ds_read_b128 v[60:63], v240 offset:35840
    v_and_b32 v102, 0xffff0000, v209
    v_fma_f32 v103, v100, v216, v217
    v_add_f32 v100, v100, v102
    v_cvt_pk_bf16_f32 v103, v103, v103
    v_lshlrev_b32 v103, 16, v103
    s_waitcnt lgkmcnt(2)
    v_mfma_f32_32x32x16_bf16 v[128:143], a[160:163], v[48:51], v[128:143]
    ds_read_b128 v[40:43], v240 offset:49152
    v_mul_f32 v103, v103, v101
    v_cvt_pk_bf16_f32 v103, v103, v103
    v_lshlrev_b32 v103, 16, v103
    v_add_f32 v227, v100, v103
    v_lshlrev_b32 v96, 16, v194
    v_mfma_f32_32x32x16_bf16 v[128:143], a[164:167], v[52:55], v[128:143]
    ds_read_b128 v[44:47], v240 offset:50176
    v_lshlrev_b32 v97, 16, v202
    v_lshlrev_b32 v98, 16, v210
    v_fma_f32 v99, v96, v216, v217
    v_add_f32 v96, v96, v98
L_pad_G_27:
    s_cbranch_execz L_ret_G
    v_cvt_pk_bf16_f32 v99, v99, v99
    s_waitcnt lgkmcnt(2)
    v_mfma_f32_32x32x16_bf16 v[128:143], a[168:171], v[56:59], v[128:143]
    ds_read_b128 v[48:51], v240 offset:51200
    v_lshlrev_b32 v99, 16, v99
    v_mul_f32 v99, v99, v97
    v_cvt_pk_bf16_f32 v99, v99, v99
    v_lshlrev_b32 v99, 16, v99
    v_add_f32 v228, v96, v99
    v_mfma_f32_32x32x16_bf16 v[128:143], a[172:175], v[60:63], v[128:143]
    ds_read_b128 v[52:55], v240 offset:52224
    v_and_b32 v100, 0xffff0000, v194
    v_and_b32 v101, 0xffff0000, v202
    v_and_b32 v102, 0xffff0000, v210
    v_fma_f32 v103, v100, v216, v217
    v_add_f32 v100, v100, v102
    s_waitcnt lgkmcnt(2)
    v_mfma_f32_32x32x16_bf16 v[128:143], a[128:131], v[40:43], v[128:143]
    ds_read_b128 v[56:59], v244 offset:0
    v_cvt_pk_bf16_f32 v103, v103, v103
    v_lshlrev_b32 v103, 16, v103
    v_mul_f32 v103, v103, v101
    v_cvt_pk_bf16_f32 v103, v103, v103
    v_lshlrev_b32 v103, 16, v103
    v_mfma_f32_32x32x16_bf16 v[128:143], a[132:135], v[44:47], v[128:143]
    ds_read_b128 v[60:63], v244 offset:1024
    v_add_f32 v229, v100, v103
    v_lshlrev_b32 v96, 16, v195
    v_lshlrev_b32 v97, 16, v203
    v_lshlrev_b32 v98, 16, v211
    v_fma_f32 v99, v96, v216, v217
    s_waitcnt lgkmcnt(2)
    v_mfma_f32_32x32x16_bf16 v[128:143], a[136:139], v[48:51], v[128:143]
    ds_read_b128 v[40:43], v244 offset:2048
    v_add_f32 v96, v96, v98
    v_cvt_pk_bf16_f32 v99, v99, v99
    v_lshlrev_b32 v99, 16, v99
    v_mul_f32 v99, v99, v97
    v_cvt_pk_bf16_f32 v99, v99, v99
    v_mfma_f32_32x32x16_bf16 v[128:143], a[140:143], v[52:55], v[128:143]
    s_nop 0
L_pad_G_28:
    s_cbranch_execz L_ret_G
    ds_read_b128 v[44:47], v244 offset:3072
    v_lshlrev_b32 v99, 16, v99
    v_add_f32 v230, v96, v99
    v_and_b32 v100, 0xffff0000, v195
    v_and_b32 v101, 0xffff0000, v203
    v_and_b32 v102, 0xffff0000, v211
    s_waitcnt lgkmcnt(2)
    v_mfma_f32_32x32x16_bf16 v[128:143], a[80:83], v[56:59], v[128:143]
    ds_read_b128 v[48:51], v244 offset:16384
    v_fma_f32 v103, v100, v216, v217
    v_add_f32 v100, v100, v102
    v_cvt_pk_bf16_f32 v103, v103, v103
    v_lshlrev_b32 v103, 16, v103
    v_mul_f32 v103, v103, v101
    v_mfma_f32_32x32x16_bf16 v[128:143], a[84:87], v[60:63], v[128:143]
    ds_read_b128 v[52:55], v244 offset:17408
    v_cvt_pk_bf16_f32 v103, v103, v103
    v_lshlrev_b32 v103, 16, v103
    v_add_f32 v231, v100, v103
    buffer_load_dwordx4 v[64:67], v2, s[16:19], s3 offen offset:0 sc1
    buffer_load_dwordx4 v[68:71], v2, s[16:19], s3 offen offset:1024 sc1
    buffer_load_dwordx4 v[72:75], v2, s[16:19], s4 offen offset:0 sc1
    buffer_load_dwordx4 v[76:79], v2, s[16:19], s4 offen offset:1024 sc1
    buffer_load_dwordx4 v[80:83], v2, s[16:19], s5 offen offset:0 sc1
    buffer_load_dwordx4 v[84:87], v2, s[16:19], s5 offen offset:1024 sc1
    v_lshlrev_b32 v96, 16, v196
    s_waitcnt lgkmcnt(2)
    v_mfma_f32_32x32x16_bf16 v[128:143], a[88:91], v[40:43], v[128:143]
    ds_read_b128 v[56:59], v244 offset:32768
    v_lshlrev_b32 v97, 16, v204
    v_lshlrev_b32 v98, 16, v212
    v_fma_f32 v99, v96, v216, v217
    v_add_f32 v96, v96, v98
    v_cvt_pk_bf16_f32 v99, v99, v99
    v_mfma_f32_32x32x16_bf16 v[128:143], a[92:95], v[44:47], v[128:143]
    ds_read_b128 v[60:63], v244 offset:33792
    v_lshlrev_b32 v99, 16, v99
    v_mul_f32 v99, v99, v97
    v_cvt_pk_bf16_f32 v99, v99, v99
L_pad_G_29:
    s_cbranch_execz L_ret_G
    v_lshlrev_b32 v99, 16, v99
    v_add_f32 v232, v96, v99
    s_waitcnt lgkmcnt(2)
    v_mfma_f32_32x32x16_bf16 v[128:143], a[56:59], v[48:51], v[128:143]
    ds_read_b128 v[40:43], v244 offset:34816
    v_and_b32 v100, 0xffff0000, v196
    v_and_b32 v101, 0xffff0000, v204
    v_and_b32 v102, 0xffff0000, v212
    v_fma_f32 v103, v100, v216, v217
    v_add_f32 v100, v100, v102
    v_mfma_f32_32x32x16_bf16 v[128:143], a[60:63], v[52:55], v[128:143]
    ds_read_b128 v[44:47], v244 offset:35840
    v_cvt_pk_bf16_f32 v103, v103, v103
    v_lshlrev_b32 v103, 16, v103
    v_mul_f32 v103, v103, v101
    v_cvt_pk_bf16_f32 v103, v103, v103
    v_lshlrev_b32 v103, 16, v103
    s_waitcnt lgkmcnt(2)
    v_mfma_f32_32x32x16_bf16 v[128:143], a[96:99], v[56:59], v[128:143]
    ds_read_b128 v[48:51], v244 offset:49152
    v_add_f32 v233, v100, v103
    v_lshlrev_b32 v96, 16, v197
    v_lshlrev_b32 v97, 16, v205
    v_lshlrev_b32 v98, 16, v213
    v_fma_f32 v99, v96, v216, v217
    v_mfma_f32_32x32x16_bf16 v[128:143], a[100:103], v[60:63], v[128:143]
    ds_read_b128 v[52:55], v244 offset:50176
    v_add_f32 v96, v96, v98
    v_cvt_pk_bf16_f32 v99, v99, v99
    v_lshlrev_b32 v99, 16, v99
    v_mul_f32 v99, v99, v97
    v_cvt_pk_bf16_f32 v99, v99, v99
    s_waitcnt lgkmcnt(2)
    v_mfma_f32_32x32x16_bf16 v[128:143], a[104:107], v[40:43], v[128:143]
    ds_read_b128 v[56:59], v244 offset:51200
    v_lshlrev_b32 v99, 16, v99
    v_add_f32 v234, v96, v99
    v_and_b32 v100, 0xffff0000, v197
    v_and_b32 v101, 0xffff0000, v205
    v_and_b32 v102, 0xffff0000, v213
    s_nop 0
L_pad_G_30:
    s_cbranch_execz L_ret_G
    v_mfma_f32_32x32x16_bf16 v[128:143], a[108:111], v[44:47], v[128:143]
    ds_read_b128 v[60:63], v244 offset:52224
    v_fma_f32 v103, v100, v216, v217
    v_add_f32 v100, v100, v102
    v_cvt_pk_bf16_f32 v103, v103, v103
    v_lshlrev_b32 v103, 16, v103
    v_mul_f32 v103, v103, v101
    s_waitcnt lgkmcnt(2)
    v_mfma_f32_32x32x16_bf16 v[128:143], a[64:67], v[48:51], v[128:143]
    v_add_u32 v244, 131072, v240
    v_add_u32 v245, 131072, v241
    v_add_u32 v246, 131072, v242
    v_add_u32 v247, 131072, v243
    ds_read_b128 v[40:43], v244 offset:0
    v_cvt_pk_bf16_f32 v103, v103, v103
    v_lshlrev_b32 v103, 16, v103
    v_add_f32 v235, v100, v103
    v_lshlrev_b32 v96, 16, v198
    v_lshlrev_b32 v97, 16, v206
    v_mfma_f32_32x32x16_bf16 v[128:143], a[68:71], v[52:55], v[128:143]
    ds_read_b128 v[44:47], v244 offset:1024
    v_lshlrev_b32 v98, 16, v214
    v_fma_f32 v99, v96, v216, v217
    v_add_f32 v96, v96, v98
    v_cvt_pk_bf16_f32 v99, v99, v99
    v_lshlrev_b32 v99, 16, v99
    s_waitcnt lgkmcnt(2)
    v_mfma_f32_32x32x16_bf16 v[128:143], a[72:75], v[56:59], v[128:143]
    v_mul_f32 v99, v99, v97
    v_cvt_pk_bf16_f32 v99, v99, v99
    v_lshlrev_b32 v99, 16, v99
    v_add_f32 v236, v96, v99
    v_and_b32 v100, 0xffff0000, v198
    v_mfma_f32_32x32x16_bf16 v[128:143], a[76:79], v[60:63], v[128:143]
    v_and_b32 v101, 0xffff0000, v206
    v_and_b32 v102, 0xffff0000, v214
    v_fma_f32 v103, v100, v216, v217
    v_add_f32 v100, v100, v102
    v_cvt_pk_bf16_f32 v103, v103, v103
    s_waitcnt lgkmcnt(0)
L_pad_G_31:
    s_cbranch_execz L_ret_G
    v_mfma_f32_32x32x16_bf16 v[128:143], a[48:51], v[40:43], v[128:143]
    v_lshlrev_b32 v103, 16, v103
    v_mul_f32 v103, v103, v101
    v_cvt_pk_bf16_f32 v103, v103, v103
    v_lshlrev_b32 v103, 16, v103
    v_add_f32 v237, v100, v103
    v_mfma_f32_32x32x16_bf16 v[128:143], a[52:55], v[44:47], v[128:143]
    v_lshlrev_b32 v96, 16, v199
    v_lshlrev_b32 v97, 16, v207
    v_lshlrev_b32 v98, 16, v215
    v_fma_f32 v99, v96, v216, v217
    v_add_f32 v96, v96, v98
    v_cvt_pk_bf16_f32 v99, v99, v99
    v_lshlrev_b32 v99, 16, v99
    v_mul_f32 v99, v99, v97
    v_cvt_pk_bf16_f32 v99, v99, v99
    v_lshlrev_b32 v99, 16, v99
    v_add_f32 v238, v96, v99
    v_and_b32 v100, 0xffff0000, v199
    v_and_b32 v101, 0xffff0000, v207
    v_and_b32 v102, 0xffff0000, v215
    v_fma_f32 v103, v100, v216, v217
    v_add_f32 v100, v100, v102
    v_cvt_pk_bf16_f32 v103, v103, v103
    v_lshlrev_b32 v103, 16, v103
    v_mul_f32 v103, v103, v101
    v_cvt_pk_bf16_f32 v103, v103, v103
    v_lshlrev_b32 v103, 16, v103
    v_add_f32 v239, v100, v103
    s_add_u32 s78, s60, 147456
    v_add_u32 v240, s78, v10
    v_add_u32 v241, s78, v11
    v_add_u32 v242, s78, v12
    v_add_u32 v243, s78, v13
    v_add_u32 v244, s78, v2
    v_and_b32 v218, 0xfffffc00, v5
    v_add_u32 v218, v218, v5
    v_xor_b32 v245, 64, v218
    s_nop 9
    v_add_f32 v128, v128, v224
    v_add_f32 v129, v129, v225
    v_add_f32 v130, v130, v226
    v_add_f32 v131, v131, v227
    v_add_f32 v132, v132, v228
    v_add_f32 v133, v133, v229
    v_add_f32 v134, v134, v230
    v_add_f32 v135, v135, v231
    v_add_f32 v136, v136, v232
    v_add_f32 v137, v137, v233
L_pad_G_32:
    s_cbranch_execz L_ret_G
    v_add_f32 v138, v138, v234
    v_add_f32 v139, v139, v235
    v_add_f32 v140, v140, v236
    v_add_f32 v141, v141, v237
    v_add_f32 v142, v142, v238
    v_add_f32 v143, v143, v239
    s_waitcnt vmcnt(0)
    v_max3_u32 v32, v64, v65, v66
    v_max3_u32 v33, v67, v68, v69
    v_max3_u32 v33, v33, v70, v71
    v_max3_u32 v32, v32, v72, v73
    v_max3_u32 v33, v33, v74, v75
    v_max3_u32 v32, v32, v76, v77
    v_max3_u32 v33, v33, v78, v79
    v_max3_u32 v32, v32, v80, v81
    v_max3_u32 v33, v33, v82, v83
    v_max3_u32 v32, v32, v84, v85
    v_max3_u32 v33, v33, v86, v87
    v_max_u32 v32, v32, v33
    v_cmp_eq_u32 vcc, -1, v32
    s_cmp_eq_u64 vcc, 0
    s_cbranch_scc1 L_inf_ok
    s_mov_b32 s65, 0x40000
L_inf:
    buffer_load_dwordx4 v[64:67], v2, s[16:19], s3 offen offset:0 sc1
    buffer_load_dwordx4 v[68:71], v2, s[16:19], s3 offen offset:1024 sc1
    buffer_load_dwordx4 v[72:75], v2, s[16:19], s4 offen offset:0 sc1
    buffer_load_dwordx4 v[76:79], v2, s[16:19], s4 offen offset:1024 sc1
    buffer_load_dwordx4 v[80:83], v2, s[16:19], s5 offen offset:0 sc1
    buffer_load_dwordx4 v[84:87], v2, s[16:19], s5 offen offset:1024 sc1
    s_waitcnt vmcnt(0)
    v_max3_u32 v32, v64, v65, v66
    v_max3_u32 v33, v67, v68, v69
    v_max3_u32 v33, v33, v70, v71
    v_max3_u32 v32, v32, v72, v73
    v_max3_u32 v33, v33, v74, v75
    v_max3_u32 v32, v32, v76, v77
    v_max3_u32 v33, v33, v78, v79
    s_nop 0
L_pad_G_33:
    s_cbranch_execz L_ret_G
    v_max3_u32 v32, v32, v80, v81
    v_max3_u32 v33, v33, v82, v83
    v_max3_u32 v32, v32, v84, v85
    v_max3_u32 v33, v33, v86, v87
    v_max_u32 v32, v32, v33
    v_cmp_eq_u32 vcc, -1, v32
    s_cmp_eq_u64 vcc, 0
    s_cbranch_scc1 L_inf_ok
    s_sleep 1
    s_sub_u32 s65, s65, 1
    s_cbranch_scc0 L_inf
L_inf_ok:
    v_lshlrev_b32 v96, 16, v64
    v_lshlrev_b32 v97, 16, v72
    v_lshlrev_b32 v98, 16, v80
    v_and_b32 v99, 0xffff0000, v64
    v_and_b32 v100, 0xffff0000, v72
    v_and_b32 v101, 0xffff0000, v80
    v_lshlrev_b32 v102, 16, v65
    v_lshlrev_b32 v103, 16, v73
    v_lshlrev_b32 v104, 16, v81
    v_and_b32 v105, 0xffff0000, v65
    v_and_b32 v106, 0xffff0000, v73
    v_and_b32 v107, 0xffff0000, v81
    v_add_f32 v96, v96, v97
    v_add_f32 v128, v128, v98
    v_add_f32 v99, v99, v100
    v_add_f32 v129, v129, v101
    v_add_f32 v102, v102, v103
    v_add_f32 v130, v130, v104
    v_add_f32 v105, v105, v106
    v_add_f32 v131, v131, v107
    v_add_f32 v128, v128, v96
    v_add_f32 v129, v129, v99
    v_add_f32 v130, v130, v102
    v_add_f32 v131, v131, v105
    ds_write_b128 v240, v[128:131]
    v_lshlrev_b32 v96, 16, v66
    v_lshlrev_b32 v97, 16, v74
    v_lshlrev_b32 v98, 16, v82
    v_and_b32 v99, 0xffff0000, v66
    v_and_b32 v100, 0xffff0000, v74
    v_and_b32 v101, 0xffff0000, v82
    v_lshlrev_b32 v102, 16, v67
    v_lshlrev_b32 v103, 16, v75
    v_lshlrev_b32 v104, 16, v83
    v_and_b32 v105, 0xffff0000, v67
    v_and_b32 v106, 0xffff0000, v75
L_pad_G_34:
    s_cbranch_execz L_ret_G
    v_and_b32 v107, 0xffff0000, v83
    v_add_f32 v96, v96, v97
    v_add_f32 v132, v132, v98
    v_add_f32 v99, v99, v100
    v_add_f32 v133, v133, v101
    v_add_f32 v102, v102, v103
    v_add_f32 v134, v134, v104
    v_add_f32 v105, v105, v106
    v_add_f32 v135, v135, v107
    v_add_f32 v132, v132, v96
    v_add_f32 v133, v133, v99
    v_add_f32 v134, v134, v102
    v_add_f32 v135, v135, v105
    ds_write_b128 v241, v[132:135]
    v_lshlrev_b32 v96, 16, v68
    v_lshlrev_b32 v97, 16, v76
    v_lshlrev_b32 v98, 16, v84
    v_and_b32 v99, 0xffff0000, v68
    v_and_b32 v100, 0xffff0000, v76
    v_and_b32 v101, 0xffff0000, v84
    v_lshlrev_b32 v102, 16, v69
    v_lshlrev_b32 v103, 16, v77
    v_lshlrev_b32 v104, 16, v85
    v_and_b32 v105, 0xffff0000, v69
    v_and_b32 v106, 0xffff0000, v77
    v_and_b32 v107, 0xffff0000, v85
    v_add_f32 v96, v96, v97
    v_add_f32 v136, v136, v98
    v_add_f32 v99, v99, v100
    v_add_f32 v137, v137, v101
    v_add_f32 v102, v102, v103
    v_add_f32 v138, v138, v104
    v_add_f32 v105, v105, v106
    v_add_f32 v139, v139, v107
    v_add_f32 v136, v136, v96
    v_add_f32 v137, v137, v99
    v_add_f32 v138, v138, v102
    v_add_f32 v139, v139, v105
    ds_write_b128 v242, v[136:139]
    v_lshlrev_b32 v96, 16, v70
    v_lshlrev_b32 v97, 16, v78
    v_lshlrev_b32 v98, 16, v86
    v_and_b32 v99, 0xffff0000, v70
    v_and_b32 v100, 0xffff0000, v78
    v_and_b32 v101, 0xffff0000, v86
    v_lshlrev_b32 v102, 16, v71
    v_lshlrev_b32 v103, 16, v79
    v_lshlrev_b32 v104, 16, v87
    v_and_b32 v105, 0xffff0000, v71
    s_nop 0
L_pad_G_35:
    s_cbranch_execz L_ret_G
    v_and_b32 v106, 0xffff0000, v79
    v_and_b32 v107, 0xffff0000, v87
    v_add_f32 v96, v96, v97
    v_add_f32 v140, v140, v98
    v_add_f32 v99, v99, v100
    v_add_f32 v141, v141, v101
    v_add_f32 v102, v102, v103
    v_add_f32 v142, v142, v104
    v_add_f32 v105, v105, v106
    v_add_f32 v143, v143, v107
    v_add_f32 v140, v140, v96
    v_add_f32 v141, v141, v99
    v_add_f32 v142, v142, v102
    v_add_f32 v143, v143, v105
    ds_write_b128 v243, v[140:143]
    s_waitcnt lgkmcnt(0)
    ds_read_b128 v[144:147], v244 offset:0
    ds_read_b128 v[148:151], v244 offset:1024
    ds_read_b128 v[152:155], v244 offset:2048
    ds_read_b128 v[156:159], v244 offset:3072
    s_waitcnt lgkmcnt(3)
    buffer_store_dwordx4 v[144:147], v218, s[32:35], s6 offen
    s_add_u32 s6, s6, 16384
    s_waitcnt lgkmcnt(2)
    buffer_store_dwordx4 v[148:151], v245, s[32:35], s6 offen
    s_add_u32 s6, s6, 16384
    s_waitcnt lgkmcnt(1)
    buffer_store_dwordx4 v[152:155], v218, s[32:35], s6 offen
    s_add_u32 s6, s6, 16384
    s_waitcnt lgkmcnt(0)
    buffer_store_dwordx4 v[156:159], v245, s[32:35], s6 offen
    s_add_u32 s6, s6, 16384
    s_endpgm
L_ssm:
R_A1:
    v_bfe_u32 v32, v1, 3, 2
    v_lshrrev_b32 v33, 5, v1
    v_lshl_add_u32 v32, v33, 4, v32
    v_and_b32 v33, 0x70, v5
    v_lshl_add_u32 v3, v32, 10, v33
    v_add_u32 v3, s63, v3
    v_xor_b32 v4, 64, v3
    s_sub_u32 s61, 15, s57
    s_lshl_b32 s61, s61, 9
    v_lshl_add_u32 v7, v1, 3, s61
L_pad_Q_0:
    s_cbranch_execz L_ret_Q
    v_mov_b32 v34, -1
    v_mov_b32 v35, -1
    s_cmp_lg_u32 s56, 0
    s_cbranch_scc1 L_noclr
    buffer_store_dwordx2 v[34:35], v7, s[40:43], 0 offen sc1
L_noclr:
    s_lshl_b32 s61, s58, 7
    v_lshl_add_u32 v32, v1, 1, s61
    global_load_ushort v64, v32, s[50:51]
    global_load_ushort v65, v32, s[52:53]
    global_load_ushort v66, v32, s[54:55]
    s_lshl_b32 s73, s58, 16
    s_lshr_b32 s3, s56, 1
    s_add_u32 s3, s3, s59
    s_add_u32 m0, s60, 0
    s_add_u32 s61, s59, 0
    s_and_b32 s61, s61, 7
    s_mul_i32 s61, s61, 128
    buffer_load_dwordx4 v3, s[8:11], s61 offen offset:0 lds
    s_add_u32 s61, s61, 3072
    buffer_load_dwordx4 v4, s[8:11], s61 offen offset:1024 lds
    s_add_u32 s61, s61, 3072
    buffer_load_dwordx4 v3, s[8:11], s61 offen offset:2048 lds
    s_add_u32 s61, s61, 3072
    buffer_load_dwordx4 v4, s[8:11], s61 offen offset:3072 lds
    s_add_u32 m0, s60, 16384
    s_add_u32 s61, s59, 1
    s_and_b32 s61, s61, 7
    s_mul_i32 s61, s61, 128
    buffer_load_dwordx4 v3, s[8:11], s61 offen offset:0 lds
    s_add_u32 s61, s61, 3072
    buffer_load_dwordx4 v4, s[8:11], s61 offen offset:1024 lds
    s_add_u32 s61, s61, 3072
    buffer_load_dwordx4 v3, s[8:11], s61 offen offset:2048 lds
    s_add_u32 s61, s61, 3072
    buffer_load_dwordx4 v4, s[8:11], s61 offen offset:3072 lds
    s_add_u32 m0, s60, 32768
    s_add_u32 s61, s59, 2
    s_and_b32 s61, s61, 7
    s_mul_i32 s61, s61, 128
L_pad_Q_1:
    s_cbranch_execz L_ret_Q
    buffer_load_dwordx4 v3, s[8:11], s61 offen offset:0 lds
    s_add_u32 s61, s61, 3072
    buffer_load_dwordx4 v4, s[8:11], s61 offen offset:1024 lds
    s_add_u32 s61, s61, 3072
    buffer_load_dwordx4 v3, s[8:11], s61 offen offset:2048 lds
    s_add_u32 s61, s61, 3072
    buffer_load_dwordx4 v4, s[8:11], s61 offen offset:3072 lds
    s_waitcnt vmcnt(12)
    v_lshlrev_b32 v64, 16, v64
    v_lshlrev_b32 v65, 16, v65
    v_lshlrev_b32 v66, 16, v66
    v_mul_f32 v66, 0x3fb8aa3b, v66
    v_exp_f32 v66, v66
    s_nop 0
    v_cvt_pk_bf16_f32 v66, v66, v66
    v_lshlrev_b32 v66, 16, v66
    v_mul_f32 v67, v66, v64
    v_mul_f32 v68, v66, v65
    v_mul_f32 v67, 0x3fb8aa3b, v67
    v_mul_f32 v68, 0x3e22f983, v68
    v_exp_f32 v69, v67
    v_rndne_f32 v67, v68
    v_sub_f32 v68, v68, v67
    v_cos_f32 v70, v68
    v_sin_f32 v71, v68
    s_nop 0
    v_mul_f32 v80, v69, v70
    v_mul_f32 v81, v69, v71
    v_mul_f32 v67, v64, v64
    v_fma_f32 v67, v65, v65, v67
    v_rcp_f32 v67, v67
    v_add_f32 v70, -1.0, v80
    v_mov_b32 v71, v81
    v_add_f32 v67, v67, v67
    v_mul_f32 v64, v64, v67
    v_mul_f32 v65, -v65, v67
    v_mul_f32 v74, v70, v64
    v_mul_f32 v75, v70, v65
    v_fma_f32 v74, -v71, v65, v74
    v_fma_f32 v85, v71, v64, v75
    v_mov_b32 v84, v74
    v_mul_f32 v74, v80, v80
    v_mul_f32 v75, v80, v81
    v_fma_f32 v74, -v81, v81, v74
    v_fma_f32 v89, v81, v80, v75
    v_mov_b32 v88, v74
    v_mul_f32 v74, v88, v88
L_pad_Q_2:
    s_cbranch_execz L_ret_Q
    v_mul_f32 v75, v88, v89
    v_fma_f32 v74, -v89, v89, v74
    v_fma_f32 v89, v89, v88, v75
    v_mov_b32 v88, v74
    v_mul_f32 v74, v88, v88
    v_mul_f32 v75, v88, v89
    v_fma_f32 v74, -v89, v89, v74
    v_fma_f32 v89, v89, v88, v75
    v_mov_b32 v88, v74
    v_mul_f32 v74, v88, v88
    v_mul_f32 v75, v88, v89
    v_fma_f32 v74, -v89, v89, v74
    v_fma_f32 v89, v89, v88, v75
    v_mov_b32 v88, v74
    v_mul_f32 v74, v88, v88
    v_mul_f32 v75, v88, v89
    v_fma_f32 v74, -v89, v89, v74
    v_fma_f32 v65, v89, v88, v75
    v_mov_b32 v64, v74
    v_mul_f32 v74, v64, v64
    v_mul_f32 v75, v64, v65
    v_fma_f32 v74, -v65, v65, v74
    v_fma_f32 v67, v65, v64, v75
    v_mov_b32 v66, v74
    v_mul_f32 v74, v66, v66
    v_mul_f32 v75, v66, v67
    v_fma_f32 v74, -v67, v67, v74
    v_fma_f32 v91, v67, v66, v75
    v_mov_b32 v90, v74
    s_bitcmp1_b32 s56, 0
    s_cselect_b64 s[78:79], -1, 0
    v_cndmask_b32 v64, 1.0, v64, s[78:79]
    v_cndmask_b32 v65, 0, v65, s[78:79]
    s_bitcmp1_b32 s56, 1
    s_cselect_b64 s[78:79], -1, 0
    v_cndmask_b32 v66, 1.0, v66, s[78:79]
    v_cndmask_b32 v67, 0, v67, s[78:79]
    v_mul_f32 v74, v64, v66
    v_mul_f32 v75, v64, v67
    v_fma_f32 v74, -v65, v67, v74
    v_fma_f32 v93, v65, v66, v75
    v_mov_b32 v92, v74
    v_mul_f32 v74, v92, v88
    v_mul_f32 v75, v92, v89
    s_nop 0
L_pad_Q_3:
    s_cbranch_execz L_ret_Q
    v_fma_f32 v74, -v93, v89, v74
    v_fma_f32 v95, v93, v88, v75
    v_mov_b32 v94, v74
    v_mov_b32 v82, v80
    v_mov_b32 v83, v81
    v_mov_b32 v86, v84
    v_mov_b32 v87, v85
    s_nop 1
    v_permlane32_swap_b32 v80, v82
    v_permlane32_swap_b32 v81, v83
    v_permlane32_swap_b32 v84, v86
    v_permlane32_swap_b32 v85, v87
    s_nop 1
    v_accvgpr_write_b32 a224, v80
    v_accvgpr_write_b32 a225, v81
    v_accvgpr_write_b32 a226, v82
    v_accvgpr_write_b32 a227, v83
    v_accvgpr_write_b32 a228, v84
    v_accvgpr_write_b32 a229, v85
    v_accvgpr_write_b32 a230, v86
    v_accvgpr_write_b32 a231, v87
    v_accvgpr_write_b32 a232, v88
    v_accvgpr_write_b32 a233, v89
    v_accvgpr_write_b32 a234, v90
    v_accvgpr_write_b32 a235, v91
    v_accvgpr_write_b32 a236, v92
    v_accvgpr_write_b32 a237, v93
    v_accvgpr_write_b32 a238, v94
    v_accvgpr_write_b32 a239, v95
    s_bfe_u32 s61, s2, 262147
    s_lshl2_add_u32 s61, s61, s56
    s_cmpk_ge_u32 s61, 0
    s_cbranch_scc1 L_ret_S
    s_mul_i32 s61, s61, 256
    s_getpc_b64 s[78:79]
L_pc_S:
    s_add_u32 s61, s61, L_pad_S_0-L_pc_S
    s_ashr_i32 s62, s61, 31
    s_add_u32 s78, s78, s61
    s_addc_u32 s79, s79, s62
    s_mov_b64 exec, 0
    s_setpc_b64 s[78:79]
L_ret_S:
    s_mov_b64 exec, -1
L_pad_Q_4:
    s_cbranch_execz L_ret_Q
    s_mov_b64 s[78:79], 0
R_S0:
    v_and_b32 v32, 1, v1
    v_lshlrev_b32 v32, 4, v32
    v_mov_b32 v33, 0x3f80
    v_lshlrev_b32 v32, v32, v33
    v_lshrrev_b32 v33, 3, v1
    v_xor_b32 v33, v33, v1
    v_and_b32 v33, 4, v33
    v_cmp_eq_u32 vcc, 0, v33
    v_cndmask_b32 v32, 0, v32, vcc
    v_bfe_u32 v33, v1, 3, 2
    v_bfe_u32 v34, v1, 1, 1
    v_lshl_add_u32 v33, v33, 1, v34
    v_cmp_eq_u32 vcc, 0, v33
    v_cndmask_b32 v34, 0, v32, vcc
    v_accvgpr_write_b32 a208, v34
    v_cmp_eq_u32 vcc, 1, v33
    v_cndmask_b32 v34, 0, v32, vcc
    v_accvgpr_write_b32 a209, v34
    v_cmp_eq_u32 vcc, 2, v33
    v_cndmask_b32 v34, 0, v32, vcc
    v_accvgpr_write_b32 a210, v34
    v_cmp_eq_u32 vcc, 3, v33
    v_cndmask_b32 v34, 0, v32, vcc
    v_accvgpr_write_b32 a211, v34
    v_cmp_eq_u32 vcc, 4, v33
    v_cndmask_b32 v34, 0, v32, vcc
    v_accvgpr_write_b32 a212, v34
    v_cmp_eq_u32 vcc, 5, v33
    v_cndmask_b32 v34, 0, v32, vcc
    v_accvgpr_write_b32 a213, v34
    v_cmp_eq_u32 vcc, 6, v33
    v_cndmask_b32 v34, 0, v32, vcc
    v_accvgpr_write_b32 a214, v34
    v_cmp_eq_u32 vcc, 7, v33
    v_cndmask_b32 v34, 0, v32, vcc
    v_accvgpr_write_b32 a215, v34
    v_add_u32 v14, s60, v10
    v_add_u32 v15, s60, v11
    v_add_u32 v16, s60, v12
    v_add_u32 v17, s60, v13
    v_mov_b32 v28, 0
    v_mov_b32 v29, 0
    v_mov_b32 v30, 0
    v_mov_b32 v31, 0
    s_waitcnt vmcnt(8)
    ds_read_b128 v[128:131], v14 offset:0
    ds_read_b128 v[132:135], v15 offset:0
    s_nop 0
L_pad_Q_5:
    s_cbranch_execz L_ret_Q
    ds_read_b128 v[136:139], v16 offset:0
    ds_read_b128 v[140:143], v17 offset:0
    s_add_u32 m0, s60, 49152
    s_add_u32 s61, s59, 3
    s_and_b32 s61, s61, 7
    s_mul_i32 s61, s61, 128
    buffer_load_dwordx4 v3, s[8:11], s61 offen offset:0 lds
    s_add_u32 s61, s61, 3072
    buffer_load_dwordx4 v4, s[8:11], s61 offen offset:1024 lds
    s_add_u32 s61, s61, 3072
    buffer_load_dwordx4 v3, s[8:11], s61 offen offset:2048 lds
    s_add_u32 s61, s61, 3072
    buffer_load_dwordx4 v4, s[8:11], s61 offen offset:3072 lds
    s_waitcnt vmcnt(8)
    s_waitcnt lgkmcnt(0)
    ds_read_b128 v[144:147], v14 offset:16384
    ds_read_b128 v[148:151], v15 offset:16384
    ds_read_b128 v[152:155], v16 offset:16384
    ds_read_b128 v[156:159], v17 offset:16384
    s_add_u32 m0, s60, 65536
    s_add_u32 s61, s59, 4
    s_and_b32 s61, s61, 7
    s_mul_i32 s61, s61, 128
    buffer_load_dwordx4 v3, s[8:11], s61 offen offset:0 lds
    v_dot2_f32_bf16 v28, v128, s72, v28
    v_dot2_f32_bf16 v29, v128, v128, v29
    v_dot2_f32_bf16 v30, v129, s72, v30
    v_dot2_f32_bf16 v31, v129, v129, v31
    s_add_u32 s61, s61, 3072
    buffer_load_dwordx4 v4, s[8:11], s61 offen offset:1024 lds
    v_dot2_f32_bf16 v28, v130, s72, v28
    v_dot2_f32_bf16 v29, v130, v130, v29
    v_dot2_f32_bf16 v30, v131, s72, v30
    v_dot2_f32_bf16 v31, v131, v131, v31
    s_nop 0
L_pad_Q_6:
    s_cbranch_execz L_ret_Q
    s_add_u32 s61, s61, 3072
    buffer_load_dwordx4 v3, s[8:11], s61 offen offset:2048 lds
    v_dot2_f32_bf16 v28, v132, s72, v28
    v_dot2_f32_bf16 v29, v132, v132, v29
    v_dot2_f32_bf16 v30, v133, s72, v30
    v_dot2_f32_bf16 v31, v133, v133, v31
    s_add_u32 s61, s61, 3072
    buffer_load_dwordx4 v4, s[8:11], s61 offen offset:3072 lds
    v_dot2_f32_bf16 v28, v134, s72, v28
    v_dot2_f32_bf16 v29, v134, v134, v29
    v_dot2_f32_bf16 v30, v135, s72, v30
    v_dot2_f32_bf16 v31, v135, v135, v31
    v_dot2_f32_bf16 v28, v136, s72, v28
    v_dot2_f32_bf16 v29, v136, v136, v29
    v_dot2_f32_bf16 v30, v137, s72, v30
    v_dot2_f32_bf16 v31, v137, v137, v31
    v_dot2_f32_bf16 v28, v138, s72, v28
    v_dot2_f32_bf16 v29, v138, v138, v29
    v_dot2_f32_bf16 v30, v139, s72, v30
    v_dot2_f32_bf16 v31, v139, v139, v31
    v_dot2_f32_bf16 v28, v140, s72, v28
    v_dot2_f32_bf16 v29, v140, v140, v29
    v_dot2_f32_bf16 v30, v141, s72, v30
    v_dot2_f32_bf16 v31, v141, v141, v31
    v_dot2_f32_bf16 v28, v142, s72, v28
    v_dot2_f32_bf16 v29, v142, v142, v29
    v_dot2_f32_bf16 v30, v143, s72, v30
    v_dot2_f32_bf16 v31, v143, v143, v31
    s_waitcnt vmcnt(8)
    s_waitcnt lgkmcnt(0)
    ds_read_b128 v[160:163], v14 offset:32768
    ds_read_b128 v[164:167], v15 offset:32768
    s_nop 0
L_pad_Q_7:
    s_cbranch_execz L_ret_Q
    ds_read_b128 v[168:171], v16 offset:32768
    ds_read_b128 v[172:175], v17 offset:32768
    s_add_u32 m0, s60, 81920
    s_add_u32 s61, s59, 5
    s_and_b32 s61, s61, 7
    s_mul_i32 s61, s61, 128
    buffer_load_dwordx4 v3, s[8:11], s61 offen offset:0 lds
    v_dot2_f32_bf16 v28, v144, s72, v28
    v_dot2_f32_bf16 v29, v144, v144, v29
    v_dot2_f32_bf16 v30, v145, s72, v30
    v_dot2_f32_bf16 v31, v145, v145, v31
    s_add_u32 s61, s61, 3072
    buffer_load_dwordx4 v4, s[8:11], s61 offen offset:1024 lds
    v_dot2_f32_bf16 v28, v146, s72, v28
    v_dot2_f32_bf16 v29, v146, v146, v29
    v_dot2_f32_bf16 v30, v147, s72, v30
    v_dot2_f32_bf16 v31, v147, v147, v31
    s_add_u32 s61, s61, 3072
    buffer_load_dwordx4 v3, s[8:11], s61 offen offset:2048 lds
    v_dot2_f32_bf16 v28, v148, s72, v28
    v_dot2_f32_bf16 v29, v148, v148, v29
    v_dot2_f32_bf16 v30, v149, s72, v30
    v_dot2_f32_bf16 v31, v149, v149, v31
    s_add_u32 s61, s61, 3072
    buffer_load_dwordx4 v4, s[8:11], s61 offen offset:3072 lds
    v_dot2_f32_bf16 v28, v150, s72, v28
    v_dot2_f32_bf16 v29, v150, v150, v29
    v_dot2_f32_bf16 v30, v151, s72, v30
    v_dot2_f32_bf16 v31, v151, v151, v31
    v_dot2_f32_bf16 v28, v152, s72, v28
    v_dot2_f32_bf16 v29, v152, v152, v29
    v_dot2_f32_bf16 v30, v153, s72, v30
    s_nop 0
L_pad_Q_8:
    s_cbranch_execz L_ret_Q
    v_dot2_f32_bf16 v31, v153, v153, v31
    v_dot2_f32_bf16 v28, v154, s72, v28
    v_dot2_f32_bf16 v29, v154, v154, v29
    v_dot2_f32_bf16 v30, v155, s72, v30
    v_dot2_f32_bf16 v31, v155, v155, v31
    v_dot2_f32_bf16 v28, v156, s72, v28
    v_dot2_f32_bf16 v29, v156, v156, v29
    v_dot2_f32_bf16 v30, v157, s72, v30
    v_dot2_f32_bf16 v31, v157, v157, v31
    v_dot2_f32_bf16 v28, v158, s72, v28
    v_dot2_f32_bf16 v29, v158, v158, v29
    v_dot2_f32_bf16 v30, v159, s72, v30
    v_dot2_f32_bf16 v31, v159, v159, v31
    s_waitcnt vmcnt(8)
    s_waitcnt lgkmcnt(0)
    ds_read_b128 v[176:179], v14 offset:49152
    ds_read_b128 v[180:183], v15 offset:49152
    ds_read_b128 v[184:187], v16 offset:49152
    ds_read_b128 v[188:191], v17 offset:49152
    s_add_u32 m0, s60, 98304
    s_add_u32 s61, s59, 6
    s_and_b32 s61, s61, 7
    s_mul_i32 s61, s61, 128
    buffer_load_dwordx4 v3, s[8:11], s61 offen offset:0 lds
    v_dot2_f32_bf16 v28, v160, s72, v28
    v_dot2_f32_bf16 v29, v160, v160, v29
    v_dot2_f32_bf16 v30, v161, s72, v30
    v_dot2_f32_bf16 v31, v161, v161, v31
    s_add_u32 s61, s61, 3072
    buffer_load_dwordx4 v4, s[8:11], s61 offen offset:1024 lds
    v_dot2_f32_bf16 v28, v162, s72, v28
    v_dot2_f32_bf16 v29, v162, v162, v29
    v_dot2_f32_bf16 v30, v163, s72, v30
    s_nop 0
L_pad_Q_9:
    s_cbranch_execz L_ret_Q
    v_dot2_f32_bf16 v31, v163, v163, v31
    s_add_u32 s61, s61, 3072
    buffer_load_dwordx4 v3, s[8:11], s61 offen offset:2048 lds
    v_dot2_f32_bf16 v28, v164, s72, v28
    v_dot2_f32_bf16 v29, v164, v164, v29
    v_dot2_f32_bf16 v30, v165, s72, v30
    v_dot2_f32_bf16 v31, v165, v165, v31
    s_add_u32 s61, s61, 3072
    buffer_load_dwordx4 v4, s[8:11], s61 offen offset:3072 lds
    v_dot2_f32_bf16 v28, v166, s72, v28
    v_dot2_f32_bf16 v29, v166, v166, v29
    v_dot2_f32_bf16 v30, v167, s72, v30
    v_dot2_f32_bf16 v31, v167, v167, v31
    v_dot2_f32_bf16 v28, v168, s72, v28
    v_dot2_f32_bf16 v29, v168, v168, v29
    v_dot2_f32_bf16 v30, v169, s72, v30
    v_dot2_f32_bf16 v31, v169, v169, v31
    v_dot2_f32_bf16 v28, v170, s72, v28
    v_dot2_f32_bf16 v29, v170, v170, v29
    v_dot2_f32_bf16 v30, v171, s72, v30
    v_dot2_f32_bf16 v31, v171, v171, v31
    v_dot2_f32_bf16 v28, v172, s72, v28
    v_dot2_f32_bf16 v29, v172, v172, v29
    v_dot2_f32_bf16 v30, v173, s72, v30
    v_dot2_f32_bf16 v31, v173, v173, v31
    v_dot2_f32_bf16 v28, v174, s72, v28
    v_dot2_f32_bf16 v29, v174, v174, v29
    v_dot2_f32_bf16 v30, v175, s72, v30
    v_dot2_f32_bf16 v31, v175, v175, v31
    s_waitcnt vmcnt(8)
    s_waitcnt lgkmcnt(0)
    v_add_u32 v40, 65536, v14
    s_nop 0
L_pad_Q_10:
    s_cbranch_execz L_ret_Q
    v_add_u32 v41, 65536, v15
    v_add_u32 v42, 65536, v16
    v_add_u32 v43, 65536, v17
    ds_read_b128 v[192:195], v40 offset:0
    ds_read_b128 v[196:199], v41 offset:0
    ds_read_b128 v[200:203], v42 offset:0
    ds_read_b128 v[204:207], v43 offset:0
    s_add_u32 m0, s60, 114688
    s_add_u32 s61, s59, 7
    s_and_b32 s61, s61, 7
    s_mul_i32 s61, s61, 128
    buffer_load_dwordx4 v3, s[8:11], s61 offen offset:0 lds
    v_dot2_f32_bf16 v28, v176, s72, v28
    v_dot2_f32_bf16 v29, v176, v176, v29
    v_dot2_f32_bf16 v30, v177, s72, v30
    v_dot2_f32_bf16 v31, v177, v177, v31
    s_add_u32 s61, s61, 3072
    buffer_load_dwordx4 v4, s[8:11], s61 offen offset:1024 lds
    v_dot2_f32_bf16 v28, v178, s72, v28
    v_dot2_f32_bf16 v29, v178, v178, v29
    v_dot2_f32_bf16 v30, v179, s72, v30
    v_dot2_f32_bf16 v31, v179, v179, v31
    s_add_u32 s61, s61, 3072
    buffer_load_dwordx4 v3, s[8:11], s61 offen offset:2048 lds
    v_dot2_f32_bf16 v28, v180, s72, v28
    v_dot2_f32_bf16 v29, v180, v180, v29
    v_dot2_f32_bf16 v30, v181, s72, v30
    v_dot2_f32_bf16 v31, v181, v181, v31
    s_add_u32 s61, s61, 3072
    buffer_load_dwordx4 v4, s[8:11], s61 offen offset:3072 lds
    v_dot2_f32_bf16 v28, v182, s72, v28
    v_dot2_f32_bf16 v29, v182, v182, v29
    s_nop 0
L_pad_Q_11:
    s_cbranch_execz L_ret_Q
    v_dot2_f32_bf16 v30, v183, s72, v30
    v_dot2_f32_bf16 v31, v183, v183, v31
    v_dot2_f32_bf16 v28, v184, s72, v28
    v_dot2_f32_bf16 v29, v184, v184, v29
    v_dot2_f32_bf16 v30, v185, s72, v30
    v_dot2_f32_bf16 v31, v185, v185, v31
    v_dot2_f32_bf16 v28, v186, s72, v28
    v_dot2_f32_bf16 v29, v186, v186, v29
    v_dot2_f32_bf16 v30, v187, s72, v30
    v_dot2_f32_bf16 v31, v187, v187, v31
    v_dot2_f32_bf16 v28, v188, s72, v28
    v_dot2_f32_bf16 v29, v188, v188, v29
    v_dot2_f32_bf16 v30, v189, s72, v30
    v_dot2_f32_bf16 v31, v189, v189, v31
    v_dot2_f32_bf16 v28, v190, s72, v28
    v_dot2_f32_bf16 v29, v190, v190, v29
    v_dot2_f32_bf16 v30, v191, s72, v30
    v_dot2_f32_bf16 v31, v191, v191, v31
    s_waitcnt vmcnt(8)
    s_waitcnt lgkmcnt(0)
    ds_read_b128 v[208:211], v40 offset:16384
    ds_read_b128 v[212:215], v41 offset:16384
    ds_read_b128 v[216:219], v42 offset:16384
    ds_read_b128 v[220:223], v43 offset:16384
    s_add_u32 m0, s60, 131072
    s_add_u32 s61, s3, 0
    s_and_b32 s61, s61, 7
    s_lshl_b32 s61, s61, 7
    s_add_u32 s61, s61, s73
    buffer_load_dwordx4 v5, s[12:15], s61 offen offset:0 lds
    v_dot2_f32_bf16 v28, v192, s72, v28
    v_dot2_f32_bf16 v29, v192, v192, v29
    v_dot2_f32_bf16 v30, v193, s72, v30
    v_dot2_f32_bf16 v31, v193, v193, v31
    s_nop 0
L_pad_Q_12:
    s_cbranch_execz L_ret_Q
    s_add_u32 s61, s61, 7168
    buffer_load_dwordx4 v6, s[12:15], s61 offen offset:1024 lds
    v_dot2_f32_bf16 v28, v194, s72, v28
    v_dot2_f32_bf16 v29, v194, v194, v29
    v_dot2_f32_bf16 v30, v195, s72, v30
    v_dot2_f32_bf16 v31, v195, v195, v31
    s_add_u32 s61, s61, 7168
    buffer_load_dwordx4 v5, s[12:15], s61 offen offset:2048 lds
    v_dot2_f32_bf16 v28, v196, s72, v28
    v_dot2_f32_bf16 v29, v196, v196, v29
    v_dot2_f32_bf16 v30, v197, s72, v30
    v_dot2_f32_bf16 v31, v197, v197, v31
    s_add_u32 s61, s61, 7168
    buffer_load_dwordx4 v6, s[12:15], s61 offen offset:3072 lds
    v_dot2_f32_bf16 v28, v198, s72, v28
    v_dot2_f32_bf16 v29, v198, v198, v29
    v_dot2_f32_bf16 v30, v199, s72, v30
    v_dot2_f32_bf16 v31, v199, v199, v31
    v_dot2_f32_bf16 v28, v200, s72, v28
    v_dot2_f32_bf16 v29, v200, v200, v29
    v_dot2_f32_bf16 v30, v201, s72, v30
    v_dot2_f32_bf16 v31, v201, v201, v31
    v_dot2_f32_bf16 v28, v202, s72, v28
    v_dot2_f32_bf16 v29, v202, v202, v29
    v_dot2_f32_bf16 v30, v203, s72, v30
    v_dot2_f32_bf16 v31, v203, v203, v31
    v_dot2_f32_bf16 v28, v204, s72, v28
    v_dot2_f32_bf16 v29, v204, v204, v29
    v_dot2_f32_bf16 v30, v205, s72, v30
    v_dot2_f32_bf16 v31, v205, v205, v31
    v_dot2_f32_bf16 v28, v206, s72, v28
    s_nop 0
L_pad_Q_13:
    s_cbranch_execz L_ret_Q
    v_dot2_f32_bf16 v29, v206, v206, v29
    v_dot2_f32_bf16 v30, v207, s72, v30
    v_dot2_f32_bf16 v31, v207, v207, v31
    s_waitcnt vmcnt(8)
    s_waitcnt lgkmcnt(0)
    ds_read_b128 v[224:227], v40 offset:32768
    ds_read_b128 v[228:231], v41 offset:32768
    ds_read_b128 v[232:235], v42 offset:32768
    ds_read_b128 v[236:239], v43 offset:32768
    s_add_u32 m0, s60, 147456
    s_add_u32 s61, s3, 2
    s_and_b32 s61, s61, 7
    s_lshl_b32 s61, s61, 7
    s_add_u32 s61, s61, s73
    buffer_load_dwordx4 v5, s[12:15], s61 offen offset:0 lds
    v_dot2_f32_bf16 v28, v208, s72, v28
    v_dot2_f32_bf16 v29, v208, v208, v29
    v_dot2_f32_bf16 v30, v209, s72, v30
    v_dot2_f32_bf16 v31, v209, v209, v31
    s_add_u32 s61, s61, 7168
    buffer_load_dwordx4 v6, s[12:15], s61 offen offset:1024 lds
    v_dot2_f32_bf16 v28, v210, s72, v28
    v_dot2_f32_bf16 v29, v210, v210, v29
    v_dot2_f32_bf16 v30, v211, s72, v30
    v_dot2_f32_bf16 v31, v211, v211, v31
    s_add_u32 s61, s61, 7168
    buffer_load_dwordx4 v5, s[12:15], s61 offen offset:2048 lds
    v_dot2_f32_bf16 v28, v212, s72, v28
    v_dot2_f32_bf16 v29, v212, v212, v29
    v_dot2_f32_bf16 v30, v213, s72, v30
    v_dot2_f32_bf16 v31, v213, v213, v31
    s_add_u32 s61, s61, 7168
    buffer_load_dwordx4 v6, s[12:15], s61 offen offset:3072 lds
    v_dot2_f32_bf16 v28, v214, s72, v28
    s_nop 0
L_pad_Q_14:
    s_cbranch_execz L_ret_Q
    v_dot2_f32_bf16 v29, v214, v214, v29
    v_dot2_f32_bf16 v30, v215, s72, v30
    v_dot2_f32_bf16 v31, v215, v215, v31
    v_dot2_f32_bf16 v28, v216, s72, v28
    v_dot2_f32_bf16 v29, v216, v216, v29
    v_dot2_f32_bf16 v30, v217, s72, v30
    v_dot2_f32_bf16 v31, v217, v217, v31
    v_dot2_f32_bf16 v28, v218, s72, v28
    v_dot2_f32_bf16 v29, v218, v218, v29
    v_dot2_f32_bf16 v30, v219, s72, v30
    v_dot2_f32_bf16 v31, v219, v219, v31
    v_dot2_f32_bf16 v28, v220, s72, v28
    v_dot2_f32_bf16 v29, v220, v220, v29
    v_dot2_f32_bf16 v30, v221, s72, v30
    v_dot2_f32_bf16 v31, v221, v221, v31
    v_dot2_f32_bf16 v28, v222, s72, v28
    v_dot2_f32_bf16 v29, v222, v222, v29
    v_dot2_f32_bf16 v30, v223, s72, v30
    v_dot2_f32_bf16 v31, v223, v223, v31
    s_waitcnt vmcnt(8)
    s_waitcnt lgkmcnt(0)
    ds_read_b128 v[240:243], v40 offset:49152
    ds_read_b128 v[244:247], v41 offset:49152
    ds_read_b128 v[248:251], v42 offset:49152
    ds_read_b128 v[252:255], v43 offset:49152
    s_add_u32 m0, s60, 0
    s_add_u32 s61, s3, 4
    s_and_b32 s61, s61, 7
    s_lshl_b32 s61, s61, 7
    s_add_u32 s61, s61, s73
    buffer_load_dwordx4 v5, s[12:15], s61 offen offset:0 lds
    v_dot2_f32_bf16 v28, v224, s72, v28
    v_dot2_f32_bf16 v29, v224, v224, v29
    v_dot2_f32_bf16 v30, v225, s72, v30
    v_dot2_f32_bf16 v31, v225, v225, v31
L_pad_Q_15:
    s_cbranch_execz L_ret_Q
    s_add_u32 s61, s61, 7168
    buffer_load_dwordx4 v6, s[12:15], s61 offen offset:1024 lds
    v_dot2_f32_bf16 v28, v226, s72, v28
    v_dot2_f32_bf16 v29, v226, v226, v29
    v_dot2_f32_bf16 v30, v227, s72, v30
    v_dot2_f32_bf16 v31, v227, v227, v31
    s_add_u32 s61, s61, 7168
    buffer_load_dwordx4 v5, s[12:15], s61 offen offset:2048 lds
    v_dot2_f32_bf16 v28, v228, s72, v28
    v_dot2_f32_bf16 v29, v228, v228, v29
    v_dot2_f32_bf16 v30, v229, s72, v30
    v_dot2_f32_bf16 v31, v229, v229, v31
    s_add_u32 s61, s61, 7168
    buffer_load_dwordx4 v6, s[12:15], s61 offen offset:3072 lds
    v_dot2_f32_bf16 v28, v230, s72, v28
    v_dot2_f32_bf16 v29, v230, v230, v29
    v_dot2_f32_bf16 v30, v231, s72, v30
    v_dot2_f32_bf16 v31, v231, v231, v31
    v_dot2_f32_bf16 v28, v232, s72, v28
    v_dot2_f32_bf16 v29, v232, v232, v29
    v_dot2_f32_bf16 v30, v233, s72, v30
    v_dot2_f32_bf16 v31, v233, v233, v31
    v_dot2_f32_bf16 v28, v234, s72, v28
    v_dot2_f32_bf16 v29, v234, v234, v29
    v_dot2_f32_bf16 v30, v235, s72, v30
    v_dot2_f32_bf16 v31, v235, v235, v31
    v_dot2_f32_bf16 v28, v236, s72, v28
    v_dot2_f32_bf16 v29, v236, v236, v29
    v_dot2_f32_bf16 v30, v237, s72, v30
    v_dot2_f32_bf16 v31, v237, v237, v31
    v_dot2_f32_bf16 v28, v238, s72, v28
    s_nop 0
L_pad_Q_16:
    s_cbranch_execz L_ret_Q
    v_dot2_f32_bf16 v29, v238, v238, v29
    v_dot2_f32_bf16 v30, v239, s72, v30
    v_dot2_f32_bf16 v31, v239, v239, v31
    s_waitcnt lgkmcnt(0)
    v_dot2_f32_bf16 v28, v240, s72, v28
    v_dot2_f32_bf16 v29, v240, v240, v29
    v_dot2_f32_bf16 v30, v241, s72, v30
    v_dot2_f32_bf16 v31, v241, v241, v31
    v_dot2_f32_bf16 v28, v242, s72, v28
    v_dot2_f32_bf16 v29, v242, v242, v29
    v_dot2_f32_bf16 v30, v243, s72, v30
    v_dot2_f32_bf16 v31, v243, v243, v31
    v_dot2_f32_bf16 v28, v244, s72, v28
    v_dot2_f32_bf16 v29, v244, v244, v29
    v_dot2_f32_bf16 v30, v245, s72, v30
    v_dot2_f32_bf16 v31, v245, v245, v31
    v_dot2_f32_bf16 v28, v246, s72, v28
    v_dot2_f32_bf16 v29, v246, v246, v29
    v_dot2_f32_bf16 v30, v247, s72, v30
    v_dot2_f32_bf16 v31, v247, v247, v31
    v_dot2_f32_bf16 v28, v248, s72, v28
    v_dot2_f32_bf16 v29, v248, v248, v29
    v_dot2_f32_bf16 v30, v249, s72, v30
    v_dot2_f32_bf16 v31, v249, v249, v31
    v_dot2_f32_bf16 v28, v250, s72, v28
    v_dot2_f32_bf16 v29, v250, v250, v29
    v_dot2_f32_bf16 v30, v251, s72, v30
    v_dot2_f32_bf16 v31, v251, v251, v31
    v_dot2_f32_bf16 v28, v252, s72, v28
    v_dot2_f32_bf16 v29, v252, v252, v29
    v_dot2_f32_bf16 v30, v253, s72, v30
    v_dot2_f32_bf16 v31, v253, v253, v31
L_pad_Q_17:
    s_cbranch_execz L_ret_Q
    v_dot2_f32_bf16 v28, v254, s72, v28
    v_dot2_f32_bf16 v29, v254, v254, v29
    v_dot2_f32_bf16 v30, v255, s72, v30
    v_dot2_f32_bf16 v31, v255, v255, v31
    s_nop 2
    v_add_f32 v28, v28, v30
    v_add_f32 v29, v29, v31
    v_mov_b32 v32, v28
    v_mov_b32 v33, v29
    s_nop 1
    v_permlane32_swap_b32 v28, v32
    v_permlane32_swap_b32 v29, v33
    s_nop 1
    v_add_f32 v28, v28, v32
    v_add_f32 v29, v29, v33
    v_mul_f32 v28, 0x3b000000, v28
    v_mul_f32 v29, 0x3b000000, v29
    v_fma_f32 v29, -v28, v28, v29
    v_max_f32 v29, 0, v29
    v_cvt_pk_bf16_f32 v29, v29, v29
    v_lshlrev_b32 v29, 16, v29
    v_cvt_pk_bf16_f32 v28, v28, v28
    v_lshlrev_b32 v28, 16, v28
    v_sub_f32 v112, 0, v28
    v_sub_f32 v113, 0, v28
    v_sub_f32 v114, 0, v28
    v_sub_f32 v115, 0, v28
    v_sub_f32 v116, 0, v28
    v_sub_f32 v117, 0, v28
    v_sub_f32 v118, 0, v28
    v_sub_f32 v119, 0, v28
    v_sub_f32 v120, 0, v28
    v_sub_f32 v121, 0, v28
    v_sub_f32 v122, 0, v28
    v_sub_f32 v123, 0, v28
    v_sub_f32 v124, 0, v28
    v_sub_f32 v125, 0, v28
    v_sub_f32 v126, 0, v28
    v_sub_f32 v127, 0, v28
    v_add_f32 v29, 0x3727c5ac, v29
    v_cvt_pk_bf16_f32 v29, v29, v29
    v_lshlrev_b32 v29, 16, v29
    v_sqrt_f32 v29, v29
    s_nop 0
    v_cvt_pk_bf16_f32 v29, v29, v29
    v_lshlrev_b32 v29, 16, v29
    v_rcp_f32 v30, v29
    s_nop 0
    v_mul_f32 v31, -v28, v30
    s_nop 0
L_pad_Q_18:
    s_cbranch_execz L_ret_Q
    v_mfma_f32_32x32x16_bf16 v[96:111], a[208:211], v[128:131], v[112:127]
    v_mfma_f32_32x32x16_bf16 v[96:111], a[212:215], v[132:135], v[96:111]
    s_nop 15
    v_cvt_pk_bf16_f32 v128, v96, v97
    v_cvt_pk_bf16_f32 v129, v98, v99
    v_cvt_pk_bf16_f32 v130, v100, v101
    v_cvt_pk_bf16_f32 v131, v102, v103
    v_cvt_pk_bf16_f32 v132, v104, v105
    v_cvt_pk_bf16_f32 v133, v106, v107
    v_cvt_pk_bf16_f32 v134, v108, v109
    v_cvt_pk_bf16_f32 v135, v110, v111
    s_waitcnt vmcnt(8)
    s_barrier
    s_cmp_lg_u32 s56, 0
    s_cbranch_scc1 L_fl4616
    s_and_b32 s61, s58, 1
    s_lshl_b32 s61, s61, 3
    s_lshl_b32 s61, 4194304, s61
    s_lshr_b32 s62, s58, 1
    s_lshl2_add_u32 s62, s57, s62
    s_lshl_b32 s62, s62, 2
    v_mov_b32 v39, s61
    s_mov_b64 exec, 1
    buffer_atomic_add v39, off, s[36:39], s62 sc1
    s_mov_b64 exec, -1
L_fl4616:
    v_add_u32 v14, 131072, v10
    v_add_u32 v15, 131072, v11
    v_add_u32 v16, 131072, v12
    v_add_u32 v17, 131072, v13
    ds_read_b128 v[40:43], v14 offset:0
    ds_read_b128 v[44:47], v14 offset:4096
    ds_read_b128 v[48:51], v15 offset:0
    ds_read_b128 v[52:55], v15 offset:4096
    s_waitcnt lgkmcnt(2)
    v_mfma_f32_32x32x16_bf16 v[96:111], a[208:211], v[136:139], v[112:127]
    ds_read_b128 v[56:59], v16 offset:0
    v_mfma_f32_32x32x16_bf16 v[96:111], a[212:215], v[140:143], v[96:111]
    ds_read_b128 v[60:63], v16 offset:4096
    s_nop 0
L_pad_Q_19:
    s_cbranch_execz L_ret_Q
    s_add_u32 m0, s60, 16384
    s_add_u32 s61, s3, 6
    s_and_b32 s61, s61, 7
    s_lshl_b32 s61, s61, 7
    s_add_u32 s61, s61, s73
    buffer_load_dwordx4 v5, s[12:15], s61 offen offset:0 lds
    v_mfma_f32_32x32x16_bf16 v[64:79], v[128:131], v[40:43], 0
    v_mfma_f32_32x32x16_bf16 v[80:95], v[128:131], v[44:47], 0
    v_cvt_pk_bf16_f32 v136, v96, v97
    v_cvt_pk_bf16_f32 v137, v98, v99
    v_cvt_pk_bf16_f32 v138, v100, v101
    v_cvt_pk_bf16_f32 v139, v102, v103
    s_add_u32 s61, s61, 7168
    buffer_load_dwordx4 v6, s[12:15], s61 offen offset:1024 lds
    s_waitcnt lgkmcnt(2)
    v_mfma_f32_32x32x16_bf16 v[64:79], v[132:135], v[48:51], v[64:79]
    v_cvt_pk_bf16_f32 v140, v104, v105
    v_cvt_pk_bf16_f32 v141, v106, v107
    v_cvt_pk_bf16_f32 v142, v108, v109
    v_cvt_pk_bf16_f32 v143, v110, v111
    ds_read_b128 v[40:43], v17 offset:0
    v_mfma_f32_32x32x16_bf16 v[80:95], v[132:135], v[52:55], v[80:95]
    ds_read_b128 v[44:47], v17 offset:4096
    s_add_u32 s61, s61, 7168
    buffer_load_dwordx4 v5, s[12:15], s61 offen offset:2048 lds
    s_waitcnt lgkmcnt(2)
    v_mfma_f32_32x32x16_bf16 v[96:111], a[208:211], v[144:147], v[112:127]
    ds_read_b128 v[48:51], v14 offset:8192
    v_mfma_f32_32x32x16_bf16 v[96:111], a[212:215], v[148:151], v[96:111]
    ds_read_b128 v[52:55], v14 offset:12288
    s_add_u32 s61, s61, 7168
    buffer_load_dwordx4 v6, s[12:15], s61 offen offset:3072 lds
    v_mfma_f32_32x32x16_bf16 v[64:79], v[136:139], v[56:59], v[64:79]
    v_mfma_f32_32x32x16_bf16 v[80:95], v[136:139], v[60:63], v[80:95]
    s_nop 0
L_pad_Q_20:
    s_cbranch_execz L_ret_Q
    v_cvt_pk_bf16_f32 v144, v96, v97
    v_cvt_pk_bf16_f32 v145, v98, v99
    v_cvt_pk_bf16_f32 v146, v100, v101
    v_cvt_pk_bf16_f32 v147, v102, v103
    s_add_u32 m0, s60, 32768
    s_add_u32 s61, s3, 0
    s_and_b32 s61, s61, 7
    s_lshl_b32 s61, s61, 7
    s_add_u32 s61, s61, s73
    s_add_u32 s61, s61, 32768
    buffer_load_dwordx4 v5, s[12:15], s61 offen offset:0 lds
    s_waitcnt lgkmcnt(2)
    v_mfma_f32_32x32x16_bf16 v[64:79], v[140:143], v[40:43], v[64:79]
    v_cvt_pk_bf16_f32 v148, v104, v105
    v_cvt_pk_bf16_f32 v149, v106, v107
    v_cvt_pk_bf16_f32 v150, v108, v109
    v_cvt_pk_bf16_f32 v151, v110, v111
    ds_read_b128 v[56:59], v15 offset:8192
    v_mfma_f32_32x32x16_bf16 v[80:95], v[140:143], v[44:47], v[80:95]
    ds_read_b128 v[60:63], v15 offset:12288
    s_add_u32 s61, s61, 7168
    buffer_load_dwordx4 v6, s[12:15], s61 offen offset:1024 lds
    s_waitcnt lgkmcnt(2)
    v_mfma_f32_32x32x16_bf16 v[96:111], a[208:211], v[152:155], v[112:127]
    ds_read_b128 v[40:43], v16 offset:8192
    v_mfma_f32_32x32x16_bf16 v[96:111], a[212:215], v[156:159], v[96:111]
    ds_read_b128 v[44:47], v16 offset:12288
    s_add_u32 s61, s61, 7168
    buffer_load_dwordx4 v5, s[12:15], s61 offen offset:2048 lds
    v_mfma_f32_32x32x16_bf16 v[64:79], v[144:147], v[48:51], v[64:79]
    v_mfma_f32_32x32x16_bf16 v[80:95], v[144:147], v[52:55], v[80:95]
    v_cvt_pk_bf16_f32 v152, v96, v97
    v_cvt_pk_bf16_f32 v153, v98, v99
    v_cvt_pk_bf16_f32 v154, v100, v101
    s_nop 0
L_pad_Q_21:
    s_cbranch_execz L_ret_Q
    v_cvt_pk_bf16_f32 v155, v102, v103
    s_add_u32 s61, s61, 7168
    buffer_load_dwordx4 v6, s[12:15], s61 offen offset:3072 lds
    s_waitcnt lgkmcnt(2)
    v_mfma_f32_32x32x16_bf16 v[64:79], v[148:151], v[56:59], v[64:79]
    v_cvt_pk_bf16_f32 v156, v104, v105
    v_cvt_pk_bf16_f32 v157, v106, v107
    v_cvt_pk_bf16_f32 v158, v108, v109
    v_cvt_pk_bf16_f32 v159, v110, v111
    ds_read_b128 v[48:51], v17 offset:8192
    v_mfma_f32_32x32x16_bf16 v[80:95], v[148:151], v[60:63], v[80:95]
    ds_read_b128 v[52:55], v17 offset:12288
    s_waitcnt lgkmcnt(2)
    v_mfma_f32_32x32x16_bf16 v[96:111], a[208:211], v[160:163], v[112:127]
    s_waitcnt vmcnt(12)
    s_barrier
    ds_read_b128 v[56:59], v14 offset:16384
    v_mfma_f32_32x32x16_bf16 v[96:111], a[212:215], v[164:167], v[96:111]
    ds_read_b128 v[60:63], v14 offset:20480
    s_add_u32 m0, s60, 49152
    s_add_u32 s61, s3, 2
    s_and_b32 s61, s61, 7
    s_lshl_b32 s61, s61, 7
    s_add_u32 s61, s61, s73
    s_add_u32 s61, s61, 32768
    buffer_load_dwordx4 v5, s[12:15], s61 offen offset:0 lds
    v_mfma_f32_32x32x16_bf16 v[64:79], v[152:155], v[40:43], v[64:79]
    v_mfma_f32_32x32x16_bf16 v[80:95], v[152:155], v[44:47], v[80:95]
    v_cvt_pk_bf16_f32 v160, v96, v97
    v_cvt_pk_bf16_f32 v161, v98, v99
    v_cvt_pk_bf16_f32 v162, v100, v101
    v_cvt_pk_bf16_f32 v163, v102, v103
    s_add_u32 s61, s61, 7168
    buffer_load_dwordx4 v6, s[12:15], s61 offen offset:1024 lds
    s_waitcnt lgkmcnt(2)
    v_mfma_f32_32x32x16_bf16 v[64:79], v[156:159], v[48:51], v[64:79]
L_pad_Q_22:
    s_cbranch_execz L_ret_Q
    v_cvt_pk_bf16_f32 v164, v104, v105
    v_cvt_pk_bf16_f32 v165, v106, v107
    v_cvt_pk_bf16_f32 v166, v108, v109
    v_cvt_pk_bf16_f32 v167, v110, v111
    ds_read_b128 v[40:43], v15 offset:16384
    v_mfma_f32_32x32x16_bf16 v[80:95], v[156:159], v[52:55], v[80:95]
    ds_read_b128 v[44:47], v15 offset:20480
    s_add_u32 s61, s61, 7168
    buffer_load_dwordx4 v5, s[12:15], s61 offen offset:2048 lds
    s_waitcnt lgkmcnt(2)
    v_mfma_f32_32x32x16_bf16 v[96:111], a[208:211], v[168:171], v[112:127]
    ds_read_b128 v[48:51], v16 offset:16384
    v_mfma_f32_32x32x16_bf16 v[96:111], a[212:215], v[172:175], v[96:111]
    ds_read_b128 v[52:55], v16 offset:20480
    s_add_u32 s61, s61, 7168
    buffer_load_dwordx4 v6, s[12:15], s61 offen offset:3072 lds
    v_mfma_f32_32x32x16_bf16 v[64:79], v[160:163], v[56:59], v[64:79]
    v_mfma_f32_32x32x16_bf16 v[80:95], v[160:163], v[60:63], v[80:95]
    v_cvt_pk_bf16_f32 v168, v96, v97
    v_cvt_pk_bf16_f32 v169, v98, v99
    v_cvt_pk_bf16_f32 v170, v100, v101
    v_cvt_pk_bf16_f32 v171, v102, v103
    s_add_u32 m0, s60, 65536
    s_add_u32 s61, s3, 4
    s_and_b32 s61, s61, 7
    s_lshl_b32 s61, s61, 7
    s_add_u32 s61, s61, s73
    s_add_u32 s61, s61, 32768
    buffer_load_dwordx4 v5, s[12:15], s61 offen offset:0 lds
    s_waitcnt lgkmcnt(2)
    v_mfma_f32_32x32x16_bf16 v[64:79], v[164:167], v[40:43], v[64:79]
    v_cvt_pk_bf16_f32 v172, v104, v105
    v_cvt_pk_bf16_f32 v173, v106, v107
    v_cvt_pk_bf16_f32 v174, v108, v109
    s_nop 0
L_pad_Q_23:
    s_cbranch_execz L_ret_Q
    v_cvt_pk_bf16_f32 v175, v110, v111
    ds_read_b128 v[56:59], v17 offset:16384
    v_mfma_f32_32x32x16_bf16 v[80:95], v[164:167], v[44:47], v[80:95]
    ds_read_b128 v[60:63], v17 offset:20480
    s_add_u32 s61, s61, 7168
    buffer_load_dwordx4 v6, s[12:15], s61 offen offset:1024 lds
    s_waitcnt lgkmcnt(2)
    v_mfma_f32_32x32x16_bf16 v[96:111], a[208:211], v[176:179], v[112:127]
    ds_read_b128 v[40:43], v14 offset:24576
    v_mfma_f32_32x32x16_bf16 v[96:111], a[212:215], v[180:183], v[96:111]
    ds_read_b128 v[44:47], v14 offset:28672
    s_add_u32 s61, s61, 7168
    buffer_load_dwordx4 v5, s[12:15], s61 offen offset:2048 lds
    v_mfma_f32_32x32x16_bf16 v[64:79], v[168:171], v[48:51], v[64:79]
    v_mfma_f32_32x32x16_bf16 v[80:95], v[168:171], v[52:55], v[80:95]
    v_cvt_pk_bf16_f32 v176, v96, v97
    v_cvt_pk_bf16_f32 v177, v98, v99
    v_cvt_pk_bf16_f32 v178, v100, v101
    v_cvt_pk_bf16_f32 v179, v102, v103
    s_add_u32 s61, s61, 7168
    buffer_load_dwordx4 v6, s[12:15], s61 offen offset:3072 lds
    s_waitcnt lgkmcnt(2)
    v_mfma_f32_32x32x16_bf16 v[64:79], v[172:175], v[56:59], v[64:79]
    v_cvt_pk_bf16_f32 v180, v104, v105
    v_cvt_pk_bf16_f32 v181, v106, v107
    v_cvt_pk_bf16_f32 v182, v108, v109
    v_cvt_pk_bf16_f32 v183, v110, v111
    ds_read_b128 v[48:51], v15 offset:24576
    v_mfma_f32_32x32x16_bf16 v[80:95], v[172:175], v[60:63], v[80:95]
    ds_read_b128 v[52:55], v15 offset:28672
    s_waitcnt lgkmcnt(2)
    v_mfma_f32_32x32x16_bf16 v[96:111], a[208:211], v[184:187], v[112:127]
    ds_read_b128 v[56:59], v16 offset:24576
L_pad_Q_24:
    s_cbranch_execz L_ret_Q
    v_mfma_f32_32x32x16_bf16 v[96:111], a[212:215], v[188:191], v[96:111]
    ds_read_b128 v[60:63], v16 offset:28672
    v_mfma_f32_32x32x16_bf16 v[64:79], v[176:179], v[40:43], v[64:79]
    v_mfma_f32_32x32x16_bf16 v[80:95], v[176:179], v[44:47], v[80:95]
    v_cvt_pk_bf16_f32 v184, v96, v97
    v_cvt_pk_bf16_f32 v185, v98, v99
    v_cvt_pk_bf16_f32 v186, v100, v101
    v_cvt_pk_bf16_f32 v187, v102, v103
    s_waitcnt lgkmcnt(2)
    v_mfma_f32_32x32x16_bf16 v[64:79], v[180:183], v[48:51], v[64:79]
    v_cvt_pk_bf16_f32 v188, v104, v105
    v_cvt_pk_bf16_f32 v189, v106, v107
    v_cvt_pk_bf16_f32 v190, v108, v109
    v_cvt_pk_bf16_f32 v191, v110, v111
    ds_read_b128 v[40:43], v17 offset:24576
    v_mfma_f32_32x32x16_bf16 v[80:95], v[180:183], v[52:55], v[80:95]
    ds_read_b128 v[44:47], v17 offset:28672
    s_waitcnt lgkmcnt(2)
    v_mfma_f32_32x32x16_bf16 v[96:111], a[208:211], v[192:195], v[112:127]
    s_waitcnt vmcnt(16)
    s_barrier
    ds_read_b128 v[48:51], v10 offset:0
    v_mfma_f32_32x32x16_bf16 v[96:111], a[212:215], v[196:199], v[96:111]
    ds_read_b128 v[52:55], v10 offset:4096
    s_add_u32 m0, s60, 81920
    s_add_u32 s61, s3, 6
    s_and_b32 s61, s61, 7
    s_lshl_b32 s61, s61, 7
    s_add_u32 s61, s61, s73
    s_add_u32 s61, s61, 32768
    buffer_load_dwordx4 v5, s[12:15], s61 offen offset:0 lds
    v_mfma_f32_32x32x16_bf16 v[64:79], v[184:187], v[56:59], v[64:79]
    v_mfma_f32_32x32x16_bf16 v[80:95], v[184:187], v[60:63], v[80:95]
    v_cvt_pk_bf16_f32 v192, v96, v97
    v_cvt_pk_bf16_f32 v193, v98, v99
    s_nop 0
L_pad_Q_25:
    s_cbranch_execz L_ret_Q
    v_cvt_pk_bf16_f32 v194, v100, v101
    v_cvt_pk_bf16_f32 v195, v102, v103
    s_add_u32 s61, s61, 7168
    buffer_load_dwordx4 v6, s[12:15], s61 offen offset:1024 lds
    s_waitcnt lgkmcnt(2)
    v_mfma_f32_32x32x16_bf16 v[64:79], v[188:191], v[40:43], v[64:79]
    v_cvt_pk_bf16_f32 v196, v104, v105
    v_cvt_pk_bf16_f32 v197, v106, v107
    v_cvt_pk_bf16_f32 v198, v108, v109
    v_cvt_pk_bf16_f32 v199, v110, v111
    ds_read_b128 v[56:59], v11 offset:0
    v_mfma_f32_32x32x16_bf16 v[80:95], v[188:191], v[44:47], v[80:95]
    ds_read_b128 v[60:63], v11 offset:4096
    s_add_u32 s61, s61, 7168
    buffer_load_dwordx4 v5, s[12:15], s61 offen offset:2048 lds
    s_waitcnt lgkmcnt(2)
    v_mfma_f32_32x32x16_bf16 v[96:111], a[208:211], v[200:203], v[112:127]
    ds_read_b128 v[40:43], v12 offset:0
    v_mfma_f32_32x32x16_bf16 v[96:111], a[212:215], v[204:207], v[96:111]
    ds_read_b128 v[44:47], v12 offset:4096
    s_add_u32 s61, s61, 7168
    buffer_load_dwordx4 v6, s[12:15], s61 offen offset:3072 lds
    v_mfma_f32_32x32x16_bf16 v[64:79], v[192:195], v[48:51], v[64:79]
    v_mfma_f32_32x32x16_bf16 v[80:95], v[192:195], v[52:55], v[80:95]
    v_cvt_pk_bf16_f32 v200, v96, v97
    v_cvt_pk_bf16_f32 v201, v98, v99
    v_cvt_pk_bf16_f32 v202, v100, v101
    v_cvt_pk_bf16_f32 v203, v102, v103
    s_add_u32 m0, s60, 98304
    s_xor_b32 s61, s70, 0
    buffer_load_dwordx4 v5, s[24:27], s61 offen offset:0 lds
    s_waitcnt lgkmcnt(2)
    v_mfma_f32_32x32x16_bf16 v[64:79], v[196:199], v[56:59], v[64:79]
    s_nop 0
L_pad_Q_26:
    s_cbranch_execz L_ret_Q
    v_cvt_pk_bf16_f32 v204, v104, v105
    v_cvt_pk_bf16_f32 v205, v106, v107
    v_cvt_pk_bf16_f32 v206, v108, v109
    v_cvt_pk_bf16_f32 v207, v110, v111
    ds_read_b128 v[48:51], v13 offset:0
    v_mfma_f32_32x32x16_bf16 v[80:95], v[196:199], v[60:63], v[80:95]
    ds_read_b128 v[52:55], v13 offset:4096
    s_add_u32 s61, s61, 7168
    buffer_load_dwordx4 v6, s[24:27], s61 offen offset:1024 lds
    s_waitcnt lgkmcnt(2)
    v_mfma_f32_32x32x16_bf16 v[96:111], a[208:211], v[208:211], v[112:127]
    ds_read_b128 v[56:59], v10 offset:8192
    v_mfma_f32_32x32x16_bf16 v[96:111], a[212:215], v[212:215], v[96:111]
    ds_read_b128 v[60:63], v10 offset:12288
    s_add_u32 s61, s61, 7168
    buffer_load_dwordx4 v5, s[24:27], s61 offen offset:2048 lds
    v_mfma_f32_32x32x16_bf16 v[64:79], v[200:203], v[40:43], v[64:79]
    v_mfma_f32_32x32x16_bf16 v[80:95], v[200:203], v[44:47], v[80:95]
    v_cvt_pk_bf16_f32 v208, v96, v97
    v_cvt_pk_bf16_f32 v209, v98, v99
    v_cvt_pk_bf16_f32 v210, v100, v101
    v_cvt_pk_bf16_f32 v211, v102, v103
    s_add_u32 s61, s61, 7168
    buffer_load_dwordx4 v6, s[24:27], s61 offen offset:3072 lds
    s_waitcnt lgkmcnt(2)
    v_mfma_f32_32x32x16_bf16 v[64:79], v[204:207], v[48:51], v[64:79]
    v_cvt_pk_bf16_f32 v212, v104, v105
    v_cvt_pk_bf16_f32 v213, v106, v107
    v_cvt_pk_bf16_f32 v214, v108, v109
    v_cvt_pk_bf16_f32 v215, v110, v111
    ds_read_b128 v[40:43], v11 offset:8192
    v_mfma_f32_32x32x16_bf16 v[80:95], v[204:207], v[52:55], v[80:95]
    s_nop 0
L_pad_Q_27:
    s_cbranch_execz L_ret_Q
    ds_read_b128 v[44:47], v11 offset:12288
    s_waitcnt lgkmcnt(2)
    v_mfma_f32_32x32x16_bf16 v[96:111], a[208:211], v[216:219], v[112:127]
    ds_read_b128 v[48:51], v12 offset:8192
    v_mfma_f32_32x32x16_bf16 v[96:111], a[212:215], v[220:223], v[96:111]
    ds_read_b128 v[52:55], v12 offset:12288
    v_mfma_f32_32x32x16_bf16 v[64:79], v[208:211], v[56:59], v[64:79]
    v_mfma_f32_32x32x16_bf16 v[80:95], v[208:211], v[60:63], v[80:95]
    v_cvt_pk_bf16_f32 v216, v96, v97
    v_cvt_pk_bf16_f32 v217, v98, v99
    v_cvt_pk_bf16_f32 v218, v100, v101
    v_cvt_pk_bf16_f32 v219, v102, v103
    s_waitcnt lgkmcnt(2)
    v_mfma_f32_32x32x16_bf16 v[64:79], v[212:215], v[40:43], v[64:79]
    v_cvt_pk_bf16_f32 v220, v104, v105
    v_cvt_pk_bf16_f32 v221, v106, v107
    v_cvt_pk_bf16_f32 v222, v108, v109
    v_cvt_pk_bf16_f32 v223, v110, v111
    ds_read_b128 v[56:59], v13 offset:8192
    v_mfma_f32_32x32x16_bf16 v[80:95], v[212:215], v[44:47], v[80:95]
    ds_read_b128 v[60:63], v13 offset:12288
    s_waitcnt lgkmcnt(2)
    v_mfma_f32_32x32x16_bf16 v[96:111], a[208:211], v[224:227], v[112:127]
    s_waitcnt vmcnt(20)
    s_barrier
    ds_read_b128 v[40:43], v10 offset:16384
    v_mfma_f32_32x32x16_bf16 v[96:111], a[212:215], v[228:231], v[96:111]
    ds_read_b128 v[44:47], v10 offset:20480
    s_add_u32 m0, s60, 114688
    s_xor_b32 s61, s70, 0
    buffer_load_dwordx4 v5, s[28:31], s61 offen offset:0 lds
    v_mfma_f32_32x32x16_bf16 v[64:79], v[216:219], v[48:51], v[64:79]
    v_mfma_f32_32x32x16_bf16 v[80:95], v[216:219], v[52:55], v[80:95]
    v_cvt_pk_bf16_f32 v224, v96, v97
    s_nop 0
L_pad_Q_28:
    s_cbranch_execz L_ret_Q
    v_cvt_pk_bf16_f32 v225, v98, v99
    v_cvt_pk_bf16_f32 v226, v100, v101
    v_cvt_pk_bf16_f32 v227, v102, v103
    s_add_u32 s61, s61, 7168
    buffer_load_dwordx4 v6, s[28:31], s61 offen offset:1024 lds
    s_waitcnt lgkmcnt(2)
    v_mfma_f32_32x32x16_bf16 v[64:79], v[220:223], v[56:59], v[64:79]
    v_cvt_pk_bf16_f32 v228, v104, v105
    v_cvt_pk_bf16_f32 v229, v106, v107
    v_cvt_pk_bf16_f32 v230, v108, v109
    v_cvt_pk_bf16_f32 v231, v110, v111
    ds_read_b128 v[48:51], v11 offset:16384
    v_mfma_f32_32x32x16_bf16 v[80:95], v[220:223], v[60:63], v[80:95]
    ds_read_b128 v[52:55], v11 offset:20480
    s_add_u32 s61, s61, 7168
    buffer_load_dwordx4 v5, s[28:31], s61 offen offset:2048 lds
    s_waitcnt lgkmcnt(2)
    v_mfma_f32_32x32x16_bf16 v[96:111], a[208:211], v[232:235], v[112:127]
    ds_read_b128 v[56:59], v12 offset:16384
    v_mfma_f32_32x32x16_bf16 v[96:111], a[212:215], v[236:239], v[96:111]
    ds_read_b128 v[60:63], v12 offset:20480
    s_add_u32 s61, s61, 7168
    buffer_load_dwordx4 v6, s[28:31], s61 offen offset:3072 lds
    v_mfma_f32_32x32x16_bf16 v[64:79], v[224:227], v[40:43], v[64:79]
    v_mfma_f32_32x32x16_bf16 v[80:95], v[224:227], v[44:47], v[80:95]
    v_cvt_pk_bf16_f32 v232, v96, v97
    v_cvt_pk_bf16_f32 v233, v98, v99
    v_cvt_pk_bf16_f32 v234, v100, v101
    v_cvt_pk_bf16_f32 v235, v102, v103
    s_add_u32 m0, s60, 131072
    s_xor_b32 s61, s70, 128
    buffer_load_dwordx4 v5, s[24:27], s61 offen offset:0 lds
    s_waitcnt lgkmcnt(2)
L_pad_Q_29:
    s_cbranch_execz L_ret_Q
    v_mfma_f32_32x32x16_bf16 v[64:79], v[228:231], v[48:51], v[64:79]
    v_cvt_pk_bf16_f32 v236, v104, v105
    v_cvt_pk_bf16_f32 v237, v106, v107
    v_cvt_pk_bf16_f32 v238, v108, v109
    v_cvt_pk_bf16_f32 v239, v110, v111
    ds_read_b128 v[40:43], v13 offset:16384
    v_mfma_f32_32x32x16_bf16 v[80:95], v[228:231], v[52:55], v[80:95]
    ds_read_b128 v[44:47], v13 offset:20480
    s_add_u32 s61, s61, 7168
    buffer_load_dwordx4 v6, s[24:27], s61 offen offset:1024 lds
    s_waitcnt lgkmcnt(2)
    v_mfma_f32_32x32x16_bf16 v[96:111], a[208:211], v[240:243], v[112:127]
    ds_read_b128 v[48:51], v10 offset:24576
    v_mfma_f32_32x32x16_bf16 v[96:111], a[212:215], v[244:247], v[96:111]
    ds_read_b128 v[52:55], v10 offset:28672
    s_add_u32 s61, s61, 7168
    buffer_load_dwordx4 v5, s[24:27], s61 offen offset:2048 lds
    v_mfma_f32_32x32x16_bf16 v[64:79], v[232:235], v[56:59], v[64:79]
    v_mfma_f32_32x32x16_bf16 v[80:95], v[232:235], v[60:63], v[80:95]
    v_cvt_pk_bf16_f32 v240, v96, v97
    v_cvt_pk_bf16_f32 v241, v98, v99
    v_cvt_pk_bf16_f32 v242, v100, v101
    v_cvt_pk_bf16_f32 v243, v102, v103
    s_add_u32 s61, s61, 7168
    buffer_load_dwordx4 v6, s[24:27], s61 offen offset:3072 lds
    s_waitcnt lgkmcnt(2)
    v_mfma_f32_32x32x16_bf16 v[64:79], v[236:239], v[40:43], v[64:79]
    v_cvt_pk_bf16_f32 v244, v104, v105
    v_cvt_pk_bf16_f32 v245, v106, v107
    v_cvt_pk_bf16_f32 v246, v108, v109
    v_cvt_pk_bf16_f32 v247, v110, v111
    ds_read_b128 v[56:59], v11 offset:24576
    s_nop 0
L_pad_Q_30:
    s_cbranch_execz L_ret_Q
    v_mfma_f32_32x32x16_bf16 v[80:95], v[236:239], v[44:47], v[80:95]
    ds_read_b128 v[60:63], v11 offset:28672
    s_waitcnt lgkmcnt(2)
    v_mfma_f32_32x32x16_bf16 v[96:111], a[208:211], v[248:251], v[112:127]
    ds_read_b128 v[40:43], v12 offset:24576
    v_mfma_f32_32x32x16_bf16 v[96:111], a[212:215], v[252:255], v[96:111]
    ds_read_b128 v[44:47], v12 offset:28672
    v_mfma_f32_32x32x16_bf16 v[64:79], v[240:243], v[48:51], v[64:79]
    v_mfma_f32_32x32x16_bf16 v[80:95], v[240:243], v[52:55], v[80:95]
    v_cvt_pk_bf16_f32 v248, v96, v97
    v_cvt_pk_bf16_f32 v249, v98, v99
    v_cvt_pk_bf16_f32 v250, v100, v101
    v_cvt_pk_bf16_f32 v251, v102, v103
    s_waitcnt lgkmcnt(2)
    v_mfma_f32_32x32x16_bf16 v[64:79], v[244:247], v[56:59], v[64:79]
    v_cvt_pk_bf16_f32 v252, v104, v105
    v_cvt_pk_bf16_f32 v253, v106, v107
    v_cvt_pk_bf16_f32 v254, v108, v109
    v_cvt_pk_bf16_f32 v255, v110, v111
    ds_read_b128 v[48:51], v13 offset:24576
    v_mfma_f32_32x32x16_bf16 v[80:95], v[244:247], v[60:63], v[80:95]
    ds_read_b128 v[52:55], v13 offset:28672
    s_waitcnt lgkmcnt(2)
    v_mfma_f32_32x32x16_bf16 v[64:79], v[248:251], v[40:43], v[64:79]
    s_waitcnt vmcnt(24)
    s_barrier
    ds_read_b128 v[56:59], v10 offset:32768
    v_mfma_f32_32x32x16_bf16 v[80:95], v[248:251], v[44:47], v[80:95]
    ds_read_b128 v[60:63], v10 offset:36864
    s_add_u32 m0, s60, 147456
    s_xor_b32 s61, s70, 128
    buffer_load_dwordx4 v5, s[28:31], s61 offen offset:0 lds
    s_waitcnt lgkmcnt(2)
    v_mfma_f32_32x32x16_bf16 v[64:79], v[252:255], v[48:51], v[64:79]
    s_nop 0
L_pad_Q_31:
    s_cbranch_execz L_ret_Q
    ds_read_b128 v[40:43], v11 offset:32768
    v_mfma_f32_32x32x16_bf16 v[80:95], v[252:255], v[52:55], v[80:95]
    ds_read_b128 v[44:47], v11 offset:36864
    s_add_u32 s61, s61, 7168
    buffer_load_dwordx4 v6, s[28:31], s61 offen offset:1024 lds
    s_waitcnt lgkmcnt(2)
    v_mfma_f32_32x32x16_bf16 v[96:111], v[128:131], v[56:59], 0
    ds_read_b128 v[48:51], v12 offset:32768
    v_mfma_f32_32x32x16_bf16 v[112:127], v[128:131], v[60:63], 0
    ds_read_b128 v[52:55], v12 offset:36864
    s_add_u32 s61, s61, 7168
    buffer_load_dwordx4 v5, s[28:31], s61 offen offset:2048 lds
    s_waitcnt lgkmcnt(2)
    v_mfma_f32_32x32x16_bf16 v[96:111], v[132:135], v[40:43], v[96:111]
    ds_read_b128 v[56:59], v13 offset:32768
    v_mfma_f32_32x32x16_bf16 v[112:127], v[132:135], v[44:47], v[112:127]
    ds_read_b128 v[60:63], v13 offset:36864
    s_add_u32 s61, s61, 7168
    buffer_load_dwordx4 v6, s[28:31], s61 offen offset:3072 lds
    s_waitcnt lgkmcnt(2)
    v_mfma_f32_32x32x16_bf16 v[96:111], v[136:139], v[48:51], v[96:111]
    ds_read_b128 v[40:43], v10 offset:40960
    s_add_u32 s78, s66, 1
    s_and_b32 s78, s78, 3
    s_mul_i32 s78, s78, 24576
    s_add_u32 s78, s78, s100
    buffer_store_dwordx4 a[248:251], v2, s[16:19], s78 offen offset:0 sc1
    s_add_u32 s78, s66, 1
    s_and_b32 s78, s78, 3
    s_mul_i32 s78, s78, 24576
    s_add_u32 s78, s78, s100
    buffer_store_dwordx4 a[248:251], v2, s[16:19], s78 offen offset:1024 sc1
    s_add_u32 s78, s66, 2
    s_and_b32 s78, s78, 3
    s_mul_i32 s78, s78, 24576
    s_add_u32 s78, s78, s100
    s_add_u32 s78, s78, 8192
    s_nop 0
L_pad_Q_32:
    s_cbranch_execz L_ret_Q
    buffer_store_dwordx4 a[248:251], v2, s[16:19], s78 offen offset:0 sc1
    s_add_u32 s78, s66, 2
    s_and_b32 s78, s78, 3
    s_mul_i32 s78, s78, 24576
    s_add_u32 s78, s78, s100
    s_add_u32 s78, s78, 8192
    buffer_store_dwordx4 a[248:251], v2, s[16:19], s78 offen offset:1024 sc1
    v_mfma_f32_32x32x16_bf16 v[112:127], v[136:139], v[52:55], v[112:127]
    ds_read_b128 v[44:47], v10 offset:45056
    s_add_u32 m0, s60, 0
    s_lshl_b32 s61, s74, 9
    s_add_u32 s61, s61, s68
    s_add_u32 s61, s61, s69
    buffer_load_dwordx4 v9, s[20:23], s61 offen offset:0 lds
    s_add_u32 s78, s66, 3
    s_and_b32 s78, s78, 3
    s_mul_i32 s78, s78, 24576
    s_add_u32 s78, s78, s100
    s_add_u32 s78, s78, 16384
    buffer_store_dwordx4 a[248:251], v2, s[16:19], s78 offen offset:0 sc1
    s_add_u32 s78, s66, 3
    s_and_b32 s78, s78, 3
    s_mul_i32 s78, s78, 24576
    s_add_u32 s78, s78, s100
    s_add_u32 s78, s78, 16384
    buffer_store_dwordx4 a[248:251], v2, s[16:19], s78 offen offset:1024 sc1
    s_waitcnt lgkmcnt(2)
    v_mfma_f32_32x32x16_bf16 v[96:111], v[140:143], v[56:59], v[96:111]
    ds_read_b128 v[48:51], v11 offset:40960
    v_mfma_f32_32x32x16_bf16 v[112:127], v[140:143], v[60:63], v[112:127]
    ds_read_b128 v[52:55], v11 offset:45056
    s_add_u32 s61, s61, 7168
    buffer_load_dwordx4 v9, s[20:23], s61 offen offset:1024 lds
    s_waitcnt lgkmcnt(2)
    v_mfma_f32_32x32x16_bf16 v[96:111], v[144:147], v[40:43], v[96:111]
    ds_read_b128 v[56:59], v12 offset:40960
    v_mfma_f32_32x32x16_bf16 v[112:127], v[144:147], v[44:47], v[112:127]
    ds_read_b128 v[60:63], v12 offset:45056
    s_add_u32 s61, s61, 7168
L_pad_Q_33:
    s_cbranch_execz L_ret_Q
    buffer_load_dwordx4 v9, s[20:23], s61 offen offset:2048 lds
    s_waitcnt lgkmcnt(2)
    v_mfma_f32_32x32x16_bf16 v[96:111], v[148:151], v[48:51], v[96:111]
    ds_read_b128 v[40:43], v13 offset:40960
    s_add_u32 s61, s61, 7168
    buffer_load_dwordx4 v9, s[20:23], s61 offen offset:3072 lds
    v_mfma_f32_32x32x16_bf16 v[112:127], v[148:151], v[52:55], v[112:127]
    ds_read_b128 v[44:47], v13 offset:45056
    s_waitcnt lgkmcnt(2)
    v_mfma_f32_32x32x16_bf16 v[96:111], v[152:155], v[56:59], v[96:111]
    s_waitcnt vmcnt(22)
    s_barrier
    ds_read_b128 v[48:51], v10 offset:49152
    s_add_u32 s79, s60, 98304
    v_add_u32 v28, s79, v10
    ds_read_b128 a[112:115], v28
    s_add_u32 s79, s60, 98304
    v_add_u32 v28, s79, v11
    ds_read_b128 a[116:119], v28
    s_add_u32 s79, s60, 98304
    v_add_u32 v28, s79, v12
    ds_read_b128 a[120:123], v28
    s_add_u32 s79, s60, 98304
    v_add_u32 v28, s79, v13
    ds_read_b128 a[124:127], v28
    v_mfma_f32_32x32x16_bf16 v[112:127], v[152:155], v[60:63], v[112:127]
    ds_read_b128 v[52:55], v10 offset:53248
    s_add_u32 m0, s60, 16384
    s_lshl_b32 s61, s74, 9
    s_xor_b32 s61, s61, 262144
    s_add_u32 s61, s61, s68
    s_add_u32 s61, s61, s69
    buffer_load_dwordx4 v9, s[20:23], s61 offen offset:0 lds
    s_waitcnt lgkmcnt(6)
    v_mfma_f32_32x32x16_bf16 v[96:111], v[156:159], v[40:43], v[96:111]
    ds_read_b128 v[56:59], v11 offset:49152
    v_mfma_f32_32x32x16_bf16 v[112:127], v[156:159], v[44:47], v[112:127]
    s_nop 0
L_pad_Q_34:
    s_cbranch_execz L_ret_Q
    ds_read_b128 v[60:63], v11 offset:53248
    s_add_u32 s61, s61, 7168
    buffer_load_dwordx4 v9, s[20:23], s61 offen offset:1024 lds
    s_waitcnt lgkmcnt(2)
    v_mfma_f32_32x32x16_bf16 v[96:111], v[160:163], v[48:51], v[96:111]
    ds_read_b128 v[40:43], v12 offset:49152
    s_lshr_b32 s78, s58, 1
    s_lshl_b32 s78, s78, 2
    buffer_load_dword v0, v2, s[36:39], s78 offen sc1
    v_mfma_f32_32x32x16_bf16 v[112:127], v[160:163], v[52:55], v[112:127]
    ds_read_b128 v[44:47], v12 offset:53248
    s_add_u32 s61, s61, 7168
    buffer_load_dwordx4 v9, s[20:23], s61 offen offset:2048 lds
    s_waitcnt lgkmcnt(2)
    v_mfma_f32_32x32x16_bf16 v[96:111], v[164:167], v[56:59], v[96:111]
    ds_read_b128 v[48:51], v13 offset:49152
    v_mfma_f32_32x32x16_bf16 v[112:127], v[164:167], v[60:63], v[112:127]
    ds_read_b128 v[52:55], v13 offset:53248
    s_add_u32 s61, s61, 7168
    buffer_load_dwordx4 v9, s[20:23], s61 offen offset:3072 lds
    s_waitcnt lgkmcnt(2)
    v_mfma_f32_32x32x16_bf16 v[96:111], v[168:171], v[40:43], v[96:111]
    ds_read_b128 v[56:59], v10 offset:57344
    v_mfma_f32_32x32x16_bf16 v[112:127], v[168:171], v[44:47], v[112:127]
    ds_read_b128 v[60:63], v10 offset:61440
    s_waitcnt lgkmcnt(2)
    v_mfma_f32_32x32x16_bf16 v[96:111], v[172:175], v[48:51], v[96:111]
    ds_read_b128 v[40:43], v11 offset:57344
    v_mfma_f32_32x32x16_bf16 v[112:127], v[172:175], v[52:55], v[112:127]
    ds_read_b128 v[44:47], v11 offset:61440
    s_waitcnt lgkmcnt(2)
    v_mfma_f32_32x32x16_bf16 v[96:111], v[176:179], v[56:59], v[96:111]
    ds_read_b128 v[48:51], v12 offset:57344
    v_mfma_f32_32x32x16_bf16 v[112:127], v[176:179], v[60:63], v[112:127]
    ds_read_b128 v[52:55], v12 offset:61440
L_pad_Q_35:
    s_cbranch_execz L_ret_Q
    s_waitcnt lgkmcnt(2)
    v_mfma_f32_32x32x16_bf16 v[96:111], v[180:183], v[40:43], v[96:111]
    ds_read_b128 v[56:59], v13 offset:57344
    v_mfma_f32_32x32x16_bf16 v[112:127], v[180:183], v[44:47], v[112:127]
    ds_read_b128 v[60:63], v13 offset:61440
    s_waitcnt lgkmcnt(2)
    v_mfma_f32_32x32x16_bf16 v[96:111], v[184:187], v[48:51], v[96:111]
    s_waitcnt vmcnt(19)
    s_barrier
    v_add_u32 v14, 65536, v10
    v_add_u32 v15, 65536, v11
    v_add_u32 v16, 65536, v12
    v_add_u32 v17, 65536, v13
    ds_read_b128 v[40:43], v14 offset:0
    s_add_u32 s79, s60, 114688
    v_add_u32 v28, s79, v10
    ds_read_b128 a[128:131], v28
    s_add_u32 s79, s60, 114688
    v_add_u32 v28, s79, v11
    ds_read_b128 a[132:135], v28
    s_add_u32 s79, s60, 114688
    v_add_u32 v28, s79, v12
    ds_read_b128 a[136:139], v28
    s_add_u32 s79, s60, 114688
    v_add_u32 v28, s79, v13
    ds_read_b128 a[140:143], v28
    v_mfma_f32_32x32x16_bf16 v[112:127], v[184:187], v[52:55], v[112:127]
    ds_read_b128 v[44:47], v14 offset:4096
    s_add_u32 m0, s60, 98304
    s_lshl_b32 s61, s75, 9
    s_add_u32 s61, s61, s68
    s_add_u32 s61, s61, s69
    buffer_load_dwordx4 v9, s[20:23], s61 offen offset:0 lds
    s_add_u32 s79, s60, 131072
    v_add_u32 v28, s79, v10
    ds_read_b128 a[144:147], v28
    s_add_u32 s79, s60, 131072
    v_add_u32 v28, s79, v11
L_pad_Q_36:
    s_cbranch_execz L_ret_Q
    ds_read_b128 a[148:151], v28
    s_waitcnt lgkmcnt(8)
    v_mfma_f32_32x32x16_bf16 v[96:111], v[188:191], v[56:59], v[96:111]
    ds_read_b128 v[48:51], v15 offset:0
    s_add_u32 s79, s60, 131072
    v_add_u32 v28, s79, v12
    ds_read_b128 a[152:155], v28
    s_add_u32 s79, s60, 131072
    v_add_u32 v28, s79, v13
    ds_read_b128 a[156:159], v28
    v_mfma_f32_32x32x16_bf16 v[112:127], v[188:191], v[60:63], v[112:127]
    ds_read_b128 v[52:55], v15 offset:4096
    s_add_u32 s61, s61, 7168
    buffer_load_dwordx4 v9, s[20:23], s61 offen offset:1024 lds
    s_waitcnt lgkmcnt(6)
    v_mfma_f32_32x32x16_bf16 v[96:111], v[192:195], v[40:43], v[96:111]
    ds_read_b128 v[56:59], v16 offset:0
    v_mfma_f32_32x32x16_bf16 v[112:127], v[192:195], v[44:47], v[112:127]
    ds_read_b128 v[60:63], v16 offset:4096
    s_add_u32 s61, s61, 7168
    buffer_load_dwordx4 v9, s[20:23], s61 offen offset:2048 lds
    s_waitcnt lgkmcnt(2)
    v_mfma_f32_32x32x16_bf16 v[96:111], v[196:199], v[48:51], v[96:111]
    ds_read_b128 v[40:43], v17 offset:0
    v_mfma_f32_32x32x16_bf16 v[112:127], v[196:199], v[52:55], v[112:127]
    ds_read_b128 v[44:47], v17 offset:4096
    s_add_u32 s61, s61, 7168
    buffer_load_dwordx4 v9, s[20:23], s61 offen offset:3072 lds
    s_waitcnt lgkmcnt(2)
    v_mfma_f32_32x32x16_bf16 v[96:111], v[200:203], v[56:59], v[96:111]
    ds_read_b128 v[48:51], v14 offset:8192
    v_mfma_f32_32x32x16_bf16 v[112:127], v[200:203], v[60:63], v[112:127]
    ds_read_b128 v[52:55], v14 offset:12288
    s_add_u32 m0, s60, 32768
    s_lshl_b32 s61, s75, 9
L_pad_Q_37:
    s_cbranch_execz L_ret_Q
    s_xor_b32 s61, s61, 262144
    s_add_u32 s61, s61, s68
    s_add_u32 s61, s61, s69
    buffer_load_dwordx4 v9, s[20:23], s61 offen offset:0 lds
    s_waitcnt lgkmcnt(2)
    v_mfma_f32_32x32x16_bf16 v[96:111], v[204:207], v[40:43], v[96:111]
    ds_read_b128 v[56:59], v15 offset:8192
    v_mfma_f32_32x32x16_bf16 v[112:127], v[204:207], v[44:47], v[112:127]
    ds_read_b128 v[60:63], v15 offset:12288
    s_add_u32 s61, s61, 7168
    buffer_load_dwordx4 v9, s[20:23], s61 offen offset:1024 lds
    s_waitcnt lgkmcnt(2)
    v_mfma_f32_32x32x16_bf16 v[96:111], v[208:211], v[48:51], v[96:111]
    ds_read_b128 v[40:43], v16 offset:8192
    v_mfma_f32_32x32x16_bf16 v[112:127], v[208:211], v[52:55], v[112:127]
    ds_read_b128 v[44:47], v16 offset:12288
    s_add_u32 s61, s61, 7168
    buffer_load_dwordx4 v9, s[20:23], s61 offen offset:2048 lds
    s_waitcnt lgkmcnt(2)
    v_mfma_f32_32x32x16_bf16 v[96:111], v[212:215], v[56:59], v[96:111]
    ds_read_b128 v[48:51], v17 offset:8192
    s_add_u32 s61, s61, 7168
    buffer_load_dwordx4 v9, s[20:23], s61 offen offset:3072 lds
    v_mfma_f32_32x32x16_bf16 v[112:127], v[212:215], v[60:63], v[112:127]
    ds_read_b128 v[52:55], v17 offset:12288
    s_waitcnt lgkmcnt(2)
    v_mfma_f32_32x32x16_bf16 v[96:111], v[216:219], v[40:43], v[96:111]
    s_waitcnt vmcnt(13)
    s_barrier
    ds_read_b128 v[56:59], v14 offset:16384
    s_add_u32 s79, s60, 147456
    v_add_u32 v28, s79, v10
    ds_read_b128 a[160:163], v28
    s_add_u32 s79, s60, 147456
    v_add_u32 v28, s79, v11
    ds_read_b128 a[164:167], v28
    s_nop 0
L_pad_Q_38:
    s_cbranch_execz L_ret_Q
    s_add_u32 s79, s60, 147456
    v_add_u32 v28, s79, v12
    ds_read_b128 a[168:171], v28
    s_add_u32 s79, s60, 147456
    v_add_u32 v28, s79, v13
    ds_read_b128 a[172:175], v28
    v_mfma_f32_32x32x16_bf16 v[112:127], v[216:219], v[44:47], v[112:127]
    ds_read_b128 v[60:63], v14 offset:20480
    s_add_u32 m0, s60, 114688
    s_lshl_b32 s61, s76, 9
    s_add_u32 s61, s61, s68
    s_add_u32 s61, s61, s69
    buffer_load_dwordx4 v9, s[20:23], s61 offen offset:0 lds
    ds_read_b64_tr_b16 a[0:1], v24 offset:0
    ds_read_b64_tr_b16 a[2:3], v24 offset:1024
    s_waitcnt lgkmcnt(8)
    v_mfma_f32_32x32x16_bf16 v[96:111], v[220:223], v[48:51], v[96:111]
    ds_read_b128 v[40:43], v15 offset:16384
    ds_read_b64_tr_b16 a[4:5], v24 offset:2048
    ds_read_b64_tr_b16 a[6:7], v24 offset:3072
    ds_read_b64_tr_b16 a[8:9], v24 offset:8192
    ds_read_b64_tr_b16 a[10:11], v24 offset:9216
    v_mfma_f32_32x32x16_bf16 v[112:127], v[220:223], v[52:55], v[112:127]
    ds_read_b128 v[44:47], v15 offset:20480
    s_add_u32 s61, s61, 7168
    buffer_load_dwordx4 v9, s[20:23], s61 offen offset:1024 lds
    ds_read_b64_tr_b16 a[12:13], v24 offset:10240
    ds_read_b64_tr_b16 a[14:15], v24 offset:11264
    s_waitcnt lgkmcnt(10)
    v_mfma_f32_32x32x16_bf16 v[96:111], v[224:227], v[56:59], v[96:111]
    ds_read_b128 v[48:51], v16 offset:16384
    s_add_u32 s78, s60, 51200
    v_lshl_add_u32 v32, v1, 2, s78
    ds_write_b32 v32, v30
    v_lshrrev_b32 v32, 5, v1
    s_nop 0
L_pad_Q_39:
    s_cbranch_execz L_ret_Q
    v_lshl_add_u32 v32, v32, 4, s78
    ds_read_b128 v[208:211], v32 offset:0
    ds_read_b128 v[212:215], v32 offset:32
    ds_read_b128 v[216:219], v32 offset:64
    v_mfma_f32_32x32x16_bf16 v[112:127], v[224:227], v[60:63], v[112:127]
    ds_read_b128 v[52:55], v16 offset:20480
    s_add_u32 s61, s61, 7168
    buffer_load_dwordx4 v9, s[20:23], s61 offen offset:2048 lds
    ds_read_b128 v[220:223], v32 offset:96
    s_waitcnt lgkmcnt(9)
    v_mfma_f32_32x32x16_bf16 v[96:111], v[228:231], v[40:43], v[96:111]
    ds_read_b128 v[56:59], v17 offset:16384
    v_mfma_f32_32x32x16_bf16 v[112:127], v[228:231], v[44:47], v[112:127]
    ds_read_b128 v[60:63], v17 offset:20480
    s_add_u32 s61, s61, 7168
    buffer_load_dwordx4 v9, s[20:23], s61 offen offset:3072 lds
    s_waitcnt lgkmcnt(3)
    v_mfma_f32_32x32x16_bf16 v[96:111], v[232:235], v[48:51], v[96:111]
    ds_read_b128 v[40:43], v14 offset:24576
    v_mfma_f32_32x32x16_bf16 v[112:127], v[232:235], v[52:55], v[112:127]
    ds_read_b128 v[44:47], v14 offset:28672
    s_add_u32 m0, s60, 131072
    s_lshl_b32 s61, s76, 9
    s_xor_b32 s61, s61, 262144
    s_add_u32 s61, s61, s68
    s_add_u32 s61, s61, s69
    buffer_load_dwordx4 v9, s[20:23], s61 offen offset:0 lds
    s_waitcnt lgkmcnt(2)
    v_mfma_f32_32x32x16_bf16 v[96:111], v[236:239], v[56:59], v[96:111]
    ds_read_b128 v[48:51], v15 offset:24576
    v_mul_f32 v64, v64, v208
    v_mul_f32 v65, v65, v209
    v_mul_f32 v66, v66, v210
    v_mfma_f32_32x32x16_bf16 v[112:127], v[236:239], v[60:63], v[112:127]
    ds_read_b128 v[52:55], v15 offset:28672
    s_add_u32 s61, s61, 7168
L_pad_Q_40:
    s_cbranch_execz L_ret_Q
    buffer_load_dwordx4 v9, s[20:23], s61 offen offset:1024 lds
    v_mul_f32 v67, v67, v211
    v_mul_f32 v68, v68, v212
    s_waitcnt lgkmcnt(2)
    v_mfma_f32_32x32x16_bf16 v[96:111], v[240:243], v[40:43], v[96:111]
    ds_read_b128 v[56:59], v16 offset:24576
    v_mul_f32 v69, v69, v213
    v_mul_f32 v70, v70, v214
    v_mul_f32 v71, v71, v215
    v_mul_f32 v72, v72, v216
    v_mfma_f32_32x32x16_bf16 v[112:127], v[240:243], v[44:47], v[112:127]
    ds_read_b128 v[60:63], v16 offset:28672
    s_add_u32 s61, s61, 7168
    buffer_load_dwordx4 v9, s[20:23], s61 offen offset:2048 lds
    v_mul_f32 v73, v73, v217
    v_mul_f32 v74, v74, v218
    s_waitcnt lgkmcnt(2)
    v_mfma_f32_32x32x16_bf16 v[96:111], v[244:247], v[48:51], v[96:111]
    ds_read_b128 v[40:43], v17 offset:24576
    s_add_u32 s61, s61, 7168
    buffer_load_dwordx4 v9, s[20:23], s61 offen offset:3072 lds
    v_mul_f32 v75, v75, v219
    v_mul_f32 v76, v76, v220
    v_mfma_f32_32x32x16_bf16 v[112:127], v[244:247], v[52:55], v[112:127]
    ds_read_b128 v[44:47], v17 offset:28672
    v_mul_f32 v77, v77, v221
    v_mul_f32 v78, v78, v222
    v_mul_f32 v79, v79, v223
    v_mul_f32 v80, v80, v208
    s_waitcnt lgkmcnt(2)
    v_mfma_f32_32x32x16_bf16 v[96:111], v[248:251], v[56:59], v[96:111]
    v_mul_f32 v81, v81, v209
    v_mul_f32 v82, v82, v210
    v_mul_f32 v83, v83, v211
    v_mul_f32 v84, v84, v212
    v_mfma_f32_32x32x16_bf16 v[112:127], v[248:251], v[60:63], v[112:127]
    v_mul_f32 v85, v85, v213
    v_mul_f32 v86, v86, v214
    v_mul_f32 v87, v87, v215
    v_mul_f32 v88, v88, v216
    s_waitcnt lgkmcnt(0)
    v_mfma_f32_32x32x16_bf16 v[96:111], v[252:255], v[40:43], v[96:111]
    v_mul_f32 v89, v89, v217
    v_mul_f32 v90, v90, v218
    v_mul_f32 v91, v91, v219
    v_mul_f32 v92, v92, v220
    s_nop 0
L_pad_Q_41:
    s_cbranch_execz L_ret_Q
    v_mfma_f32_32x32x16_bf16 v[112:127], v[252:255], v[44:47], v[112:127]
    v_mul_f32 v93, v93, v221
    v_mul_f32 v94, v94, v222
    v_mul_f32 v95, v95, v223
R_S1:
    v_accvgpr_read_b32 v128, a224
    v_accvgpr_read_b32 v129, a225
    v_accvgpr_read_b32 v130, a226
    v_accvgpr_read_b32 v131, a227
    v_accvgpr_read_b32 v132, a228
    v_accvgpr_read_b32 v133, a229
    v_accvgpr_read_b32 v134, a230
    v_accvgpr_read_b32 v135, a231
    v_accvgpr_read_b32 v136, a232
    v_accvgpr_read_b32 v137, a233
    v_accvgpr_read_b32 v138, a234
    v_accvgpr_read_b32 v139, a235
    v_accvgpr_read_b32 v140, a236
    v_accvgpr_read_b32 v141, a237
    v_accvgpr_read_b32 v142, a238
    v_accvgpr_read_b32 v143, a239
    v_and_b32 v32, 31, v1
    v_lshrrev_b32 v33, 5, v1
    v_lshlrev_b32 v34, 3, v32
    v_lshl_add_u32 v34, v33, 9, v34
    s_add_u32 s61, s60, 49152
    v_add_u32 v34, s61, v34
    v_lshlrev_b32 v35, 3, v1
    v_add_u32 v35, 49152, v35
    v_lshlrev_b32 v36, 6, v32
    v_lshl_add_u32 v36, v33, 5, v36
    s_add_u32 s61, s60, 65536
    s_add_u32 s62, s60, 81920
    v_add_u32 v8, s62, v36
    v_add_u32 v36, s61, v36
    v_add_u32 v23, s62, v22
    v_add_u32 v22, s61, v22
    v_mul_f32 v96, v96, v208
    v_mul_f32 v97, v97, v209
    v_mul_f32 v98, v98, v210
    v_mul_f32 v99, v99, v211
L_pad_Q_42:
    s_cbranch_execz L_ret_Q
    v_mul_f32 v100, v100, v212
    v_mul_f32 v101, v101, v213
    v_mul_f32 v102, v102, v214
    v_mul_f32 v103, v103, v215
    v_mul_f32 v104, v104, v216
    v_mul_f32 v105, v105, v217
    v_mul_f32 v106, v106, v218
    v_mul_f32 v107, v107, v219
    v_mul_f32 v108, v108, v220
    v_mul_f32 v109, v109, v221
    v_mul_f32 v110, v110, v222
    v_mul_f32 v111, v111, v223
    v_mul_f32 v112, v112, v208
    v_mul_f32 v113, v113, v209
    v_mul_f32 v114, v114, v210
    v_mul_f32 v115, v115, v211
    v_mul_f32 v116, v116, v212
    v_mul_f32 v117, v117, v213
    v_mul_f32 v118, v118, v214
    v_mul_f32 v119, v119, v215
    v_mul_f32 v120, v120, v216
    v_mul_f32 v121, v121, v217
    v_mul_f32 v122, v122, v218
    v_mul_f32 v123, v123, v219
    v_mul_f32 v124, v124, v220
    v_mul_f32 v125, v125, v221
    v_mul_f32 v126, v126, v222
    v_mul_f32 v127, v127, v223
    v_fma_f32 v146, v128, v64, v65
    v_fma_f32 v147, v128, v80, v81
    v_fma_f32 v146, -v129, v80, v146
    v_fma_f32 v147, v129, v64, v147
    v_fma_f32 v150, v130, v96, v97
    v_fma_f32 v151, v130, v112, v113
    v_fma_f32 v150, -v131, v112, v150
    v_fma_f32 v151, v131, v96, v151
    v_fma_f32 v144, v128, v146, v66
    v_fma_f32 v145, v128, v147, v82
    v_fma_f32 v144, -v129, v147, v144
    v_fma_f32 v145, v129, v146, v145
    v_fma_f32 v148, v130, v150, v98
    v_fma_f32 v149, v130, v151, v114
    v_fma_f32 v148, -v131, v151, v148
    v_fma_f32 v149, v131, v150, v149
    v_fma_f32 v146, v128, v144, v67
    s_nop 0
L_pad_Q_43:
    s_cbranch_execz L_ret_Q
    v_fma_f32 v147, v128, v145, v83
    v_fma_f32 v146, -v129, v145, v146
    v_fma_f32 v147, v129, v144, v147
    v_fma_f32 v150, v130, v148, v99
    v_fma_f32 v151, v130, v149, v115
    v_fma_f32 v150, -v131, v149, v150
    v_fma_f32 v151, v131, v148, v151
    v_fma_f32 v144, v128, v146, v68
    v_fma_f32 v145, v128, v147, v84
    v_fma_f32 v144, -v129, v147, v144
    v_fma_f32 v145, v129, v146, v145
    v_fma_f32 v148, v130, v150, v100
    v_fma_f32 v149, v130, v151, v116
    v_fma_f32 v148, -v131, v151, v148
    v_fma_f32 v149, v131, v150, v149
    v_fma_f32 v146, v128, v144, v69
    v_fma_f32 v147, v128, v145, v85
    v_fma_f32 v146, -v129, v145, v146
    v_fma_f32 v147, v129, v144, v147
    v_fma_f32 v150, v130, v148, v101
    v_fma_f32 v151, v130, v149, v117
    v_fma_f32 v150, -v131, v149, v150
    v_fma_f32 v151, v131, v148, v151
    v_fma_f32 v144, v128, v146, v70
    v_fma_f32 v145, v128, v147, v86
    v_fma_f32 v144, -v129, v147, v144
    v_fma_f32 v145, v129, v146, v145
    v_fma_f32 v148, v130, v150, v102
    v_fma_f32 v149, v130, v151, v118
    v_fma_f32 v148, -v131, v151, v148
    v_fma_f32 v149, v131, v150, v149
    s_nop 0
L_pad_Q_44:
    s_cbranch_execz L_ret_Q
    v_fma_f32 v146, v128, v144, v71
    v_fma_f32 v147, v128, v145, v87
    v_fma_f32 v146, -v129, v145, v146
    v_fma_f32 v147, v129, v144, v147
    v_fma_f32 v150, v130, v148, v103
    v_fma_f32 v151, v130, v149, v119
    v_fma_f32 v150, -v131, v149, v150
    v_fma_f32 v151, v131, v148, v151
    v_fma_f32 v144, v128, v146, v72
    v_fma_f32 v145, v128, v147, v88
    v_fma_f32 v144, -v129, v147, v144
    v_fma_f32 v145, v129, v146, v145
    v_fma_f32 v148, v130, v150, v104
    v_fma_f32 v149, v130, v151, v120
    v_fma_f32 v148, -v131, v151, v148
    v_fma_f32 v149, v131, v150, v149
    v_fma_f32 v146, v128, v144, v73
    v_fma_f32 v147, v128, v145, v89
    v_fma_f32 v146, -v129, v145, v146
    v_fma_f32 v147, v129, v144, v147
    v_fma_f32 v150, v130, v148, v105
    v_fma_f32 v151, v130, v149, v121
    v_fma_f32 v150, -v131, v149, v150
    v_fma_f32 v151, v131, v148, v151
    v_fma_f32 v144, v128, v146, v74
    v_fma_f32 v145, v128, v147, v90
    v_fma_f32 v144, -v129, v147, v144
    v_fma_f32 v145, v129, v146, v145
    v_fma_f32 v148, v130, v150, v106
    v_fma_f32 v149, v130, v151, v122
    v_fma_f32 v148, -v131, v151, v148
    s_nop 0
L_pad_Q_45:
    s_cbranch_execz L_ret_Q
    v_fma_f32 v149, v131, v150, v149
    v_fma_f32 v146, v128, v144, v75
    v_fma_f32 v147, v128, v145, v91
    v_fma_f32 v146, -v129, v145, v146
    v_fma_f32 v147, v129, v144, v147
    v_fma_f32 v150, v130, v148, v107
    v_fma_f32 v151, v130, v149, v123
    v_fma_f32 v150, -v131, v149, v150
    v_fma_f32 v151, v131, v148, v151
    v_fma_f32 v144, v128, v146, v76
    v_fma_f32 v145, v128, v147, v92
    v_fma_f32 v144, -v129, v147, v144
    v_fma_f32 v145, v129, v146, v145
    v_fma_f32 v148, v130, v150, v108
    v_fma_f32 v149, v130, v151, v124
    v_fma_f32 v148, -v131, v151, v148
    v_fma_f32 v149, v131, v150, v149
    v_fma_f32 v146, v128, v144, v77
    v_fma_f32 v147, v128, v145, v93
    v_fma_f32 v146, -v129, v145, v146
    v_fma_f32 v147, v129, v144, v147
    v_fma_f32 v150, v130, v148, v109
    v_fma_f32 v151, v130, v149, v125
    v_fma_f32 v150, -v131, v149, v150
    v_fma_f32 v151, v131, v148, v151
    v_fma_f32 v144, v128, v146, v78
    v_fma_f32 v145, v128, v147, v94
    v_fma_f32 v144, -v129, v147, v144
    v_fma_f32 v145, v129, v146, v145
    v_fma_f32 v148, v130, v150, v110
    v_fma_f32 v149, v130, v151, v126
    s_nop 0
L_pad_Q_46:
    s_cbranch_execz L_ret_Q
    v_fma_f32 v148, -v131, v151, v148
    v_fma_f32 v149, v131, v150, v149
    v_fma_f32 v146, v128, v144, v79
    v_fma_f32 v147, v128, v145, v95
    v_fma_f32 v146, -v129, v145, v146
    v_fma_f32 v147, v129, v144, v147
    v_fma_f32 v150, v130, v148, v111
    v_fma_f32 v151, v130, v149, v127
    v_fma_f32 v150, -v131, v149, v150
    v_fma_f32 v151, v131, v148, v151
    ds_write_b64 v34, v[146:147] offset:0
    ds_write_b64 v34, v[150:151] offset:256
    s_waitcnt lgkmcnt(0)
    s_waitcnt vmcnt(8)
    s_barrier
    ds_read_b64 v[160:161], v35 offset:0
    ds_read_b64 v[162:163], v35 offset:512
    ds_read_b64 v[164:165], v35 offset:4096
    ds_read_b64 v[166:167], v35 offset:4608
    ds_read_b64 v[168:169], v35 offset:8192
    ds_read_b64 v[170:171], v35 offset:8704
    ds_read_b64 v[172:173], v35 offset:12288
    ds_read_b64 v[174:175], v35 offset:12800
    v_mov_b32 v176, 0
    v_mov_b32 v177, 0
    s_waitcnt lgkmcnt(0)
    v_mov_b32 v178, v160
    v_mov_b32 v179, v161
    v_fma_f32 v180, v136, v178, v162
    v_fma_f32 v181, v136, v179, v163
    v_fma_f32 v180, -v137, v179, v180
    v_fma_f32 v181, v137, v178, v181
    v_fma_f32 v182, v136, v180, v164
    v_fma_f32 v183, v136, v181, v165
    v_fma_f32 v182, -v137, v181, v182
    s_nop 0
L_pad_Q_47:
    s_cbranch_execz L_ret_Q
    v_fma_f32 v183, v137, v180, v183
    v_fma_f32 v184, v136, v182, v166
    v_fma_f32 v185, v136, v183, v167
    v_fma_f32 v184, -v137, v183, v184
    v_fma_f32 v185, v137, v182, v185
    v_fma_f32 v186, v136, v184, v168
    v_fma_f32 v187, v136, v185, v169
    v_fma_f32 v186, -v137, v185, v186
    v_fma_f32 v187, v137, v184, v187
    v_fma_f32 v188, v136, v186, v170
    v_fma_f32 v189, v136, v187, v171
    v_fma_f32 v188, -v137, v187, v188
    v_fma_f32 v189, v137, v186, v189
    v_fma_f32 v190, v136, v188, v172
    v_fma_f32 v191, v136, v189, v173
    v_fma_f32 v190, -v137, v189, v190
    v_fma_f32 v191, v137, v188, v191
    v_fma_f32 v192, v136, v190, v174
    v_fma_f32 v193, v136, v191, v175
    v_fma_f32 v192, -v137, v191, v192
    v_fma_f32 v193, v137, v190, v193
    s_cmp_lg_u32 s56, 0
    s_cbranch_scc1 L_nopub
    v_cmp_eq_u32 vcc, -1, v192
    v_mov_b32 v32, 0x7fc00000
    v_cndmask_b32 v192, v192, v32, vcc
    buffer_store_dwordx2 v[192:193], v7, s[40:43], 0 offen sc1
L_nopub:
    ds_read_b64_tr_b16 a[64:65], v24 offset:16384
    ds_read_b64_tr_b16 a[66:67], v24 offset:17408
    ds_read_b64_tr_b16 a[68:69], v24 offset:18432
    ds_read_b64_tr_b16 a[70:71], v24 offset:19456
    ds_read_b64_tr_b16 a[72:73], v24 offset:24576
    ds_read_b64_tr_b16 a[74:75], v24 offset:25600
    s_nop 0
L_pad_Q_48:
    s_cbranch_execz L_ret_Q
    ds_read_b64_tr_b16 a[76:77], v24 offset:26624
    ds_read_b64_tr_b16 a[78:79], v24 offset:27648
    v_add_u32 v26, 65536, v24
    ds_read_b64_tr_b16 a[16:17], v26 offset:32768
    ds_read_b64_tr_b16 a[18:19], v26 offset:33792
    ds_read_b64_tr_b16 a[20:21], v26 offset:34816
    ds_read_b64_tr_b16 a[22:23], v26 offset:35840
    ds_read_b64_tr_b16 a[24:25], v26 offset:40960
    ds_read_b64_tr_b16 a[26:27], v26 offset:41984
    ds_read_b64_tr_b16 a[28:29], v26 offset:43008
    ds_read_b64_tr_b16 a[30:31], v26 offset:44032
    ds_read_b64_tr_b16 a[80:81], v24 offset:32768
    ds_read_b64_tr_b16 a[82:83], v24 offset:33792
    ds_read_b64_tr_b16 a[84:85], v24 offset:34816
    ds_read_b64_tr_b16 a[86:87], v24 offset:35840
    ds_read_b64_tr_b16 a[88:89], v24 offset:40960
    ds_read_b64_tr_b16 a[90:91], v24 offset:41984
    ds_read_b64_tr_b16 a[92:93], v24 offset:43008
    ds_read_b64_tr_b16 a[94:95], v24 offset:44032
    s_and_b32 s61, s58, 1
    s_lshl_b32 s61, s61, 3
    s_lshl_b32 s61, 0x400000, s61
    v_and_b32 v0, s61, v0
    v_cmp_eq_u32 vcc, 0, v0
    s_bfm_b32 s61, s57, 0
    s_and_b32 s61, s61, vcc_lo
    s_cmp_eq_u32 s61, 0
    s_cbranch_scc1 L_cl_ok
    s_mov_b32 s65, 0x40000
L_cl:
    s_lshr_b32 s78, s58, 1
    s_lshl_b32 s78, s78, 2
    buffer_load_dword v0, v2, s[36:39], s78 offen sc1
    s_waitcnt vmcnt(0)
    s_and_b32 s61, s58, 1
    s_lshl_b32 s61, s61, 3
    s_lshl_b32 s61, 0x400000, s61
    v_and_b32 v0, s61, v0
    v_cmp_eq_u32 vcc, 0, v0
    s_bfm_b32 s61, s57, 0
    s_and_b32 s61, s61, vcc_lo
L_pad_Q_49:
    s_cbranch_execz L_ret_Q
    s_cmp_eq_u32 s61, 0
    s_cbranch_scc1 L_cl_ok
    s_sleep 1
    s_sub_u32 s65, s65, 1
    s_cbranch_scc0 L_cl
L_cl_ok:
    v_add_u32 v37, 512, v7
    v_add_u32 v38, 4608, v7
    buffer_load_dwordx2 v[200:201], v37, s[40:43], 0 offen offset:0 sc1
    buffer_load_dwordx2 v[202:203], v37, s[40:43], 0 offen offset:512 sc1
    buffer_load_dwordx2 v[204:205], v37, s[40:43], 0 offen offset:1024 sc1
    buffer_load_dwordx2 v[206:207], v37, s[40:43], 0 offen offset:1536 sc1
    buffer_load_dwordx2 v[208:209], v37, s[40:43], 0 offen offset:2048 sc1
    buffer_load_dwordx2 v[210:211], v37, s[40:43], 0 offen offset:2560 sc1
    buffer_load_dwordx2 v[212:213], v37, s[40:43], 0 offen offset:3072 sc1
    buffer_load_dwordx2 v[214:215], v37, s[40:43], 0 offen offset:3584 sc1
    buffer_load_dwordx2 v[216:217], v38, s[40:43], 0 offen offset:0 sc1
    buffer_load_dwordx2 v[218:219], v38, s[40:43], 0 offen offset:512 sc1
    buffer_load_dwordx2 v[220:221], v38, s[40:43], 0 offen offset:1024 sc1
    buffer_load_dwordx2 v[222:223], v38, s[40:43], 0 offen offset:1536 sc1
    buffer_load_dwordx2 v[224:225], v38, s[40:43], 0 offen offset:2048 sc1
    buffer_load_dwordx2 v[226:227], v38, s[40:43], 0 offen offset:2560 sc1
    buffer_load_dwordx2 v[228:229], v38, s[40:43], 0 offen offset:3072 sc1
    s_lshl_b32 s78, s57, 4
    buffer_load_dwordx4 v[232:235], off, s[36:39], s78 sc1
    s_cmp_eq_u32 s56, 1
    s_cselect_b64 s[78:79], -1, 0
    v_cndmask_b32 v176, v176, v180, s[78:79]
    v_cndmask_b32 v177, v177, v181, s[78:79]
    v_cndmask_b32 v178, v178, v182, s[78:79]
    v_cndmask_b32 v179, v179, v183, s[78:79]
    s_cmp_eq_u32 s56, 2
    s_cselect_b64 s[78:79], -1, 0
    v_cndmask_b32 v176, v176, v184, s[78:79]
    v_cndmask_b32 v177, v177, v185, s[78:79]
    v_cndmask_b32 v178, v178, v186, s[78:79]
    v_cndmask_b32 v179, v179, v187, s[78:79]
    s_cmp_eq_u32 s56, 3
L_pad_Q_50:
    s_cbranch_execz L_ret_Q
    s_cselect_b64 s[78:79], -1, 0
    v_cndmask_b32 v176, v176, v188, s[78:79]
    v_cndmask_b32 v177, v177, v189, s[78:79]
    v_cndmask_b32 v178, v178, v190, s[78:79]
    v_cndmask_b32 v179, v179, v191, s[78:79]
    v_mul_f32 v144, -v133, v80
    v_mul_f32 v80, -v132, v80
    v_fma_f32 v80, -v133, v64, v80
    v_fma_f32 v64, v132, v64, v144
    v_mul_f32 v145, -v135, v112
    v_mul_f32 v112, -v134, v112
    v_fma_f32 v112, -v135, v96, v112
    v_fma_f32 v96, v134, v96, v145
    v_mul_f32 v144, -v133, v81
    v_mul_f32 v81, -v132, v81
    v_fma_f32 v81, -v133, v65, v81
    v_fma_f32 v65, v132, v65, v144
    v_mul_f32 v145, -v135, v113
    v_mul_f32 v113, -v134, v113
    v_fma_f32 v113, -v135, v97, v113
    v_fma_f32 v97, v134, v97, v145
    v_mul_f32 v144, -v133, v82
    v_mul_f32 v82, -v132, v82
    v_fma_f32 v82, -v133, v66, v82
    v_fma_f32 v66, v132, v66, v144
    v_mul_f32 v145, -v135, v114
    v_mul_f32 v114, -v134, v114
    v_fma_f32 v114, -v135, v98, v114
    v_fma_f32 v98, v134, v98, v145
    v_mul_f32 v144, -v133, v83
    v_mul_f32 v83, -v132, v83
    v_fma_f32 v83, -v133, v67, v83
L_pad_Q_51:
    s_cbranch_execz L_ret_Q
    v_fma_f32 v67, v132, v67, v144
    v_mul_f32 v145, -v135, v115
    v_mul_f32 v115, -v134, v115
    v_fma_f32 v115, -v135, v99, v115
    v_fma_f32 v99, v134, v99, v145
    v_mul_f32 v144, -v133, v84
    v_mul_f32 v84, -v132, v84
    v_fma_f32 v84, -v133, v68, v84
    v_fma_f32 v68, v132, v68, v144
    v_mul_f32 v145, -v135, v116
    v_mul_f32 v116, -v134, v116
    v_fma_f32 v116, -v135, v100, v116
    v_fma_f32 v100, v134, v100, v145
    v_mul_f32 v144, -v133, v85
    v_mul_f32 v85, -v132, v85
    v_fma_f32 v85, -v133, v69, v85
    v_fma_f32 v69, v132, v69, v144
    v_mul_f32 v145, -v135, v117
    v_mul_f32 v117, -v134, v117
    v_fma_f32 v117, -v135, v101, v117
    v_fma_f32 v101, v134, v101, v145
    v_mul_f32 v144, -v133, v86
    v_mul_f32 v86, -v132, v86
    v_fma_f32 v86, -v133, v70, v86
    v_fma_f32 v70, v132, v70, v144
    v_mul_f32 v145, -v135, v118
    v_mul_f32 v118, -v134, v118
    v_fma_f32 v118, -v135, v102, v118
    v_fma_f32 v102, v134, v102, v145
    v_mul_f32 v144, -v133, v87
    v_mul_f32 v87, -v132, v87
    s_nop 0
L_pad_Q_52:
    s_cbranch_execz L_ret_Q
    v_fma_f32 v87, -v133, v71, v87
    v_fma_f32 v71, v132, v71, v144
    v_mul_f32 v145, -v135, v119
    v_mul_f32 v119, -v134, v119
    v_fma_f32 v119, -v135, v103, v119
    v_fma_f32 v103, v134, v103, v145
    v_mul_f32 v144, -v133, v88
    v_mul_f32 v88, -v132, v88
    v_fma_f32 v88, -v133, v72, v88
    v_fma_f32 v72, v132, v72, v144
    v_mul_f32 v145, -v135, v120
    v_mul_f32 v120, -v134, v120
    v_fma_f32 v120, -v135, v104, v120
    v_fma_f32 v104, v134, v104, v145
    v_mul_f32 v144, -v133, v89
    v_mul_f32 v89, -v132, v89
    v_fma_f32 v89, -v133, v73, v89
    v_fma_f32 v73, v132, v73, v144
    v_mul_f32 v145, -v135, v121
    v_mul_f32 v121, -v134, v121
    v_fma_f32 v121, -v135, v105, v121
    v_fma_f32 v105, v134, v105, v145
    v_mul_f32 v144, -v133, v90
    v_mul_f32 v90, -v132, v90
    v_fma_f32 v90, -v133, v74, v90
    v_fma_f32 v74, v132, v74, v144
    v_mul_f32 v145, -v135, v122
    v_mul_f32 v122, -v134, v122
    v_fma_f32 v122, -v135, v106, v122
    v_fma_f32 v106, v134, v106, v145
    v_mul_f32 v144, -v133, v91
    s_nop 0
L_pad_Q_53:
    s_cbranch_execz L_ret_Q
    v_mul_f32 v91, -v132, v91
    v_fma_f32 v91, -v133, v75, v91
    v_fma_f32 v75, v132, v75, v144
    v_mul_f32 v145, -v135, v123
    v_mul_f32 v123, -v134, v123
    v_fma_f32 v123, -v135, v107, v123
    v_fma_f32 v107, v134, v107, v145
    v_mul_f32 v144, -v133, v92
    v_mul_f32 v92, -v132, v92
    v_fma_f32 v92, -v133, v76, v92
    v_fma_f32 v76, v132, v76, v144
    v_mul_f32 v145, -v135, v124
    v_mul_f32 v124, -v134, v124
    v_fma_f32 v124, -v135, v108, v124
    v_fma_f32 v108, v134, v108, v145
    v_mul_f32 v144, -v133, v93
    v_mul_f32 v93, -v132, v93
    v_fma_f32 v93, -v133, v77, v93
    v_fma_f32 v77, v132, v77, v144
    v_mul_f32 v145, -v135, v125
    v_mul_f32 v125, -v134, v125
    v_fma_f32 v125, -v135, v109, v125
    v_fma_f32 v109, v134, v109, v145
    v_mul_f32 v144, -v133, v94
    v_mul_f32 v94, -v132, v94
    v_fma_f32 v94, -v133, v78, v94
    v_fma_f32 v78, v132, v78, v144
    v_mul_f32 v145, -v135, v126
    v_mul_f32 v126, -v134, v126
    v_fma_f32 v126, -v135, v110, v126
    v_fma_f32 v110, v134, v110, v145
    s_nop 0
L_pad_Q_54:
    s_cbranch_execz L_ret_Q
    v_mul_f32 v144, -v133, v95
    v_mul_f32 v95, -v132, v95
    v_fma_f32 v95, -v133, v79, v95
    v_fma_f32 v79, v132, v79, v144
    v_mul_f32 v145, -v135, v127
    v_mul_f32 v127, -v134, v127
    v_fma_f32 v127, -v135, v111, v127
    v_fma_f32 v111, v134, v111, v145
    s_bfe_u32 s61, s2, 262147
    s_lshl2_add_u32 s61, s61, s56
    s_cmpk_ge_u32 s61, 36
    s_cbranch_scc1 L_ret_G
    s_mul_i32 s61, s61, 256
    s_getpc_b64 s[78:79]
L_pc_G:
    s_add_u32 s61, s61, L_pad_G_0-L_pc_G
    s_ashr_i32 s62, s61, 31
    s_add_u32 s78, s78, s61
    s_addc_u32 s79, s79, s62
    s_mov_b64 exec, 0
    s_setpc_b64 s[78:79]
L_ret_G:
    s_mov_b64 exec, -1
    s_mov_b64 s[78:79], 0
    s_bfe_u32 s61, s2, 262147
    s_lshl2_add_u32 s61, s61, s56
    s_xor_b32 s61, s61, 63
    s_cmpk_ge_u32 s61, 33
    s_cbranch_scc1 L_ret_H
    s_mul_i32 s61, s61, 256
    s_getpc_b64 s[78:79]
L_pc_H:
    s_add_u32 s61, s61, L_pad_H_0-L_pc_H
    s_ashr_i32 s62, s61, 31
    s_add_u32 s78, s78, s61
    s_addc_u32 s79, s79, s62
    s_mov_b64 exec, 0
    s_setpc_b64 s[78:79]
L_ret_H:
    s_mov_b64 exec, -1
    s_mov_b64 s[78:79], 0
    s_waitcnt vmcnt(0)
    v_max3_u32 v32, v200, v202, v204
    v_max3_u32 v32, v32, v206, v208
    v_max3_u32 v32, v32, v210, v212
    v_max3_u32 v32, v32, v214, v216
    v_max3_u32 v32, v32, v218, v220
    s_nop 0
L_pad_Q_55:
    s_cbranch_execz L_ret_Q
    v_max3_u32 v32, v32, v222, v224
    v_max3_u32 v32, v32, v226, v228
    v_cmp_eq_u32 vcc, -1, v32
    s_cmp_eq_u64 vcc, 0
    s_cbranch_scc1 L_gr_ok
    s_mov_b32 s65, 0x40000
L_gr:
    buffer_load_dwordx2 v[200:201], v37, s[40:43], 0 offen offset:0 sc1
    buffer_load_dwordx2 v[202:203], v37, s[40:43], 0 offen offset:512 sc1
    buffer_load_dwordx2 v[204:205], v37, s[40:43], 0 offen offset:1024 sc1
    buffer_load_dwordx2 v[206:207], v37, s[40:43], 0 offen offset:1536 sc1
    buffer_load_dwordx2 v[208:209], v37, s[40:43], 0 offen offset:2048 sc1
    buffer_load_dwordx2 v[210:211], v37, s[40:43], 0 offen offset:2560 sc1
    buffer_load_dwordx2 v[212:213], v37, s[40:43], 0 offen offset:3072 sc1
    buffer_load_dwordx2 v[214:215], v37, s[40:43], 0 offen offset:3584 sc1
    buffer_load_dwordx2 v[216:217], v38, s[40:43], 0 offen offset:0 sc1
    buffer_load_dwordx2 v[218:219], v38, s[40:43], 0 offen offset:512 sc1
    buffer_load_dwordx2 v[220:221], v38, s[40:43], 0 offen offset:1024 sc1
    buffer_load_dwordx2 v[222:223], v38, s[40:43], 0 offen offset:1536 sc1
    buffer_load_dwordx2 v[224:225], v38, s[40:43], 0 offen offset:2048 sc1
    buffer_load_dwordx2 v[226:227], v38, s[40:43], 0 offen offset:2560 sc1
    buffer_load_dwordx2 v[228:229], v38, s[40:43], 0 offen offset:3072 sc1
    s_waitcnt vmcnt(0)
    v_max3_u32 v32, v200, v202, v204
    v_max3_u32 v32, v32, v206, v208
    v_max3_u32 v32, v32, v210, v212
    v_max3_u32 v32, v32, v214, v216
    v_max3_u32 v32, v32, v218, v220
    v_max3_u32 v32, v32, v222, v224
    v_max3_u32 v32, v32, v226, v228
    v_cmp_eq_u32 vcc, -1, v32
    s_cmp_eq_u64 vcc, 0
    s_cbranch_scc1 L_gr_ok
    s_sleep 1
    s_sub_u32 s65, s65, 1
    s_cbranch_scc0 L_gr
L_gr_ok:
    s_cmp_lg_u32 s56, 0
    s_cbranch_scc1 L_f4s_ok
    v_and_b32 v232, v232, v233
L_pad_Q_56:
    s_cbranch_execz L_ret_Q
    v_and_b32 v234, v234, v235
    v_and_b32 v232, v232, v234
    s_nop 0
    v_readfirstlane_b32 s61, v232
    s_and_b32 s61, s61, 0x40404040
    s_cmp_eq_u32 s61, 0x40404040
    s_cbranch_scc1 L_f4s_ok
    s_mov_b32 s65, 0x40000
L_f4s:
    s_lshl_b32 s78, s57, 4
    buffer_load_dwordx4 v[232:235], off, s[36:39], s78 sc1
    s_waitcnt vmcnt(0)
    v_and_b32 v232, v232, v233
    v_and_b32 v234, v234, v235
    v_and_b32 v232, v232, v234
    s_nop 0
    v_readfirstlane_b32 s61, v232
    s_and_b32 s61, s61, 0x40404040
    s_cmp_eq_u32 s61, 0x40404040
    s_cbranch_scc1 L_f4s_ok
    s_sleep 1
    s_sub_u32 s65, s65, 1
    s_cbranch_scc0 L_f4s
L_f4s_ok:
    buffer_load_dwordx2 v[38:39], off, s[16:19], s82 offset:0 sc1
    v_fma_f32 v150, v138, v228, v226
    v_fma_f32 v151, v138, v229, v227
    v_fma_f32 v150, -v139, v229, v150
    v_fma_f32 v151, v139, v228, v151
    v_fma_f32 v148, v138, v150, v224
    v_fma_f32 v149, v138, v151, v225
    v_fma_f32 v148, -v139, v151, v148
    v_fma_f32 v149, v139, v150, v149
    v_fma_f32 v150, v138, v148, v222
    v_fma_f32 v151, v138, v149, v223
    v_fma_f32 v150, -v139, v149, v150
    v_fma_f32 v151, v139, v148, v151
    v_fma_f32 v148, v138, v150, v220
    v_fma_f32 v149, v138, v151, v221
    v_fma_f32 v148, -v139, v151, v148
    v_fma_f32 v149, v139, v150, v149
    s_nop 0
L_pad_Q_57:
    s_cbranch_execz L_ret_Q
    v_fma_f32 v150, v138, v148, v218
    v_fma_f32 v151, v138, v149, v219
    v_fma_f32 v150, -v139, v149, v150
    v_fma_f32 v151, v139, v148, v151
    v_fma_f32 v148, v138, v150, v216
    v_fma_f32 v149, v138, v151, v217
    v_fma_f32 v148, -v139, v151, v148
    v_fma_f32 v149, v139, v150, v149
    v_fma_f32 v150, v138, v148, v214
    v_fma_f32 v151, v138, v149, v215
    v_fma_f32 v150, -v139, v149, v150
    v_fma_f32 v151, v139, v148, v151
    v_fma_f32 v148, v138, v150, v212
    v_fma_f32 v149, v138, v151, v213
    v_fma_f32 v148, -v139, v151, v148
    v_fma_f32 v149, v139, v150, v149
    v_fma_f32 v150, v138, v148, v210
    v_fma_f32 v151, v138, v149, v211
    v_fma_f32 v150, -v139, v149, v150
    v_fma_f32 v151, v139, v148, v151
    v_fma_f32 v148, v138, v150, v208
    v_fma_f32 v149, v138, v151, v209
    v_fma_f32 v148, -v139, v151, v148
    v_fma_f32 v149, v139, v150, v149
    v_fma_f32 v150, v138, v148, v206
    v_fma_f32 v151, v138, v149, v207
    v_fma_f32 v150, -v139, v149, v150
    v_fma_f32 v151, v139, v148, v151
    v_fma_f32 v148, v138, v150, v204
    v_fma_f32 v149, v138, v151, v205
    v_fma_f32 v148, -v139, v151, v148
    s_nop 0
L_pad_Q_58:
    s_cbranch_execz L_ret_Q
    v_fma_f32 v149, v139, v150, v149
    v_fma_f32 v150, v138, v148, v202
    v_fma_f32 v151, v138, v149, v203
    v_fma_f32 v150, -v139, v149, v150
    v_fma_f32 v151, v139, v148, v151
    v_fma_f32 v148, v138, v150, v200
    v_fma_f32 v149, v138, v151, v201
    v_fma_f32 v148, -v139, v151, v148
    v_fma_f32 v149, v139, v150, v149
    v_fma_f32 v152, v140, v148, v176
    v_fma_f32 v153, v140, v149, v177
    v_fma_f32 v152, -v141, v149, v152
    v_fma_f32 v153, v141, v148, v153
    v_fma_f32 v154, v142, v148, v178
    v_fma_f32 v155, v142, v149, v179
    v_fma_f32 v154, -v143, v149, v154
    v_fma_f32 v155, v143, v148, v155
    s_nop 1
    v_permlane32_swap_b32 v152, v154
    v_permlane32_swap_b32 v153, v155
    s_nop 1
    v_mul_f32 v144, -v133, v153
    v_mul_f32 v153, -v132, v153
    v_fma_f32 v153, -v133, v152, v153
    v_fma_f32 v152, v132, v152, v144
    v_mul_f32 v145, -v135, v155
    v_mul_f32 v155, -v134, v155
    v_fma_f32 v155, -v135, v154, v155
    v_fma_f32 v154, v134, v154, v145
    v_fma_f32 v64, v128, v152, v64
    v_fma_f32 v80, v128, v153, v80
    v_fma_f32 v64, v129, v153, v64
    v_fma_f32 v80, -v129, v152, v80
    s_nop 0
L_pad_Q_59:
    s_cbranch_execz L_ret_Q
    v_fma_f32 v96, v130, v154, v96
    v_fma_f32 v112, v130, v155, v112
    v_fma_f32 v96, v131, v155, v96
    v_fma_f32 v112, -v131, v154, v112
    v_fma_f32 v65, v128, v64, v65
    v_fma_f32 v81, v128, v80, v81
    v_fma_f32 v65, v129, v80, v65
    v_fma_f32 v81, -v129, v64, v81
    v_fma_f32 v97, v130, v96, v97
    v_fma_f32 v113, v130, v112, v113
    v_fma_f32 v97, v131, v112, v97
    v_fma_f32 v113, -v131, v96, v113
    v_fma_f32 v66, v128, v65, v66
    v_fma_f32 v82, v128, v81, v82
    v_fma_f32 v66, v129, v81, v66
    v_fma_f32 v82, -v129, v65, v82
    v_fma_f32 v98, v130, v97, v98
    v_fma_f32 v114, v130, v113, v114
    v_fma_f32 v98, v131, v113, v98
    v_fma_f32 v114, -v131, v97, v114
    v_fma_f32 v67, v128, v66, v67
    v_fma_f32 v83, v128, v82, v83
    v_fma_f32 v67, v129, v82, v67
    v_fma_f32 v83, -v129, v66, v83
    v_fma_f32 v99, v130, v98, v99
    v_fma_f32 v115, v130, v114, v115
    v_fma_f32 v99, v131, v114, v99
    v_fma_f32 v115, -v131, v98, v115
    v_fma_f32 v68, v128, v67, v68
    v_fma_f32 v84, v128, v83, v84
    v_fma_f32 v68, v129, v83, v68
    s_nop 0
L_pad_Q_60:
    s_cbranch_execz L_ret_Q
    v_fma_f32 v84, -v129, v67, v84
    v_fma_f32 v100, v130, v99, v100
    v_fma_f32 v116, v130, v115, v116
    v_fma_f32 v100, v131, v115, v100
    v_fma_f32 v116, -v131, v99, v116
    v_fma_f32 v69, v128, v68, v69
    v_fma_f32 v85, v128, v84, v85
    v_fma_f32 v69, v129, v84, v69
    v_fma_f32 v85, -v129, v68, v85
    v_fma_f32 v101, v130, v100, v101
    v_fma_f32 v117, v130, v116, v117
    v_fma_f32 v101, v131, v116, v101
    v_fma_f32 v117, -v131, v100, v117
    v_fma_f32 v70, v128, v69, v70
    v_fma_f32 v86, v128, v85, v86
    v_fma_f32 v70, v129, v85, v70
    v_fma_f32 v86, -v129, v69, v86
    v_fma_f32 v102, v130, v101, v102
    v_fma_f32 v118, v130, v117, v118
    v_fma_f32 v102, v131, v117, v102
    v_fma_f32 v118, -v131, v101, v118
    v_fma_f32 v71, v128, v70, v71
    v_fma_f32 v87, v128, v86, v87
    v_fma_f32 v71, v129, v86, v71
    v_fma_f32 v87, -v129, v70, v87
    v_fma_f32 v103, v130, v102, v103
    v_fma_f32 v119, v130, v118, v119
    v_fma_f32 v103, v131, v118, v103
    v_fma_f32 v119, -v131, v102, v119
    v_fma_f32 v72, v128, v71, v72
    v_fma_f32 v88, v128, v87, v88
    s_nop 0
L_pad_Q_61:
    s_cbranch_execz L_ret_Q
    v_fma_f32 v72, v129, v87, v72
    v_fma_f32 v88, -v129, v71, v88
    v_fma_f32 v104, v130, v103, v104
    v_fma_f32 v120, v130, v119, v120
    v_fma_f32 v104, v131, v119, v104
    v_fma_f32 v120, -v131, v103, v120
    v_fma_f32 v73, v128, v72, v73
    v_fma_f32 v89, v128, v88, v89
    v_fma_f32 v73, v129, v88, v73
    v_fma_f32 v89, -v129, v72, v89
    v_fma_f32 v105, v130, v104, v105
    v_fma_f32 v121, v130, v120, v121
    v_fma_f32 v105, v131, v120, v105
    v_fma_f32 v121, -v131, v104, v121
    v_fma_f32 v74, v128, v73, v74
    v_fma_f32 v90, v128, v89, v90
    v_fma_f32 v74, v129, v89, v74
    v_fma_f32 v90, -v129, v73, v90
    v_fma_f32 v106, v130, v105, v106
    v_fma_f32 v122, v130, v121, v122
    v_fma_f32 v106, v131, v121, v106
    v_fma_f32 v122, -v131, v105, v122
    v_fma_f32 v75, v128, v74, v75
    v_fma_f32 v91, v128, v90, v91
    v_fma_f32 v75, v129, v90, v75
    v_fma_f32 v91, -v129, v74, v91
    v_fma_f32 v107, v130, v106, v107
    v_fma_f32 v123, v130, v122, v123
    v_fma_f32 v107, v131, v122, v107
    v_fma_f32 v123, -v131, v106, v123
    v_fma_f32 v76, v128, v75, v76
    s_nop 0
L_pad_Q_62:
    s_cbranch_execz L_ret_Q
    v_fma_f32 v92, v128, v91, v92
    v_fma_f32 v76, v129, v91, v76
    v_fma_f32 v92, -v129, v75, v92
    v_fma_f32 v108, v130, v107, v108
    v_fma_f32 v124, v130, v123, v124
    v_fma_f32 v108, v131, v123, v108
    v_fma_f32 v124, -v131, v107, v124
    v_fma_f32 v77, v128, v76, v77
    v_fma_f32 v93, v128, v92, v93
    v_fma_f32 v77, v129, v92, v77
    v_fma_f32 v93, -v129, v76, v93
    v_fma_f32 v109, v130, v108, v109
    v_fma_f32 v125, v130, v124, v125
    v_fma_f32 v109, v131, v124, v109
    v_fma_f32 v125, -v131, v108, v125
    v_fma_f32 v78, v128, v77, v78
    v_fma_f32 v94, v128, v93, v94
    v_fma_f32 v78, v129, v93, v78
    v_fma_f32 v94, -v129, v77, v94
    v_fma_f32 v110, v130, v109, v110
    v_fma_f32 v126, v130, v125, v126
    v_fma_f32 v110, v131, v125, v110
    v_fma_f32 v126, -v131, v109, v126
    v_fma_f32 v79, v128, v78, v79
    v_fma_f32 v95, v128, v94, v95
    v_fma_f32 v79, v129, v94, v79
    v_fma_f32 v95, -v129, v78, v95
    v_fma_f32 v111, v130, v110, v111
    v_fma_f32 v127, v130, v126, v127
    v_fma_f32 v111, v131, v126, v111
    v_fma_f32 v127, -v131, v110, v127
    s_nop 0
L_pad_Q_63:
    s_cbranch_execz L_ret_Q
    v_cvt_pk_bf16_f32 v64, v64, v65
    v_cvt_pk_bf16_f32 v65, v66, v67
    v_cvt_pk_bf16_f32 v66, v68, v69
    v_cvt_pk_bf16_f32 v67, v70, v71
    v_cvt_pk_bf16_f32 v68, v72, v73
    v_cvt_pk_bf16_f32 v69, v74, v75
    v_cvt_pk_bf16_f32 v70, v76, v77
    v_cvt_pk_bf16_f32 v71, v78, v79
    ds_write_b128 v36, v[64:67] offset:0
    ds_write_b128 v36, v[68:71] offset:16
    v_cvt_pk_bf16_f32 v80, v80, v81
    v_cvt_pk_bf16_f32 v81, v82, v83
    v_cvt_pk_bf16_f32 v82, v84, v85
    v_cvt_pk_bf16_f32 v83, v86, v87
    v_cvt_pk_bf16_f32 v84, v88, v89
    v_cvt_pk_bf16_f32 v85, v90, v91
    v_cvt_pk_bf16_f32 v86, v92, v93
    v_cvt_pk_bf16_f32 v87, v94, v95
    ds_write_b128 v36, v[80:83] offset:2048
    ds_write_b128 v36, v[84:87] offset:2064
    v_cvt_pk_bf16_f32 v96, v96, v97
    v_cvt_pk_bf16_f32 v97, v98, v99
    v_cvt_pk_bf16_f32 v98, v100, v101
    v_cvt_pk_bf16_f32 v99, v102, v103
    v_cvt_pk_bf16_f32 v100, v104, v105
    v_cvt_pk_bf16_f32 v101, v106, v107
    v_cvt_pk_bf16_f32 v102, v108, v109
    v_cvt_pk_bf16_f32 v103, v110, v111
    ds_write_b128 v8, v[96:99] offset:0
    ds_write_b128 v8, v[100:103] offset:16
    v_cvt_pk_bf16_f32 v112, v112, v113
    s_nop 0
L_pad_H_0:
    s_cbranch_execz L_ret_H
    v_cvt_pk_bf16_f32 v113, v114, v115
    v_cvt_pk_bf16_f32 v114, v116, v117
    v_cvt_pk_bf16_f32 v115, v118, v119
    v_cvt_pk_bf16_f32 v116, v120, v121
    v_cvt_pk_bf16_f32 v117, v122, v123
    v_cvt_pk_bf16_f32 v118, v124, v125
    v_cvt_pk_bf16_f32 v119, v126, v127
    ds_write_b128 v8, v[112:115] offset:2048
    ds_write_b128 v8, v[116:119] offset:2064
    s_waitcnt lgkmcnt(0)
    s_add_u32 s78, s83, 4096
    ds_read_b64_tr_b16 v[160:161], v22 offset:0
    ds_read_b64_tr_b16 v[162:163], v22 offset:256
    ds_read_b64_tr_b16 v[164:165], v22 offset:1024
    ds_read_b64_tr_b16 v[166:167], v22 offset:1280
    ds_read_b64_tr_b16 v[168:169], v22 offset:2048
    ds_read_b64_tr_b16 v[170:171], v22 offset:2304
    ds_read_b64_tr_b16 v[172:173], v22 offset:3072
    ds_read_b64_tr_b16 v[174:175], v22 offset:3328
    ds_read_b64_tr_b16 v[176:177], v23 offset:0
    ds_read_b64_tr_b16 v[178:179], v23 offset:256
    ds_read_b64_tr_b16 v[180:181], v23 offset:1024
    ds_read_b64_tr_b16 v[182:183], v23 offset:1280
    ds_read_b64_tr_b16 v[184:185], v23 offset:2048
    ds_read_b64_tr_b16 v[186:187], v23 offset:2304
    ds_read_b64_tr_b16 v[188:189], v23 offset:3072
    ds_read_b64_tr_b16 v[190:191], v23 offset:3328
    s_waitcnt lgkmcnt(14)
    buffer_store_dwordx4 v[160:163], v2, s[16:19], s83 offen offset:0 sc1
    s_waitcnt lgkmcnt(12)
    buffer_store_dwordx4 v[164:167], v2, s[16:19], s83 offen offset:1024 sc1
    s_waitcnt lgkmcnt(10)
    buffer_store_dwordx4 v[168:171], v2, s[16:19], s78 offen offset:0 sc1
    s_waitcnt lgkmcnt(8)
L_pad_H_1:
    s_cbranch_execz L_ret_H
    buffer_store_dwordx4 v[172:175], v2, s[16:19], s78 offen offset:1024 sc1
    s_waitcnt lgkmcnt(6)
    buffer_store_dwordx4 v[176:179], v2, s[16:19], s83 offen offset:2048 sc1
    s_waitcnt lgkmcnt(4)
    buffer_store_dwordx4 v[180:183], v2, s[16:19], s83 offen offset:3072 sc1
    s_waitcnt lgkmcnt(2)
    buffer_store_dwordx4 v[184:187], v2, s[16:19], s78 offen offset:2048 sc1
    s_waitcnt lgkmcnt(0)
    buffer_store_dwordx4 v[188:191], v2, s[16:19], s78 offen offset:3072 sc1
    s_add_u32 s78, s60, 65536
    v_add_u32 v29, s78, v2
    ds_write_b128 v29, v[160:163] offset:0
    ds_write_b128 v29, v[164:167] offset:1024
    ds_write_b128 v29, v[176:179] offset:2048
    ds_write_b128 v29, v[180:183] offset:3072
    s_add_u32 s78, s60, 81920
    v_add_u32 v29, s78, v2
    ds_write_b128 v29, v[168:171] offset:0
    ds_write_b128 v29, v[172:175] offset:1024
    ds_write_b128 v29, v[184:187] offset:2048
    ds_write_b128 v29, v[188:191] offset:3072
    v_lshrrev_b32 v221, 2, v1
    v_lshlrev_b32 v221, 10, v221
    v_and_b32 v240, 48, v2
    v_add_u32 v221, v221, v240
    s_add_u32 s78, s66, 0
    s_and_b32 s78, s78, 3
    s_lshl_b32 s78, s78, 12
    v_add_u32 v240, s78, v2
    s_add_u32 s78, s66, 1
    s_and_b32 s78, s78, 3
    s_lshl_b32 s78, s78, 12
    v_add_u32 v241, s78, v2
    s_add_u32 s78, s66, 2
    s_and_b32 s78, s78, 3
    s_lshl_b32 s78, s78, 12
    v_add_u32 v242, s78, v2
    s_add_u32 s78, s66, 3
    s_and_b32 s78, s78, 3
    s_lshl_b32 s78, s78, 12
    v_add_u32 v243, s78, v2
    s_cmp_lg_u32 s56, 0
    s_cbranch_scc1 L_e1s_ok
    s_waitcnt vmcnt(8)
    v_min_u32 v38, v38, v39
    s_nop 0
    v_readfirstlane_b32 s61, v38
    s_cmp_ge_u32 s61, 1
L_pad_H_2:
    s_cbranch_execz L_ret_H
    s_cbranch_scc1 L_e1s_ok
    s_mov_b32 s65, 0x40000
L_e1s:
    buffer_load_dwordx2 v[38:39], off, s[16:19], s82 offset:0 sc1
    s_waitcnt vmcnt(0)
    v_min_u32 v38, v38, v39
    s_nop 0
    v_readfirstlane_b32 s61, v38
    s_cmp_ge_u32 s61, 1
    s_cbranch_scc1 L_e1s_ok
    s_sleep 1
    s_sub_u32 s65, s65, 1
    s_cbranch_scc0 L_e1s
L_e1s_ok:
    s_waitcnt lgkmcnt(0)
    s_barrier
    v_add_u32 v244, 65536, v240
    v_add_u32 v245, 65536, v241
    v_add_u32 v246, 65536, v242
    v_add_u32 v247, 65536, v243
    ds_read_b128 v[40:43], v244 offset:0
    ds_read_b128 v[44:47], v245 offset:0
    ds_read_b128 v[48:51], v246 offset:0
    ds_read_b128 v[52:55], v247 offset:0
    s_waitcnt lgkmcnt(2)
    v_mfma_f32_32x32x16_bf16 v[128:143], a[112:115], v[40:43], 0
    ds_read_b128 v[56:59], v244 offset:1024
    s_add_u32 m0, s60, 147456
    s_lshl_b32 s61, s77, 9
    s_xor_b32 s61, s61, s68
    s_add_u32 s61, s61, s69
    buffer_load_dwordx4 v9, s[20:23], s61 offen offset:0 lds
    buffer_load_dwordx2 v[112:113], off, s[16:19], s82 offset:0 sc1
    ds_read_b64_tr_b16 a[32:33], v26 offset:49152
    v_mfma_f32_32x32x16_bf16 v[144:159], a[112:115], v[44:47], 0
    ds_read_b128 v[60:63], v245 offset:1024
    s_add_u32 s61, s61, 7168
    buffer_load_dwordx4 v9, s[20:23], s61 offen offset:1024 lds
    ds_read_b64_tr_b16 a[34:35], v26 offset:50176
    ds_read_b64_tr_b16 a[36:37], v26 offset:51200
    s_waitcnt lgkmcnt(5)
    v_mfma_f32_32x32x16_bf16 v[160:175], a[112:115], v[48:51], 0
L_pad_H_3:
    s_cbranch_execz L_ret_H
    ds_read_b128 v[40:43], v246 offset:1024
    s_add_u32 s61, s61, 7168
    buffer_load_dwordx4 v9, s[20:23], s61 offen offset:2048 lds
    ds_read_b64_tr_b16 a[38:39], v26 offset:52224
    ds_read_b64_tr_b16 a[40:41], v26 offset:57344
    v_mfma_f32_32x32x16_bf16 v[176:191], a[112:115], v[52:55], 0
    ds_read_b128 v[44:47], v247 offset:1024
    s_add_u32 s61, s61, 7168
    buffer_load_dwordx4 v9, s[20:23], s61 offen offset:3072 lds
    ds_read_b64_tr_b16 a[42:43], v26 offset:58368
    ds_read_b64_tr_b16 a[44:45], v26 offset:59392
    s_waitcnt lgkmcnt(8)
    v_mfma_f32_32x32x16_bf16 v[128:143], a[116:119], v[56:59], v[128:143]
    ds_read_b128 v[48:51], v244 offset:2048
    s_add_u32 m0, s60, 0
    s_xor_b32 s61, s74, 0
    s_lshl_b32 s61, s61, 5
    s_add_u32 s61, s61, s71
    buffer_load_dwordx4 v2, s[16:19], s61 offen offset:0 sc1 lds
    ds_read_b64_tr_b16 a[46:47], v26 offset:60416
    v_add_u32 v26, 131072, v24
    ds_read_b64_tr_b16 a[96:97], v26 offset:0
    v_mfma_f32_32x32x16_bf16 v[144:159], a[116:119], v[60:63], v[144:159]
    ds_read_b128 v[52:55], v245 offset:2048
    buffer_load_dwordx4 v2, s[16:19], s61 offen offset:1024 sc1 lds
    ds_read_b64_tr_b16 a[98:99], v26 offset:1024
    ds_read_b64_tr_b16 a[100:101], v26 offset:2048
    s_waitcnt lgkmcnt(8)
    v_mfma_f32_32x32x16_bf16 v[160:175], a[116:119], v[40:43], v[160:175]
    ds_read_b128 v[56:59], v246 offset:2048
    buffer_load_dwordx4 v2, s[16:19], s61 offen offset:2048 sc1 lds
    ds_read_b64_tr_b16 a[102:103], v26 offset:3072
    ds_read_b64_tr_b16 a[104:105], v26 offset:8192
    v_mfma_f32_32x32x16_bf16 v[176:191], a[116:119], v[44:47], v[176:191]
    s_nop 0
L_pad_H_4:
    s_cbranch_execz L_ret_H
    ds_read_b128 v[60:63], v247 offset:2048
    buffer_load_dwordx4 v2, s[16:19], s61 offen offset:3072 sc1 lds
    ds_read_b64_tr_b16 a[106:107], v26 offset:9216
    ds_read_b64_tr_b16 a[108:109], v26 offset:10240
    s_waitcnt lgkmcnt(8)
    v_mfma_f32_32x32x16_bf16 v[128:143], a[120:123], v[48:51], v[128:143]
    ds_read_b128 v[40:43], v244 offset:3072
    s_add_u32 m0, s60, 16384
    s_xor_b32 s61, s74, 512
    s_lshl_b32 s61, s61, 5
    s_add_u32 s61, s61, s71
    buffer_load_dwordx4 v2, s[16:19], s61 offen offset:0 sc1 lds
    ds_read_b64_tr_b16 a[110:111], v26 offset:11264
    v_mfma_f32_32x32x16_bf16 v[144:159], a[120:123], v[52:55], v[144:159]
    ds_read_b128 v[44:47], v245 offset:3072
    buffer_load_dwordx4 v2, s[16:19], s61 offen offset:1024 sc1 lds
    s_waitcnt lgkmcnt(5)
    v_mfma_f32_32x32x16_bf16 v[160:175], a[120:123], v[56:59], v[160:175]
    ds_read_b128 v[48:51], v246 offset:3072
    buffer_load_dwordx4 v2, s[16:19], s61 offen offset:2048 sc1 lds
    v_mfma_f32_32x32x16_bf16 v[176:191], a[120:123], v[60:63], v[176:191]
    ds_read_b128 v[52:55], v247 offset:3072
    buffer_load_dwordx4 v2, s[16:19], s61 offen offset:3072 sc1 lds
    s_waitcnt lgkmcnt(2)
    v_mfma_f32_32x32x16_bf16 v[128:143], a[124:127], v[40:43], v[128:143]
    s_waitcnt vmcnt(13)
    s_barrier
    s_cmp_lg_u32 s56, 0
    s_cbranch_scc1 L_fs6404
    s_xor_b32 s78, s101, 4
    v_mov_b32 v37, 1
    s_mov_b64 exec, 1
    buffer_store_dword v37, off, s[16:19], s78 sc1
    s_mov_b64 exec, -1
L_fs6404:
    ds_read_b128 v[56:59], v244 offset:16384
    v_mfma_f32_32x32x16_bf16 v[144:159], a[124:127], v[44:47], v[144:159]
    ds_read_b128 v[60:63], v245 offset:16384
    s_waitcnt lgkmcnt(2)
    s_nop 0
L_pad_H_5:
    s_cbranch_execz L_ret_H
    v_mfma_f32_32x32x16_bf16 v[160:175], a[124:127], v[48:51], v[160:175]
    ds_read_b128 v[40:43], v246 offset:16384
    v_mfma_f32_32x32x16_bf16 v[176:191], a[124:127], v[52:55], v[176:191]
    ds_read_b128 v[44:47], v247 offset:16384
    s_waitcnt lgkmcnt(2)
    v_mfma_f32_32x32x16_bf16 v[128:143], a[128:131], v[56:59], v[128:143]
    ds_read_b128 v[48:51], v244 offset:17408
    v_mfma_f32_32x32x16_bf16 v[144:159], a[128:131], v[60:63], v[144:159]
    ds_read_b128 v[52:55], v245 offset:17408
    s_waitcnt lgkmcnt(2)
    v_mfma_f32_32x32x16_bf16 v[160:175], a[128:131], v[40:43], v[160:175]
    ds_read_b128 v[56:59], v246 offset:17408
    v_mfma_f32_32x32x16_bf16 v[176:191], a[128:131], v[44:47], v[176:191]
    ds_read_b128 v[60:63], v247 offset:17408
    s_waitcnt lgkmcnt(2)
    v_mfma_f32_32x32x16_bf16 v[128:143], a[132:135], v[48:51], v[128:143]
    ds_read_b128 v[40:43], v244 offset:18432
    v_mfma_f32_32x32x16_bf16 v[144:159], a[132:135], v[52:55], v[144:159]
    ds_read_b128 v[44:47], v245 offset:18432
    s_waitcnt lgkmcnt(2)
    v_mfma_f32_32x32x16_bf16 v[160:175], a[132:135], v[56:59], v[160:175]
    ds_read_b128 v[48:51], v246 offset:18432
    v_mfma_f32_32x32x16_bf16 v[176:191], a[132:135], v[60:63], v[176:191]
    ds_read_b128 v[52:55], v247 offset:18432
    s_waitcnt lgkmcnt(2)
    v_mfma_f32_32x32x16_bf16 v[128:143], a[136:139], v[40:43], v[128:143]
    ds_read_b128 v[56:59], v244 offset:19456
    v_mfma_f32_32x32x16_bf16 v[144:159], a[136:139], v[44:47], v[144:159]
    ds_read_b128 v[60:63], v245 offset:19456
    s_waitcnt lgkmcnt(2)
    v_mfma_f32_32x32x16_bf16 v[160:175], a[136:139], v[48:51], v[160:175]
    ds_read_b128 v[40:43], v246 offset:19456
    v_mfma_f32_32x32x16_bf16 v[176:191], a[136:139], v[52:55], v[176:191]
    ds_read_b128 v[44:47], v247 offset:19456
    s_waitcnt lgkmcnt(2)
L_pad_H_6:
    s_cbranch_execz L_ret_H
    v_mfma_f32_32x32x16_bf16 v[128:143], a[140:143], v[56:59], v[128:143]
    s_cmp_lg_u32 s56, 0
    s_cbranch_scc1 L_gts0_ok
    s_waitcnt vmcnt(11)
    v_min_u32 v112, v112, v113
    s_nop 0
    v_readfirstlane_b32 s61, v112
    s_cmp_ge_u32 s61, 2
    s_cbranch_scc1 L_gts0_ok
    s_mov_b32 s65, 0x40000
L_gts0:
    buffer_load_dwordx2 v[112:113], off, s[16:19], s82 offset:0 sc1
    s_waitcnt vmcnt(0)
    v_min_u32 v112, v112, v113
    s_nop 0
    v_readfirstlane_b32 s61, v112
    s_cmp_ge_u32 s61, 2
    s_cbranch_scc1 L_gts0_ok
    s_sleep 1
    s_sub_u32 s65, s65, 1
    s_cbranch_scc0 L_gts0
L_gts0_ok:
    s_waitcnt vmcnt(4)
    s_barrier
    ds_read_b128 v[48:51], v240 offset:0
    ds_read_b64_tr_b16 a[48:49], v26 offset:16384
    ds_read_b64_tr_b16 a[50:51], v26 offset:17408
    ds_read_b64_tr_b16 a[52:53], v26 offset:18432
    ds_read_b64_tr_b16 a[54:55], v26 offset:19456
    v_mfma_f32_32x32x16_bf16 v[144:159], a[140:143], v[60:63], v[144:159]
    ds_read_b128 v[52:55], v241 offset:0
    s_add_u32 m0, s60, 98304
    s_xor_b32 s61, s75, 0
    s_lshl_b32 s61, s61, 5
    s_add_u32 s61, s61, s71
    buffer_load_dwordx4 v2, s[16:19], s61 offen offset:0 sc1 lds
    ds_read_b64_tr_b16 a[56:57], v26 offset:24576
    ds_read_b64_tr_b16 a[58:59], v26 offset:25600
    s_waitcnt lgkmcnt(8)
    v_mfma_f32_32x32x16_bf16 v[160:175], a[140:143], v[40:43], v[160:175]
    ds_read_b128 v[56:59], v242 offset:0
    ds_read_b64_tr_b16 a[60:61], v26 offset:26624
    ds_read_b64_tr_b16 a[62:63], v26 offset:27648
    v_mfma_f32_32x32x16_bf16 v[176:191], a[140:143], v[44:47], v[176:191]
    ds_read_b128 v[60:63], v243 offset:0
L_pad_H_7:
    s_cbranch_execz L_ret_H
    buffer_load_dwordx4 v2, s[16:19], s61 offen offset:1024 sc1 lds
    s_waitcnt lgkmcnt(6)
    v_mfma_f32_32x32x16_bf16 v[128:143], a[0:3], v[48:51], v[128:143]
    ds_read_b128 v[40:43], v240 offset:1024
    v_mfma_f32_32x32x16_bf16 v[144:159], a[0:3], v[52:55], v[144:159]
    ds_read_b128 v[44:47], v241 offset:1024
    buffer_load_dwordx4 v2, s[16:19], s61 offen offset:2048 sc1 lds
    s_waitcnt lgkmcnt(2)
    v_mfma_f32_32x32x16_bf16 v[160:175], a[0:3], v[56:59], v[160:175]
    ds_read_b128 v[48:51], v242 offset:1024
    v_mfma_f32_32x32x16_bf16 v[176:191], a[0:3], v[60:63], v[176:191]
    ds_read_b128 v[52:55], v243 offset:1024
    buffer_load_dwordx4 v2, s[16:19], s61 offen offset:3072 sc1 lds
    s_waitcnt lgkmcnt(2)
    v_mfma_f32_32x32x16_bf16 v[128:143], a[4:7], v[40:43], v[128:143]
    ds_read_b128 v[56:59], v240 offset:2048
    v_mfma_f32_32x32x16_bf16 v[144:159], a[4:7], v[44:47], v[144:159]
    ds_read_b128 v[60:63], v241 offset:2048
    s_add_u32 m0, s60, 32768
    s_xor_b32 s61, s75, 512
    s_lshl_b32 s61, s61, 5
    s_add_u32 s61, s61, s71
    buffer_load_dwordx4 v2, s[16:19], s61 offen offset:0 sc1 lds
    s_waitcnt lgkmcnt(2)
    v_mfma_f32_32x32x16_bf16 v[160:175], a[4:7], v[48:51], v[160:175]
    ds_read_b128 v[40:43], v242 offset:2048
    v_mfma_f32_32x32x16_bf16 v[176:191], a[4:7], v[52:55], v[176:191]
    ds_read_b128 v[44:47], v243 offset:2048
    buffer_load_dwordx4 v2, s[16:19], s61 offen offset:1024 sc1 lds
    s_waitcnt lgkmcnt(2)
    v_mfma_f32_32x32x16_bf16 v[128:143], a[8:11], v[56:59], v[128:143]
    ds_read_b128 v[48:51], v240 offset:3072
    buffer_load_dword v114, off, s[16:19], s101 sc1
    v_mfma_f32_32x32x16_bf16 v[144:159], a[8:11], v[60:63], v[144:159]
    ds_read_b128 v[52:55], v241 offset:3072
L_pad_H_8:
    s_cbranch_execz L_ret_H
    buffer_load_dwordx4 v2, s[16:19], s61 offen offset:2048 sc1 lds
    s_waitcnt lgkmcnt(2)
    v_mfma_f32_32x32x16_bf16 v[160:175], a[8:11], v[40:43], v[160:175]
    ds_read_b128 v[56:59], v242 offset:3072
    buffer_load_dwordx4 v2, s[16:19], s61 offen offset:3072 sc1 lds
    v_mfma_f32_32x32x16_bf16 v[176:191], a[8:11], v[44:47], v[176:191]
    ds_read_b128 v[60:63], v243 offset:3072
    s_waitcnt lgkmcnt(2)
    v_mfma_f32_32x32x16_bf16 v[128:143], a[12:15], v[48:51], v[128:143]
    s_waitcnt vmcnt(9)
    s_barrier
    ds_read_b128 v[40:43], v241 offset:16384
    v_mfma_f32_32x32x16_bf16 v[144:159], a[12:15], v[52:55], v[144:159]
    ds_read_b128 v[44:47], v242 offset:16384
    s_add_u32 m0, s60, 49152
    s_lshl2_add_u32 s61, s57, s66
    s_lshl_b32 s61, s61, 9
    s_lshl2_add_u32 s79, s67, s56
    s_add_u32 s61, s61, s79
    s_lshl_b32 s61, s61, 6
    buffer_load_dwordx4 v221, s[8:11], s61 offen offset:0 lds
    s_waitcnt lgkmcnt(2)
    v_mfma_f32_32x32x16_bf16 v[160:175], a[12:15], v[56:59], v[160:175]
    ds_read_b128 v[48:51], v243 offset:16384
    v_mfma_f32_32x32x16_bf16 v[176:191], a[12:15], v[60:63], v[176:191]
    ds_read_b128 v[52:55], v241 offset:17408
    s_add_u32 s61, s61, 15360
    buffer_load_dwordx4 v221, s[8:11], s61 offen offset:1024 lds
    s_waitcnt lgkmcnt(2)
    v_mfma_f32_32x32x16_bf16 v[144:159], a[64:67], v[40:43], v[144:159]
    ds_read_b128 v[56:59], v242 offset:17408
    v_mfma_f32_32x32x16_bf16 v[160:175], a[64:67], v[44:47], v[160:175]
    ds_read_b128 v[60:63], v243 offset:17408
    s_waitcnt lgkmcnt(2)
    v_mfma_f32_32x32x16_bf16 v[176:191], a[64:67], v[48:51], v[176:191]
    ds_read_b128 v[40:43], v241 offset:18432
    v_and_b32 v218, 31, v1
    s_lshl2_add_u32 s78, s57, s66
    s_nop 0
L_pad_H_9:
    s_cbranch_execz L_ret_H
    v_lshl_add_u32 v218, s78, 5, v218
    v_lshlrev_b32 v216, 3, v218
    s_lshl_b32 s78, s66, 14
    s_add_u32 s78, s78, 11534336
    buffer_load_dwordx2 v[216:217], v216, s[16:19], s78 offen sc1
    v_and_b32 v219, 15, v1
    s_lshl2_add_u32 s78, s67, s56
    s_lshl_b32 s78, s78, 6
    v_lshl_add_u32 v219, v219, 2, s78
    global_load_dword v200, v219, s[48:49]
    global_load_dword v208, v219, s[46:47]
    v_mfma_f32_32x32x16_bf16 v[144:159], a[68:71], v[52:55], v[144:159]
    ds_read_b128 v[44:47], v242 offset:18432
    s_waitcnt lgkmcnt(2)
    v_mfma_f32_32x32x16_bf16 v[160:175], a[68:71], v[56:59], v[160:175]
    ds_read_b128 v[48:51], v243 offset:18432
    v_mfma_f32_32x32x16_bf16 v[176:191], a[68:71], v[60:63], v[176:191]
    ds_read_b128 v[52:55], v241 offset:19456
    s_waitcnt lgkmcnt(2)
    v_mfma_f32_32x32x16_bf16 v[144:159], a[72:75], v[40:43], v[144:159]
    ds_read_b128 v[56:59], v242 offset:19456
    v_mfma_f32_32x32x16_bf16 v[160:175], a[72:75], v[44:47], v[160:175]
    ds_read_b128 v[60:63], v243 offset:19456
    s_waitcnt lgkmcnt(2)
    v_mfma_f32_32x32x16_bf16 v[176:191], a[72:75], v[48:51], v[176:191]
    s_cmp_lg_u32 s56, 0
    s_cbranch_scc1 L_gts1_ok
    s_waitcnt vmcnt(7)
    v_readfirstlane_b32 s61, v114
    s_cmp_ge_u32 s61, 1
    s_cbranch_scc1 L_gts1_ok
    s_mov_b32 s65, 0x40000
L_gts1:
    buffer_load_dword v114, off, s[16:19], s101 sc1
    s_waitcnt vmcnt(0)
    v_readfirstlane_b32 s61, v114
    s_cmp_ge_u32 s61, 1
    s_cbranch_scc1 L_gts1_ok
    s_sleep 1
    s_sub_u32 s65, s65, 1
    s_cbranch_scc0 L_gts1
L_gts1_ok:
    s_waitcnt vmcnt(10)
    s_barrier
    ds_read_b128 v[40:43], v245 offset:32768
L_pad_H_10:
    s_cbranch_execz L_ret_H
    s_add_u32 m0, s60, 114688
    s_xor_b32 s61, s83, 8192
    buffer_load_dwordx4 v2, s[16:19], s61 offen offset:0 sc1 lds
    v_mfma_f32_32x32x16_bf16 v[144:159], a[76:79], v[52:55], v[144:159]
    ds_read_b128 v[44:47], v246 offset:32768
    buffer_load_dwordx4 v2, s[16:19], s61 offen offset:1024 sc1 lds
    s_waitcnt lgkmcnt(2)
    v_mfma_f32_32x32x16_bf16 v[160:175], a[76:79], v[56:59], v[160:175]
    ds_read_b128 v[48:51], v247 offset:32768
    buffer_load_dwordx4 v2, s[16:19], s61 offen offset:2048 sc1 lds
    v_mfma_f32_32x32x16_bf16 v[176:191], a[76:79], v[60:63], v[176:191]
    ds_read_b128 v[52:55], v245 offset:33792
    buffer_load_dwordx4 v2, s[16:19], s61 offen offset:3072 sc1 lds
    s_waitcnt lgkmcnt(2)
    v_mfma_f32_32x32x16_bf16 v[144:159], a[16:19], v[40:43], v[144:159]
    ds_read_b128 v[56:59], v246 offset:33792
    v_mfma_f32_32x32x16_bf16 v[160:175], a[16:19], v[44:47], v[160:175]
    ds_read_b128 v[60:63], v247 offset:33792
    s_add_u32 m0, s60, 131072
    s_xor_b32 s61, s83, 12288
    buffer_load_dwordx4 v2, s[16:19], s61 offen offset:0 sc1 lds
    s_waitcnt lgkmcnt(2)
    v_mfma_f32_32x32x16_bf16 v[176:191], a[16:19], v[48:51], v[176:191]
    ds_read_b128 v[40:43], v245 offset:34816
    v_mfma_f32_32x32x16_bf16 v[144:159], a[20:23], v[52:55], v[144:159]
    ds_read_b128 v[44:47], v246 offset:34816
    buffer_load_dwordx4 v2, s[16:19], s61 offen offset:1024 sc1 lds
    s_waitcnt lgkmcnt(2)
    v_mfma_f32_32x32x16_bf16 v[160:175], a[20:23], v[56:59], v[160:175]
    ds_read_b128 v[48:51], v247 offset:34816
    v_mfma_f32_32x32x16_bf16 v[176:191], a[20:23], v[60:63], v[176:191]
    ds_read_b128 v[52:55], v245 offset:35840
    buffer_load_dwordx4 v2, s[16:19], s61 offen offset:2048 sc1 lds
    s_waitcnt lgkmcnt(2)
L_pad_H_11:
    s_cbranch_execz L_ret_H
    v_mfma_f32_32x32x16_bf16 v[144:159], a[24:27], v[40:43], v[144:159]
    ds_read_b128 v[56:59], v246 offset:35840
    v_mfma_f32_32x32x16_bf16 v[160:175], a[24:27], v[44:47], v[160:175]
    ds_read_b128 v[60:63], v247 offset:35840
    buffer_load_dwordx4 v2, s[16:19], s61 offen offset:3072 sc1 lds
    s_waitcnt lgkmcnt(2)
    v_mfma_f32_32x32x16_bf16 v[176:191], a[24:27], v[48:51], v[176:191]
    s_waitcnt vmcnt(13)
    s_barrier
    ds_read_b128 v[40:43], v241 offset:32768
    v_mfma_f32_32x32x16_bf16 v[144:159], a[28:31], v[52:55], v[144:159]
    ds_read_b128 v[44:47], v242 offset:32768
    s_waitcnt lgkmcnt(2)
    v_mfma_f32_32x32x16_bf16 v[160:175], a[28:31], v[56:59], v[160:175]
    ds_read_b128 v[48:51], v243 offset:32768
    v_mfma_f32_32x32x16_bf16 v[176:191], a[28:31], v[60:63], v[176:191]
    ds_read_b128 v[52:55], v241 offset:33792
    s_waitcnt lgkmcnt(2)
    v_mfma_f32_32x32x16_bf16 v[144:159], a[80:83], v[40:43], v[144:159]
    ds_read_b128 v[56:59], v242 offset:33792
    v_mfma_f32_32x32x16_bf16 v[160:175], a[80:83], v[44:47], v[160:175]
    ds_read_b128 v[60:63], v243 offset:33792
    s_waitcnt lgkmcnt(2)
    v_mfma_f32_32x32x16_bf16 v[176:191], a[80:83], v[48:51], v[176:191]
    ds_read_b128 v[40:43], v241 offset:34816
    v_mfma_f32_32x32x16_bf16 v[144:159], a[84:87], v[52:55], v[144:159]
    ds_read_b128 v[44:47], v242 offset:34816
    s_waitcnt lgkmcnt(2)
    v_mfma_f32_32x32x16_bf16 v[160:175], a[84:87], v[56:59], v[160:175]
    ds_read_b128 v[48:51], v243 offset:34816
    v_mfma_f32_32x32x16_bf16 v[176:191], a[84:87], v[60:63], v[176:191]
    ds_read_b128 v[52:55], v241 offset:35840
    s_waitcnt lgkmcnt(2)
    v_mfma_f32_32x32x16_bf16 v[144:159], a[88:91], v[40:43], v[144:159]
    ds_read_b128 v[56:59], v242 offset:35840
    s_nop 0
L_pad_H_12:
    s_cbranch_execz L_ret_H
    v_mfma_f32_32x32x16_bf16 v[160:175], a[88:91], v[44:47], v[160:175]
    ds_read_b128 v[60:63], v243 offset:35840
    s_waitcnt lgkmcnt(2)
    v_mfma_f32_32x32x16_bf16 v[176:191], a[88:91], v[48:51], v[176:191]
    s_waitcnt vmcnt(4)
    s_barrier
    ds_read_b128 v[40:43], v245 offset:49152
    buffer_load_dwordx2 v[116:117], off, s[16:19], s82 offset:0 sc1
    v_mfma_f32_32x32x16_bf16 v[144:159], a[92:95], v[52:55], v[144:159]
    ds_read_b128 v[44:47], v246 offset:49152
    s_waitcnt lgkmcnt(2)
    v_mfma_f32_32x32x16_bf16 v[160:175], a[92:95], v[56:59], v[160:175]
    ds_read_b128 v[48:51], v247 offset:49152
    v_mfma_f32_32x32x16_bf16 v[176:191], a[92:95], v[60:63], v[176:191]
    ds_read_b128 v[52:55], v245 offset:50176
    s_waitcnt lgkmcnt(2)
    v_mfma_f32_32x32x16_bf16 v[144:159], a[144:147], v[40:43], v[144:159]
    ds_read_b128 v[56:59], v246 offset:50176
    v_mfma_f32_32x32x16_bf16 v[160:175], a[144:147], v[44:47], v[160:175]
    ds_read_b128 v[60:63], v247 offset:50176
    s_waitcnt lgkmcnt(2)
    v_mfma_f32_32x32x16_bf16 v[176:191], a[144:147], v[48:51], v[176:191]
    ds_read_b128 v[40:43], v245 offset:51200
    v_mfma_f32_32x32x16_bf16 v[144:159], a[148:151], v[52:55], v[144:159]
    ds_read_b128 v[44:47], v246 offset:51200
    s_waitcnt lgkmcnt(2)
    v_mfma_f32_32x32x16_bf16 v[160:175], a[148:151], v[56:59], v[160:175]
    ds_read_b128 v[48:51], v247 offset:51200
    v_mfma_f32_32x32x16_bf16 v[176:191], a[148:151], v[60:63], v[176:191]
    ds_read_b128 v[52:55], v245 offset:52224
    s_waitcnt lgkmcnt(2)
    v_mfma_f32_32x32x16_bf16 v[144:159], a[152:155], v[40:43], v[144:159]
    ds_read_b128 v[56:59], v246 offset:52224
    v_mfma_f32_32x32x16_bf16 v[160:175], a[152:155], v[44:47], v[160:175]
    ds_read_b128 v[60:63], v247 offset:52224
    s_waitcnt lgkmcnt(2)
L_pad_H_13:
    s_cbranch_execz L_ret_H
    v_mfma_f32_32x32x16_bf16 v[176:191], a[152:155], v[48:51], v[176:191]
    s_cmp_lg_u32 s56, 0
    s_cbranch_scc1 L_gts2_ok
    s_waitcnt vmcnt(0)
    v_min_u32 v116, v116, v117
    s_nop 0
    v_readfirstlane_b32 s61, v116
    s_cmp_ge_u32 s61, 3
    s_cbranch_scc1 L_gts2_ok
    s_mov_b32 s65, 0x40000
L_gts2:
    buffer_load_dwordx2 v[116:117], off, s[16:19], s82 offset:0 sc1
    s_waitcnt vmcnt(0)
    v_min_u32 v116, v116, v117
    s_nop 0
    v_readfirstlane_b32 s61, v116
    s_cmp_ge_u32 s61, 3
    s_cbranch_scc1 L_gts2_ok
    s_sleep 1
    s_sub_u32 s65, s65, 1
    s_cbranch_scc0 L_gts2
L_gts2_ok:
    s_waitcnt vmcnt(1)
    s_barrier
    v_add_u32 v244, 131072, v240
    v_add_u32 v245, 131072, v241
    v_add_u32 v246, 131072, v242
    v_add_u32 v247, 131072, v243
    ds_read_b128 v[40:43], v245 offset:0
    v_mfma_f32_32x32x16_bf16 v[144:159], a[156:159], v[52:55], v[144:159]
    ds_read_b128 v[44:47], v246 offset:0
    s_add_u32 m0, s60, 65536
    s_xor_b32 s61, s76, 0
    s_lshl_b32 s61, s61, 5
    s_add_u32 s61, s61, s71
    buffer_load_dwordx4 v2, s[16:19], s61 offen offset:0 sc1 lds
    s_waitcnt lgkmcnt(2)
    v_mfma_f32_32x32x16_bf16 v[160:175], a[156:159], v[56:59], v[160:175]
    ds_read_b128 v[48:51], v247 offset:0
    v_mfma_f32_32x32x16_bf16 v[176:191], a[156:159], v[60:63], v[176:191]
    ds_read_b128 v[52:55], v245 offset:1024
    buffer_load_dwordx4 v2, s[16:19], s61 offen offset:1024 sc1 lds
    s_waitcnt lgkmcnt(2)
    v_mfma_f32_32x32x16_bf16 v[144:159], a[160:163], v[40:43], v[144:159]
    ds_read_b128 v[56:59], v246 offset:1024
    s_nop 0
L_pad_H_14:
    s_cbranch_execz L_ret_H
    v_mfma_f32_32x32x16_bf16 v[160:175], a[160:163], v[44:47], v[160:175]
    ds_read_b128 v[60:63], v247 offset:1024
    buffer_load_dwordx4 v2, s[16:19], s61 offen offset:2048 sc1 lds
    s_waitcnt lgkmcnt(2)
    v_mfma_f32_32x32x16_bf16 v[176:191], a[160:163], v[48:51], v[176:191]
    ds_read_b128 v[40:43], v245 offset:2048
    v_mfma_f32_32x32x16_bf16 v[144:159], a[164:167], v[52:55], v[144:159]
    ds_read_b128 v[44:47], v246 offset:2048
    buffer_load_dwordx4 v2, s[16:19], s61 offen offset:3072 sc1 lds
    s_waitcnt lgkmcnt(2)
    v_mfma_f32_32x32x16_bf16 v[160:175], a[164:167], v[56:59], v[160:175]
    ds_read_b128 v[48:51], v247 offset:2048
    v_mfma_f32_32x32x16_bf16 v[176:191], a[164:167], v[60:63], v[176:191]
    ds_read_b128 v[52:55], v245 offset:3072
    s_add_u32 m0, s60, 147456
    s_xor_b32 s61, s76, 512
    s_lshl_b32 s61, s61, 5
    s_add_u32 s61, s61, s71
    buffer_load_dwordx4 v2, s[16:19], s61 offen offset:0 sc1 lds
    s_waitcnt lgkmcnt(2)
    v_mfma_f32_32x32x16_bf16 v[144:159], a[168:171], v[40:43], v[144:159]
    ds_read_b128 v[56:59], v246 offset:3072
    v_mfma_f32_32x32x16_bf16 v[160:175], a[168:171], v[44:47], v[160:175]
    ds_read_b128 v[60:63], v247 offset:3072
    buffer_load_dwordx4 v2, s[16:19], s61 offen offset:1024 sc1 lds
    s_waitcnt lgkmcnt(2)
    v_mfma_f32_32x32x16_bf16 v[176:191], a[168:171], v[48:51], v[176:191]
    buffer_load_dwordx4 v2, s[16:19], s61 offen offset:2048 sc1 lds
    buffer_load_dwordx4 v2, s[16:19], s61 offen offset:3072 sc1 lds
    s_waitcnt vmcnt(4)
    s_barrier
    v_add_u32 v244, 65536, v240
    v_add_u32 v245, 65536, v241
    v_add_u32 v246, 65536, v242
    v_add_u32 v247, 65536, v243
    s_nop 0
L_pad_H_15:
    s_cbranch_execz L_ret_H
    ds_read_b128 v[40:43], v245 offset:0
    v_mfma_f32_32x32x16_bf16 v[144:159], a[172:175], v[52:55], v[144:159]
    ds_read_b128 v[44:47], v246 offset:0
    s_waitcnt lgkmcnt(2)
    v_mfma_f32_32x32x16_bf16 v[160:175], a[172:175], v[56:59], v[160:175]
    ds_read_b128 v[48:51], v247 offset:0
    v_mfma_f32_32x32x16_bf16 v[176:191], a[172:175], v[60:63], v[176:191]
    ds_read_b128 v[52:55], v245 offset:1024
    s_waitcnt lgkmcnt(2)
    v_mfma_f32_32x32x16_bf16 v[144:159], a[32:35], v[40:43], v[144:159]
    ds_read_b128 v[56:59], v246 offset:1024
    buffer_load_dwordx2 v[118:119], off, s[16:19], s82 offset:0 sc1
    v_mfma_f32_32x32x16_bf16 v[160:175], a[32:35], v[44:47], v[160:175]
    ds_read_b128 v[60:63], v247 offset:1024
    s_waitcnt lgkmcnt(2)
    v_mfma_f32_32x32x16_bf16 v[176:191], a[32:35], v[48:51], v[176:191]
    ds_read_b128 v[40:43], v245 offset:2048
    v_mfma_f32_32x32x16_bf16 v[144:159], a[36:39], v[52:55], v[144:159]
    ds_read_b128 v[44:47], v246 offset:2048
    s_waitcnt lgkmcnt(2)
    v_mfma_f32_32x32x16_bf16 v[160:175], a[36:39], v[56:59], v[160:175]
    ds_read_b128 v[48:51], v247 offset:2048
    v_mfma_f32_32x32x16_bf16 v[176:191], a[36:39], v[60:63], v[176:191]
    ds_read_b128 v[52:55], v245 offset:3072
    s_waitcnt lgkmcnt(2)
    v_mfma_f32_32x32x16_bf16 v[144:159], a[40:43], v[40:43], v[144:159]
    ds_read_b128 v[56:59], v246 offset:3072
    v_mfma_f32_32x32x16_bf16 v[160:175], a[40:43], v[44:47], v[160:175]
    ds_read_b128 v[60:63], v247 offset:3072
    s_waitcnt lgkmcnt(2)
    v_mfma_f32_32x32x16_bf16 v[176:191], a[40:43], v[48:51], v[176:191]
    s_cmp_lg_u32 s56, 0
    s_cbranch_scc1 L_gts3_ok
    s_waitcnt vmcnt(0)
    v_min_u32 v118, v118, v119
    s_nop 0
    v_readfirstlane_b32 s61, v118
    s_cmp_ge_u32 s61, 4
L_pad_H_16:
    s_cbranch_execz L_ret_H
    s_cbranch_scc1 L_gts3_ok
    s_mov_b32 s65, 0x40000
L_gts3:
    buffer_load_dwordx2 v[118:119], off, s[16:19], s82 offset:0 sc1
    s_waitcnt vmcnt(0)
    v_min_u32 v118, v118, v119
    s_nop 0
    v_readfirstlane_b32 s61, v118
    s_cmp_ge_u32 s61, 4
    s_cbranch_scc1 L_gts3_ok
    s_sleep 1
    s_sub_u32 s65, s65, 1
    s_cbranch_scc0 L_gts3
L_gts3_ok:
    s_waitcnt vmcnt(1)
    s_barrier
    v_add_u32 v244, 131072, v240
    v_add_u32 v245, 131072, v241
    v_add_u32 v246, 131072, v242
    v_add_u32 v247, 131072, v243
    ds_read_b128 v[40:43], v245 offset:16384
    v_mfma_f32_32x32x16_bf16 v[144:159], a[44:47], v[52:55], v[144:159]
    ds_read_b128 v[44:47], v246 offset:16384
    s_add_u32 m0, s60, 81920
    s_xor_b32 s61, s77, 0
    s_lshl_b32 s61, s61, 5
    s_add_u32 s61, s61, s71
    buffer_load_dwordx4 v2, s[16:19], s61 offen offset:0 sc1 lds
    s_waitcnt lgkmcnt(2)
    v_mfma_f32_32x32x16_bf16 v[160:175], a[44:47], v[56:59], v[160:175]
    ds_read_b128 v[48:51], v247 offset:16384
    v_mfma_f32_32x32x16_bf16 v[176:191], a[44:47], v[60:63], v[176:191]
    ds_read_b128 v[52:55], v245 offset:17408
    buffer_load_dwordx4 v2, s[16:19], s61 offen offset:1024 sc1 lds
    s_waitcnt lgkmcnt(2)
    v_mfma_f32_32x32x16_bf16 v[144:159], a[96:99], v[40:43], v[144:159]
    ds_read_b128 v[56:59], v246 offset:17408
    s_xor_b32 s78, s101, 4
    s_andn2_b32 s78, s78, 0x300
    v_and_b32 v220, 3, v1
    v_lshlrev_b32 v220, 8, v220
    buffer_load_dword v220, v220, s[16:19], s78 offen sc1
    v_mfma_f32_32x32x16_bf16 v[160:175], a[96:99], v[44:47], v[160:175]
    s_nop 0
L_pad_H_17:
    s_cbranch_execz L_ret_H
    ds_read_b128 v[60:63], v247 offset:17408
    s_add_u32 m0, s60, 0
    s_xor_b32 s61, s77, 64
    s_lshl_b32 s61, s61, 5
    s_add_u32 s61, s61, s71
    buffer_load_dwordx4 v2, s[16:19], s61 offen offset:0 sc1 lds
    s_waitcnt lgkmcnt(2)
    v_mfma_f32_32x32x16_bf16 v[176:191], a[96:99], v[48:51], v[176:191]
    ds_read_b128 v[40:43], v245 offset:18432
    buffer_load_dwordx4 v2, s[16:19], s61 offen offset:1024 sc1 lds
    v_mfma_f32_32x32x16_bf16 v[144:159], a[100:103], v[52:55], v[144:159]
    ds_read_b128 v[44:47], v246 offset:18432
    s_waitcnt lgkmcnt(2)
    v_mfma_f32_32x32x16_bf16 v[160:175], a[100:103], v[56:59], v[160:175]
    ds_read_b128 v[48:51], v247 offset:18432
    v_mfma_f32_32x32x16_bf16 v[176:191], a[100:103], v[60:63], v[176:191]
    ds_read_b128 v[52:55], v245 offset:19456
    s_waitcnt lgkmcnt(2)
    v_mfma_f32_32x32x16_bf16 v[144:159], a[104:107], v[40:43], v[144:159]
    ds_read_b128 v[56:59], v246 offset:19456
    v_mfma_f32_32x32x16_bf16 v[160:175], a[104:107], v[44:47], v[160:175]
    ds_read_b128 v[60:63], v247 offset:19456
    s_waitcnt lgkmcnt(2)
    v_mfma_f32_32x32x16_bf16 v[176:191], a[104:107], v[48:51], v[176:191]
    s_waitcnt vmcnt(3)
    s_barrier
    v_add_u32 v244, 65536, v240
    v_add_u32 v245, 65536, v241
    v_add_u32 v246, 65536, v242
    v_add_u32 v247, 65536, v243
    ds_read_b128 v[40:43], v245 offset:16384
    v_mfma_f32_32x32x16_bf16 v[144:159], a[108:111], v[52:55], v[144:159]
    ds_read_b128 v[44:47], v246 offset:16384
    s_waitcnt lgkmcnt(2)
    v_mfma_f32_32x32x16_bf16 v[160:175], a[108:111], v[56:59], v[160:175]
    ds_read_b128 v[48:51], v247 offset:16384
    v_mfma_f32_32x32x16_bf16 v[176:191], a[108:111], v[60:63], v[176:191]
L_pad_H_18:
    s_cbranch_execz L_ret_H
    ds_read_b128 v[52:55], v245 offset:17408
    s_waitcnt lgkmcnt(2)
    v_mfma_f32_32x32x16_bf16 v[144:159], a[48:51], v[40:43], v[144:159]
    ds_read_b128 v[56:59], v246 offset:17408
    v_mfma_f32_32x32x16_bf16 v[160:175], a[48:51], v[44:47], v[160:175]
    ds_read_b128 v[60:63], v247 offset:17408
    s_waitcnt lgkmcnt(2)
    v_mfma_f32_32x32x16_bf16 v[176:191], a[48:51], v[48:51], v[176:191]
    s_waitcnt vmcnt(0)
    s_barrier
    ds_read_b128 v[40:43], v241 offset:0
    v_mfma_f32_32x32x16_bf16 v[144:159], a[52:55], v[52:55], v[144:159]
    ds_read_b128 v[44:47], v242 offset:0
    s_waitcnt lgkmcnt(2)
    v_mfma_f32_32x32x16_bf16 v[160:175], a[52:55], v[56:59], v[160:175]
    ds_read_b128 v[48:51], v243 offset:0
    v_mfma_f32_32x32x16_bf16 v[176:191], a[52:55], v[60:63], v[176:191]
    ds_read_b128 v[52:55], v241 offset:1024
    s_waitcnt lgkmcnt(2)
    v_mfma_f32_32x32x16_bf16 v[144:159], a[56:59], v[40:43], v[144:159]
    ds_read_b128 v[56:59], v242 offset:1024
    v_mfma_f32_32x32x16_bf16 v[160:175], a[56:59], v[44:47], v[160:175]
    ds_read_b128 v[60:63], v243 offset:1024
    s_waitcnt lgkmcnt(2)
    v_mfma_f32_32x32x16_bf16 v[176:191], a[56:59], v[48:51], v[176:191]
    v_mfma_f32_32x32x16_bf16 v[144:159], a[60:63], v[52:55], v[144:159]
    s_waitcnt lgkmcnt(0)
    v_mfma_f32_32x32x16_bf16 v[160:175], a[60:63], v[56:59], v[160:175]
    v_mfma_f32_32x32x16_bf16 v[176:191], a[60:63], v[60:63], v[176:191]
    s_nop 15
    s_add_u32 s78, s66, 1
    s_and_b32 s78, s78, 3
    s_mul_i32 s78, s78, 24576
    s_add_u32 s78, s78, s100
    v_cvt_pk_bf16_f32 v144, v144, v145
    v_cvt_pk_bf16_f32 v145, v146, v147
    v_cvt_pk_bf16_f32 v146, v148, v149
    s_nop 0
L_pad_H_19:
    s_cbranch_execz L_ret_H
    v_cvt_pk_bf16_f32 v147, v150, v151
    v_min_u32 v144, -2, v144
    v_min_u32 v145, -2, v145
    v_min_u32 v146, -2, v146
    v_min_u32 v147, -2, v147
    buffer_store_dwordx4 v[144:147], v2, s[16:19], s78 offen offset:0 sc1
    v_cvt_pk_bf16_f32 v148, v152, v153
    v_cvt_pk_bf16_f32 v149, v154, v155
    v_cvt_pk_bf16_f32 v150, v156, v157
    v_cvt_pk_bf16_f32 v151, v158, v159
    v_min_u32 v148, -2, v148
    v_min_u32 v149, -2, v149
    v_min_u32 v150, -2, v150
    v_min_u32 v151, -2, v151
    buffer_store_dwordx4 v[148:151], v2, s[16:19], s78 offen offset:1024 sc1
    s_add_u32 s78, s66, 2
    s_and_b32 s78, s78, 3
    s_mul_i32 s78, s78, 24576
    s_add_u32 s78, s78, s100
    s_add_u32 s78, s78, 8192
    s_nop 7
    v_cvt_pk_bf16_f32 v160, v160, v161
    v_cvt_pk_bf16_f32 v161, v162, v163
    v_cvt_pk_bf16_f32 v162, v164, v165
    v_cvt_pk_bf16_f32 v163, v166, v167
    v_min_u32 v160, -2, v160
    v_min_u32 v161, -2, v161
    v_min_u32 v162, -2, v162
    v_min_u32 v163, -2, v163
    buffer_store_dwordx4 v[160:163], v2, s[16:19], s78 offen offset:0 sc1
    v_cvt_pk_bf16_f32 v164, v168, v169
    v_cvt_pk_bf16_f32 v165, v170, v171
    v_cvt_pk_bf16_f32 v166, v172, v173
    v_cvt_pk_bf16_f32 v167, v174, v175
    v_min_u32 v164, -2, v164
    v_min_u32 v165, -2, v165
    v_min_u32 v166, -2, v166
    v_min_u32 v167, -2, v167
    buffer_store_dwordx4 v[164:167], v2, s[16:19], s78 offen offset:1024 sc1
    s_add_u32 s78, s66, 3
    s_and_b32 s78, s78, 3
    s_mul_i32 s78, s78, 24576
    s_add_u32 s78, s78, s100
L_pad_H_20:
    s_cbranch_execz L_ret_H
    s_add_u32 s78, s78, 16384
    v_cvt_pk_bf16_f32 v176, v176, v177
    v_cvt_pk_bf16_f32 v177, v178, v179
    v_cvt_pk_bf16_f32 v178, v180, v181
    v_cvt_pk_bf16_f32 v179, v182, v183
    v_min_u32 v176, -2, v176
    v_min_u32 v177, -2, v177
    v_min_u32 v178, -2, v178
    v_min_u32 v179, -2, v179
    buffer_store_dwordx4 v[176:179], v2, s[16:19], s78 offen offset:0 sc1
    v_cvt_pk_bf16_f32 v180, v184, v185
    v_cvt_pk_bf16_f32 v181, v186, v187
    v_cvt_pk_bf16_f32 v182, v188, v189
    v_cvt_pk_bf16_f32 v183, v190, v191
    v_min_u32 v180, -2, v180
    v_min_u32 v181, -2, v181
    v_min_u32 v182, -2, v182
    v_min_u32 v183, -2, v183
    buffer_store_dwordx4 v[180:183], v2, s[16:19], s78 offen offset:1024 sc1
    v_cmp_gt_u32 vcc, 1, v220
    s_cmp_eq_u64 vcc, 0
    s_cbranch_scc1 L_pns_ok
    s_mov_b32 s65, 0x40000
L_pns:
    s_xor_b32 s78, s101, 4
    s_andn2_b32 s78, s78, 0x300
    v_and_b32 v220, 3, v1
    v_lshlrev_b32 v220, 8, v220
    buffer_load_dword v220, v220, s[16:19], s78 offen sc1
    s_waitcnt vmcnt(0)
    v_cmp_gt_u32 vcc, 1, v220
    s_cmp_eq_u64 vcc, 0
    s_cbranch_scc1 L_pns_ok
    s_sleep 2
    s_sub_u32 s65, s65, 1
    s_cbranch_scc0 L_pns
L_pns_ok:
    s_mul_i32 s3, s66, 24576
    s_add_u32 s3, s3, s100
    s_add_u32 s4, s3, 8192
    s_add_u32 s5, s3, 16384
    s_add_u32 s78, s60, 49152
    v_and_b32 v218, 31, v1
    v_lshrrev_b32 v219, 5, v1
    v_lshlrev_b32 v219, 3, v219
    v_and_b32 v96, 15, v1
    s_nop 0
L_pad_H_21:
    s_cbranch_execz L_ret_H
    v_lshl_add_u32 v96, v96, 2, s78
    v_add_u32 v97, s78, v219
    ds_write_b32 v96, v200 offset:2048
    ds_write_b32 v96, v208 offset:2112
    s_waitcnt lgkmcnt(0)
    ds_read_b64 v[200:201], v97 offset:2048
    ds_read_b64 v[202:203], v97 offset:2064
    ds_read_b64 v[204:205], v97 offset:2080
    ds_read_b64 v[206:207], v97 offset:2096
    ds_read_b64 v[208:209], v97 offset:2112
    ds_read_b64 v[210:211], v97 offset:2128
    ds_read_b64 v[212:213], v97 offset:2144
    ds_read_b64 v[214:215], v97 offset:2160
    v_lshl_add_u32 v219, v218, 6, v97
    ds_read_b64 v[192:193], v219 offset:0
    ds_read_b64 v[194:195], v219 offset:16
    ds_read_b64 v[196:197], v219 offset:32
    ds_read_b64 v[198:199], v219 offset:48
    s_lshl2_add_u32 s6, s57, s66
    s_lshl_b32 s6, s6, 9
    s_lshl2_add_u32 s79, s67, s56
    s_add_u32 s6, s6, s79
    s_lshl_b32 s6, s6, 7
    s_waitcnt lgkmcnt(0)
    ds_read_b128 v[40:43], v240 offset:0
    ds_read_b128 v[44:47], v240 offset:1024
    ds_read_b128 v[48:51], v240 offset:16384
    ds_read_b128 v[52:55], v240 offset:17408
    s_waitcnt lgkmcnt(2)
    v_mfma_f32_32x32x16_bf16 v[128:143], a[56:59], v[40:43], v[128:143]
    ds_read_b128 v[56:59], v240 offset:18432
    v_lshlrev_b32 v96, 16, v192
    v_lshlrev_b32 v97, 16, v200
    v_lshlrev_b32 v98, 16, v208
    v_fma_f32 v99, v96, v216, v217
    v_add_f32 v96, v96, v98
    v_mfma_f32_32x32x16_bf16 v[128:143], a[60:63], v[44:47], v[128:143]
    ds_read_b128 v[60:63], v240 offset:19456
L_pad_H_22:
    s_cbranch_execz L_ret_H
    v_cvt_pk_bf16_f32 v99, v99, v99
    v_lshlrev_b32 v99, 16, v99
    v_mul_f32 v99, v99, v97
    v_cvt_pk_bf16_f32 v99, v99, v99
    v_lshlrev_b32 v99, 16, v99
    s_waitcnt lgkmcnt(2)
    v_mfma_f32_32x32x16_bf16 v[128:143], a[64:67], v[48:51], v[128:143]
    ds_read_b128 v[40:43], v240 offset:32768
    v_add_f32 v224, v96, v99
    v_and_b32 v100, 0xffff0000, v192
    v_and_b32 v101, 0xffff0000, v200
    v_and_b32 v102, 0xffff0000, v208
    v_fma_f32 v103, v100, v216, v217
    v_mfma_f32_32x32x16_bf16 v[128:143], a[68:71], v[52:55], v[128:143]
    ds_read_b128 v[44:47], v240 offset:33792
    v_add_f32 v100, v100, v102
    v_cvt_pk_bf16_f32 v103, v103, v103
    v_lshlrev_b32 v103, 16, v103
    v_mul_f32 v103, v103, v101
    v_cvt_pk_bf16_f32 v103, v103, v103
    s_waitcnt lgkmcnt(2)
    v_mfma_f32_32x32x16_bf16 v[128:143], a[72:75], v[56:59], v[128:143]
    ds_read_b128 v[48:51], v240 offset:34816
    v_lshlrev_b32 v103, 16, v103
    v_add_f32 v225, v100, v103
    v_lshlrev_b32 v96, 16, v193
    v_lshlrev_b32 v97, 16, v201
    v_lshlrev_b32 v98, 16, v209
    v_mfma_f32_32x32x16_bf16 v[128:143], a[76:79], v[60:63], v[128:143]
    ds_read_b128 v[52:55], v240 offset:35840
    v_fma_f32 v99, v96, v216, v217
    v_add_f32 v96, v96, v98
    v_cvt_pk_bf16_f32 v99, v99, v99
    v_lshlrev_b32 v99, 16, v99
    v_mul_f32 v99, v99, v97
    s_waitcnt lgkmcnt(2)
    v_mfma_f32_32x32x16_bf16 v[128:143], a[80:83], v[40:43], v[128:143]
    ds_read_b128 v[56:59], v244 offset:0
    v_cvt_pk_bf16_f32 v99, v99, v99
    v_lshlrev_b32 v99, 16, v99
    v_add_f32 v226, v96, v99
    s_nop 0
L_pad_H_23:
    s_cbranch_execz L_ret_H
    v_and_b32 v100, 0xffff0000, v193
    v_and_b32 v101, 0xffff0000, v201
    v_mfma_f32_32x32x16_bf16 v[128:143], a[84:87], v[44:47], v[128:143]
    ds_read_b128 v[60:63], v244 offset:1024
    v_and_b32 v102, 0xffff0000, v209
    v_fma_f32 v103, v100, v216, v217
    v_add_f32 v100, v100, v102
    v_cvt_pk_bf16_f32 v103, v103, v103
    v_lshlrev_b32 v103, 16, v103
    s_waitcnt lgkmcnt(2)
    v_mfma_f32_32x32x16_bf16 v[128:143], a[88:91], v[48:51], v[128:143]
    ds_read_b128 v[40:43], v244 offset:2048
    v_mul_f32 v103, v103, v101
    v_cvt_pk_bf16_f32 v103, v103, v103
    v_lshlrev_b32 v103, 16, v103
    v_add_f32 v227, v100, v103
    v_lshlrev_b32 v96, 16, v194
    v_mfma_f32_32x32x16_bf16 v[128:143], a[92:95], v[52:55], v[128:143]
    ds_read_b128 v[44:47], v244 offset:3072
    v_lshlrev_b32 v97, 16, v202
    v_lshlrev_b32 v98, 16, v210
    v_fma_f32 v99, v96, v216, v217
    v_add_f32 v96, v96, v98
    v_cvt_pk_bf16_f32 v99, v99, v99
    s_waitcnt lgkmcnt(2)
    v_mfma_f32_32x32x16_bf16 v[128:143], a[32:35], v[56:59], v[128:143]
    ds_read_b128 v[48:51], v244 offset:16384
    v_lshlrev_b32 v99, 16, v99
    v_mul_f32 v99, v99, v97
    v_cvt_pk_bf16_f32 v99, v99, v99
    v_lshlrev_b32 v99, 16, v99
    v_add_f32 v228, v96, v99
    v_mfma_f32_32x32x16_bf16 v[128:143], a[36:39], v[60:63], v[128:143]
    ds_read_b128 v[52:55], v244 offset:17408
    v_and_b32 v100, 0xffff0000, v194
    v_and_b32 v101, 0xffff0000, v202
    v_and_b32 v102, 0xffff0000, v210
    v_fma_f32 v103, v100, v216, v217
    v_add_f32 v100, v100, v102
    s_waitcnt lgkmcnt(2)
L_pad_H_24:
    s_cbranch_execz L_ret_H
    v_mfma_f32_32x32x16_bf16 v[128:143], a[40:43], v[40:43], v[128:143]
    ds_read_b128 v[56:59], v244 offset:32768
    v_cvt_pk_bf16_f32 v103, v103, v103
    v_lshlrev_b32 v103, 16, v103
    v_mul_f32 v103, v103, v101
    v_cvt_pk_bf16_f32 v103, v103, v103
    v_lshlrev_b32 v103, 16, v103
    v_mfma_f32_32x32x16_bf16 v[128:143], a[44:47], v[44:47], v[128:143]
    ds_read_b128 v[60:63], v244 offset:33792
    v_add_f32 v229, v100, v103
    v_lshlrev_b32 v96, 16, v195
    v_lshlrev_b32 v97, 16, v203
    v_lshlrev_b32 v98, 16, v211
    v_fma_f32 v99, v96, v216, v217
    s_waitcnt lgkmcnt(2)
    v_mfma_f32_32x32x16_bf16 v[128:143], a[48:51], v[48:51], v[128:143]
    ds_read_b128 v[40:43], v244 offset:34816
    v_add_f32 v96, v96, v98
    v_cvt_pk_bf16_f32 v99, v99, v99
    v_lshlrev_b32 v99, 16, v99
    v_mul_f32 v99, v99, v97
    v_cvt_pk_bf16_f32 v99, v99, v99
    v_mfma_f32_32x32x16_bf16 v[128:143], a[52:55], v[52:55], v[128:143]
    ds_read_b128 v[44:47], v244 offset:35840
    v_lshlrev_b32 v99, 16, v99
    v_add_f32 v230, v96, v99
    v_and_b32 v100, 0xffff0000, v195
    v_and_b32 v101, 0xffff0000, v203
    v_and_b32 v102, 0xffff0000, v211
    s_waitcnt lgkmcnt(2)
    v_mfma_f32_32x32x16_bf16 v[128:143], a[16:19], v[56:59], v[128:143]
    ds_read_b128 v[48:51], v244 offset:49152
    v_fma_f32 v103, v100, v216, v217
    v_add_f32 v100, v100, v102
    v_cvt_pk_bf16_f32 v103, v103, v103
    v_lshlrev_b32 v103, 16, v103
    v_mul_f32 v103, v103, v101
    v_mfma_f32_32x32x16_bf16 v[128:143], a[20:23], v[60:63], v[128:143]
    ds_read_b128 v[52:55], v244 offset:50176
    v_cvt_pk_bf16_f32 v103, v103, v103
L_pad_H_25:
    s_cbranch_execz L_ret_H
    v_lshlrev_b32 v103, 16, v103
    v_add_f32 v231, v100, v103
    buffer_load_dwordx4 v[64:67], v2, s[16:19], s3 offen offset:0 sc1
    buffer_load_dwordx4 v[68:71], v2, s[16:19], s3 offen offset:1024 sc1
    buffer_load_dwordx4 v[72:75], v2, s[16:19], s4 offen offset:0 sc1
    buffer_load_dwordx4 v[76:79], v2, s[16:19], s4 offen offset:1024 sc1
    buffer_load_dwordx4 v[80:83], v2, s[16:19], s5 offen offset:0 sc1
    buffer_load_dwordx4 v[84:87], v2, s[16:19], s5 offen offset:1024 sc1
    v_lshlrev_b32 v96, 16, v196
    s_waitcnt lgkmcnt(2)
    v_mfma_f32_32x32x16_bf16 v[128:143], a[24:27], v[40:43], v[128:143]
    ds_read_b128 v[56:59], v244 offset:51200
    v_lshlrev_b32 v97, 16, v204
    v_lshlrev_b32 v98, 16, v212
    v_fma_f32 v99, v96, v216, v217
    v_add_f32 v96, v96, v98
    v_cvt_pk_bf16_f32 v99, v99, v99
    v_mfma_f32_32x32x16_bf16 v[128:143], a[28:31], v[44:47], v[128:143]
    ds_read_b128 v[60:63], v244 offset:52224
    v_lshlrev_b32 v99, 16, v99
    v_mul_f32 v99, v99, v97
    v_cvt_pk_bf16_f32 v99, v99, v99
    v_lshlrev_b32 v99, 16, v99
    v_add_f32 v232, v96, v99
    s_waitcnt lgkmcnt(2)
    v_mfma_f32_32x32x16_bf16 v[128:143], a[144:147], v[48:51], v[128:143]
    v_add_u32 v244, 131072, v240
    v_add_u32 v245, 131072, v241
    v_add_u32 v246, 131072, v242
    v_add_u32 v247, 131072, v243
    ds_read_b128 v[40:43], v244 offset:0
    v_and_b32 v100, 0xffff0000, v196
    v_and_b32 v101, 0xffff0000, v204
    v_and_b32 v102, 0xffff0000, v212
    v_fma_f32 v103, v100, v216, v217
    v_add_f32 v100, v100, v102
    v_mfma_f32_32x32x16_bf16 v[128:143], a[148:151], v[52:55], v[128:143]
    ds_read_b128 v[44:47], v244 offset:1024
L_pad_H_26:
    s_cbranch_execz L_ret_H
    v_cvt_pk_bf16_f32 v103, v103, v103
    v_lshlrev_b32 v103, 16, v103
    v_mul_f32 v103, v103, v101
    v_cvt_pk_bf16_f32 v103, v103, v103
    v_lshlrev_b32 v103, 16, v103
    s_waitcnt lgkmcnt(2)
    v_mfma_f32_32x32x16_bf16 v[128:143], a[152:155], v[56:59], v[128:143]
    ds_read_b128 v[48:51], v244 offset:2048
    v_add_f32 v233, v100, v103
    v_lshlrev_b32 v96, 16, v197
    v_lshlrev_b32 v97, 16, v205
    v_lshlrev_b32 v98, 16, v213
    v_fma_f32 v99, v96, v216, v217
    v_mfma_f32_32x32x16_bf16 v[128:143], a[156:159], v[60:63], v[128:143]
    ds_read_b128 v[52:55], v244 offset:3072
    v_add_f32 v96, v96, v98
    v_cvt_pk_bf16_f32 v99, v99, v99
    v_lshlrev_b32 v99, 16, v99
    v_mul_f32 v99, v99, v97
    v_cvt_pk_bf16_f32 v99, v99, v99
    s_waitcnt lgkmcnt(2)
    v_mfma_f32_32x32x16_bf16 v[128:143], a[160:163], v[40:43], v[128:143]
    ds_read_b128 v[56:59], v244 offset:16384
    v_lshlrev_b32 v99, 16, v99
    v_add_f32 v234, v96, v99
    v_and_b32 v100, 0xffff0000, v197
    v_and_b32 v101, 0xffff0000, v205
    v_and_b32 v102, 0xffff0000, v213
    v_mfma_f32_32x32x16_bf16 v[128:143], a[164:167], v[44:47], v[128:143]
    ds_read_b128 v[60:63], v244 offset:17408
    v_fma_f32 v103, v100, v216, v217
    v_add_f32 v100, v100, v102
    v_cvt_pk_bf16_f32 v103, v103, v103
    v_lshlrev_b32 v103, 16, v103
    v_mul_f32 v103, v103, v101
    s_waitcnt lgkmcnt(2)
    v_mfma_f32_32x32x16_bf16 v[128:143], a[168:171], v[48:51], v[128:143]
    ds_read_b128 v[40:43], v244 offset:18432
    v_cvt_pk_bf16_f32 v103, v103, v103
    v_lshlrev_b32 v103, 16, v103
    v_add_f32 v235, v100, v103
    v_lshlrev_b32 v96, 16, v198
L_pad_H_27:
    s_cbranch_execz L_ret_H
    v_lshlrev_b32 v97, 16, v206
    v_mfma_f32_32x32x16_bf16 v[128:143], a[172:175], v[52:55], v[128:143]
    ds_read_b128 v[44:47], v244 offset:19456
    v_lshlrev_b32 v98, 16, v214
    v_fma_f32 v99, v96, v216, v217
    v_add_f32 v96, v96, v98
    v_cvt_pk_bf16_f32 v99, v99, v99
    v_lshlrev_b32 v99, 16, v99
    s_waitcnt lgkmcnt(2)
    v_mfma_f32_32x32x16_bf16 v[128:143], a[96:99], v[56:59], v[128:143]
    v_mul_f32 v99, v99, v97
    v_cvt_pk_bf16_f32 v99, v99, v99
    v_lshlrev_b32 v99, 16, v99
    v_add_f32 v236, v96, v99
    v_and_b32 v100, 0xffff0000, v198
    v_mfma_f32_32x32x16_bf16 v[128:143], a[100:103], v[60:63], v[128:143]
    v_and_b32 v101, 0xffff0000, v206
    v_and_b32 v102, 0xffff0000, v214
    v_fma_f32 v103, v100, v216, v217
    v_add_f32 v100, v100, v102
    v_cvt_pk_bf16_f32 v103, v103, v103
    s_waitcnt lgkmcnt(0)
    v_mfma_f32_32x32x16_bf16 v[128:143], a[104:107], v[40:43], v[128:143]
    v_lshlrev_b32 v103, 16, v103
    v_mul_f32 v103, v103, v101
    v_cvt_pk_bf16_f32 v103, v103, v103
    v_lshlrev_b32 v103, 16, v103
    v_add_f32 v237, v100, v103
    v_mfma_f32_32x32x16_bf16 v[128:143], a[108:111], v[44:47], v[128:143]
    v_lshlrev_b32 v96, 16, v199
    v_lshlrev_b32 v97, 16, v207
    v_lshlrev_b32 v98, 16, v215
    v_fma_f32 v99, v96, v216, v217
    v_add_f32 v96, v96, v98
    v_cvt_pk_bf16_f32 v99, v99, v99
    v_lshlrev_b32 v99, 16, v99
    v_mul_f32 v99, v99, v97
    v_cvt_pk_bf16_f32 v99, v99, v99
    v_lshlrev_b32 v99, 16, v99
    v_add_f32 v238, v96, v99
    v_and_b32 v100, 0xffff0000, v199
    v_and_b32 v101, 0xffff0000, v207
    s_nop 0
L_pad_H_28:
    s_cbranch_execz L_ret_H
    v_and_b32 v102, 0xffff0000, v215
    v_fma_f32 v103, v100, v216, v217
    v_add_f32 v100, v100, v102
    v_cvt_pk_bf16_f32 v103, v103, v103
    v_lshlrev_b32 v103, 16, v103
    v_mul_f32 v103, v103, v101
    v_cvt_pk_bf16_f32 v103, v103, v103
    v_lshlrev_b32 v103, 16, v103
    v_add_f32 v239, v100, v103
    s_add_u32 s78, s60, 49152
    v_add_u32 v240, s78, v10
    v_add_u32 v241, s78, v11
    v_add_u32 v242, s78, v12
    v_add_u32 v243, s78, v13
    v_add_u32 v244, s78, v2
    v_and_b32 v218, 0xfffffc00, v5
    v_add_u32 v218, v218, v5
    v_xor_b32 v245, 64, v218
    s_nop 9
    v_add_f32 v128, v128, v224
    v_add_f32 v129, v129, v225
    v_add_f32 v130, v130, v226
    v_add_f32 v131, v131, v227
    v_add_f32 v132, v132, v228
    v_add_f32 v133, v133, v229
    v_add_f32 v134, v134, v230
    v_add_f32 v135, v135, v231
    v_add_f32 v136, v136, v232
    v_add_f32 v137, v137, v233
    v_add_f32 v138, v138, v234
    v_add_f32 v139, v139, v235
    v_add_f32 v140, v140, v236
    v_add_f32 v141, v141, v237
    v_add_f32 v142, v142, v238
    v_add_f32 v143, v143, v239
    s_waitcnt vmcnt(0)
    v_max3_u32 v32, v64, v65, v66
    v_max3_u32 v33, v67, v68, v69
    v_max3_u32 v33, v33, v70, v71
    v_max3_u32 v32, v32, v72, v73
    v_max3_u32 v33, v33, v74, v75
    v_max3_u32 v32, v32, v76, v77
    v_max3_u32 v33, v33, v78, v79
    v_max3_u32 v32, v32, v80, v81
    v_max3_u32 v33, v33, v82, v83
    v_max3_u32 v32, v32, v84, v85
    s_nop 0
L_pad_H_29:
    s_cbranch_execz L_ret_H
    v_max3_u32 v33, v33, v86, v87
    v_max_u32 v32, v32, v33
    v_cmp_eq_u32 vcc, -1, v32
    s_cmp_eq_u64 vcc, 0
    s_cbranch_scc1 L_ins_ok
    s_mov_b32 s65, 0x40000
L_ins:
    buffer_load_dwordx4 v[64:67], v2, s[16:19], s3 offen offset:0 sc1
    buffer_load_dwordx4 v[68:71], v2, s[16:19], s3 offen offset:1024 sc1
    buffer_load_dwordx4 v[72:75], v2, s[16:19], s4 offen offset:0 sc1
    buffer_load_dwordx4 v[76:79], v2, s[16:19], s4 offen offset:1024 sc1
    buffer_load_dwordx4 v[80:83], v2, s[16:19], s5 offen offset:0 sc1
    buffer_load_dwordx4 v[84:87], v2, s[16:19], s5 offen offset:1024 sc1
    s_waitcnt vmcnt(0)
    v_max3_u32 v32, v64, v65, v66
    v_max3_u32 v33, v67, v68, v69
    v_max3_u32 v33, v33, v70, v71
    v_max3_u32 v32, v32, v72, v73
    v_max3_u32 v33, v33, v74, v75
    v_max3_u32 v32, v32, v76, v77
    v_max3_u32 v33, v33, v78, v79
    v_max3_u32 v32, v32, v80, v81
    v_max3_u32 v33, v33, v82, v83
    v_max3_u32 v32, v32, v84, v85
    v_max3_u32 v33, v33, v86, v87
    v_max_u32 v32, v32, v33
    v_cmp_eq_u32 vcc, -1, v32
    s_cmp_eq_u64 vcc, 0
    s_cbranch_scc1 L_ins_ok
    s_sleep 1
    s_sub_u32 s65, s65, 1
    s_cbranch_scc0 L_ins
L_ins_ok:
    v_lshlrev_b32 v96, 16, v64
    v_lshlrev_b32 v97, 16, v72
    v_lshlrev_b32 v98, 16, v80
    v_and_b32 v99, 0xffff0000, v64
    v_and_b32 v100, 0xffff0000, v72
    v_and_b32 v101, 0xffff0000, v80
    v_lshlrev_b32 v102, 16, v65
    v_lshlrev_b32 v103, 16, v73
    v_lshlrev_b32 v104, 16, v81
    s_nop 0
L_pad_H_30:
    s_cbranch_execz L_ret_H
    v_and_b32 v105, 0xffff0000, v65
    v_and_b32 v106, 0xffff0000, v73
    v_and_b32 v107, 0xffff0000, v81
    v_add_f32 v96, v96, v97
    v_add_f32 v128, v128, v98
    v_add_f32 v99, v99, v100
    v_add_f32 v129, v129, v101
    v_add_f32 v102, v102, v103
    v_add_f32 v130, v130, v104
    v_add_f32 v105, v105, v106
    v_add_f32 v131, v131, v107
    v_add_f32 v128, v128, v96
    v_add_f32 v129, v129, v99
    v_add_f32 v130, v130, v102
    v_add_f32 v131, v131, v105
    ds_write_b128 v240, v[128:131]
    v_lshlrev_b32 v96, 16, v66
    v_lshlrev_b32 v97, 16, v74
    v_lshlrev_b32 v98, 16, v82
    v_and_b32 v99, 0xffff0000, v66
    v_and_b32 v100, 0xffff0000, v74
    v_and_b32 v101, 0xffff0000, v82
    v_lshlrev_b32 v102, 16, v67
    v_lshlrev_b32 v103, 16, v75
    v_lshlrev_b32 v104, 16, v83
    v_and_b32 v105, 0xffff0000, v67
    v_and_b32 v106, 0xffff0000, v75
    v_and_b32 v107, 0xffff0000, v83
    v_add_f32 v96, v96, v97
    v_add_f32 v132, v132, v98
    v_add_f32 v99, v99, v100
    v_add_f32 v133, v133, v101
    v_add_f32 v102, v102, v103
    v_add_f32 v134, v134, v104
    v_add_f32 v105, v105, v106
    v_add_f32 v135, v135, v107
    v_add_f32 v132, v132, v96
    v_add_f32 v133, v133, v99
    v_add_f32 v134, v134, v102
    v_add_f32 v135, v135, v105
    ds_write_b128 v241, v[132:135]
    v_lshlrev_b32 v96, 16, v68
    v_lshlrev_b32 v97, 16, v76
    v_lshlrev_b32 v98, 16, v84
    v_and_b32 v99, 0xffff0000, v68
    v_and_b32 v100, 0xffff0000, v76
    v_and_b32 v101, 0xffff0000, v84
    v_lshlrev_b32 v102, 16, v69
    v_lshlrev_b32 v103, 16, v77
L_pad_H_31:
    s_cbranch_execz L_ret_H
    v_lshlrev_b32 v104, 16, v85
    v_and_b32 v105, 0xffff0000, v69
    v_and_b32 v106, 0xffff0000, v77
    v_and_b32 v107, 0xffff0000, v85
    v_add_f32 v96, v96, v97
    v_add_f32 v136, v136, v98
    v_add_f32 v99, v99, v100
    v_add_f32 v137, v137, v101
    v_add_f32 v102, v102, v103
    v_add_f32 v138, v138, v104
    v_add_f32 v105, v105, v106
    v_add_f32 v139, v139, v107
    v_add_f32 v136, v136, v96
    v_add_f32 v137, v137, v99
    v_add_f32 v138, v138, v102
    v_add_f32 v139, v139, v105
    ds_write_b128 v242, v[136:139]
    v_lshlrev_b32 v96, 16, v70
    v_lshlrev_b32 v97, 16, v78
    v_lshlrev_b32 v98, 16, v86
    v_and_b32 v99, 0xffff0000, v70
    v_and_b32 v100, 0xffff0000, v78
    v_and_b32 v101, 0xffff0000, v86
    v_lshlrev_b32 v102, 16, v71
    v_lshlrev_b32 v103, 16, v79
    v_lshlrev_b32 v104, 16, v87
    v_and_b32 v105, 0xffff0000, v71
    v_and_b32 v106, 0xffff0000, v79
    v_and_b32 v107, 0xffff0000, v87
    v_add_f32 v96, v96, v97
    v_add_f32 v140, v140, v98
    v_add_f32 v99, v99, v100
    v_add_f32 v141, v141, v101
    v_add_f32 v102, v102, v103
    v_add_f32 v142, v142, v104
    v_add_f32 v105, v105, v106
    v_add_f32 v143, v143, v107
    v_add_f32 v140, v140, v96
    v_add_f32 v141, v141, v99
    v_add_f32 v142, v142, v102
    v_add_f32 v143, v143, v105
    ds_write_b128 v243, v[140:143]
    s_waitcnt lgkmcnt(0)
    ds_read_b128 v[144:147], v244 offset:0
    ds_read_b128 v[148:151], v244 offset:1024
    ds_read_b128 v[152:155], v244 offset:2048
    ds_read_b128 v[156:159], v244 offset:3072
    s_waitcnt lgkmcnt(3)
L_pad_H_32:
    s_cbranch_execz L_ret_H
    buffer_store_dwordx4 v[144:147], v218, s[32:35], s6 offen
    s_add_u32 s6, s6, 16384
    s_waitcnt lgkmcnt(2)
    buffer_store_dwordx4 v[148:151], v245, s[32:35], s6 offen
    s_add_u32 s6, s6, 16384
    s_waitcnt lgkmcnt(1)
    buffer_store_dwordx4 v[152:155], v218, s[32:35], s6 offen
    s_add_u32 s6, s6, 16384
    s_waitcnt lgkmcnt(0)
    buffer_store_dwordx4 v[156:159], v245, s[32:35], s6 offen
    s_add_u32 s6, s6, 16384
    s_endpgm
L_end:
    s_endpgm
L_pad_F_0:
L_pad_S_0:
.section .rodata,"a"
.p2align 6
.amdhsa_kernel parallel_sum__ssm_conv_s5__dense_activation_squared_relu__prompt_kernel
  .amdhsa_next_free_vgpr 512
  .amdhsa_next_free_sgpr 102
  .amdhsa_accum_offset 256
  .amdhsa_group_segment_fixed_size 0
  .amdhsa_kernarg_size 136
  .amdhsa_user_sgpr_count 2
  .amdhsa_user_sgpr_kernarg_segment_ptr 1
  .amdhsa_system_sgpr_workgroup_id_x 1
.end_amdhsa_kernel
```
